```python
import torch

def _softmax(x, axis=-1):
    return torch.softmax(x, dim=axis)
def _gelu(x):
    return torch.nn.functional.gelu(x, approximate="tanh")
def _silu(x):
    return torch.nn.functional.silu(x)
def _sigmoid(x):
    return torch.sigmoid(x)
def _layernorm(x, axis=-1, eps=1e-5):
    m = x.mean(dim=axis, keepdim=True)
    v = x.var(dim=axis, keepdim=True, unbiased=False)
    return (x - m) / torch.sqrt(v + eps)
def _scatter_add(tgt, idx, src, axis=0):
    return tgt.clone().index_add_(axis, idx, src)
def _segment_sum(src, seg, n):
    out = torch.zeros((n,) + src.shape[1:], dtype=src.dtype)
    return out.index_add_(0, seg, src)
def _pad(x, pw):
    flat = tuple(v for pair in reversed(pw) for v in pair)
    return torch.nn.functional.pad(x, flat)

kernel_name = 'parallel_sum__compressed_kv_cla__mixer_channel_mlp__prompt'

def setup_inputs():

    _w = (lambda a: (lambda t: t.to(torch.bfloat16) if t.is_floating_point() else t)(torch.as_tensor(a)))
    def _A_setup():
        B, H, Sq, Sk, D, M = 1, 32, 2048, 2048, 128, 512
        Dc = 4 * D
        return {
            "x": _w((lambda *s: torch.randn(*s, dtype=torch.bfloat16) * 0.05)(B, Sq, M)),
            "c_kv": _w((lambda *s: torch.randn(*s, dtype=torch.bfloat16) * 0.4)(B, Sk, Dc)),
            "w_q": _w((lambda *s: torch.randn(*s, dtype=torch.bfloat16) * 3.2)(M, H, D) * (M ** -0.5)),
            "w_uk": _w((lambda *s: torch.randn(*s, dtype=torch.bfloat16) * 3.2)(Dc, H, D) * (Dc ** -0.5)),
            "w_uv": _w((lambda *s: torch.randn(*s, dtype=torch.bfloat16) * 0.4)(Dc, H, D) * (Dc ** -0.5)),
            "w_o": _w((lambda *s: torch.randn(*s, dtype=torch.bfloat16) * 0.4)(H, D, M) * ((H * D) ** -0.5)),
        }
    _A_in = _A_setup()

    def _B_setup():
        B, S, D, F = 1, 2048, 512, 1376
        return {
            "x": _w((lambda *s: torch.randn(*s, dtype=torch.bfloat16) * 0.05)(B, S, D)),
            "w1": _w((lambda *s: torch.randn(*s, dtype=torch.bfloat16) * 0.8)(D, F) * (D ** -0.5)),
            "b1": _w((lambda *s: torch.randn(*s, dtype=torch.bfloat16) * 0.4)(F)),
            "w2": _w((lambda *s: torch.randn(*s, dtype=torch.bfloat16) * 0.05)(F, D) * (F ** -0.5)),
            "b2": _w((lambda *s: torch.randn(*s, dtype=torch.bfloat16) * 0.05)(D)),
        }
    _B_in = _B_setup()

    return {
        "A_x": _A_in["x"],
        "A_c_kv": _A_in["c_kv"],
        "A_w_q": _A_in["w_q"],
        "A_w_uk": _A_in["w_uk"],
        "A_w_uv": _A_in["w_uv"],
        "A_w_o": _A_in["w_o"],
        "B_x": _B_in["x"],
        "B_w1": _B_in["w1"],
        "B_b1": _B_in["b1"],
        "B_w2": _B_in["w2"],
        "B_b2": _B_in["b2"],
    }

def reference(A_x, A_c_kv, A_w_q, A_w_uk, A_w_uv, A_w_o, B_x, B_w1, B_b1, B_w2, B_b2):
    def _A_ref(x, c_kv, w_q, w_uk, w_uv, w_o):
        B, Sq, M = x.shape[0], x.shape[1], x.shape[2]
        Sk = c_kv.shape[1]
        H, D = w_q.shape[1], w_q.shape[2]
        q = torch.einsum("bqm,mhd->bhqd", x, w_q)
        k = torch.einsum("bkc,chd->bhkd", c_kv, w_uk)
        v = torch.einsum("bkc,chd->bhkd", c_kv, w_uv)
        scores = torch.einsum("bhqd,bhkd->bhqk", q, k) * (D ** -0.5)
        off = Sk - Sq
        qi = torch.arange(Sq)[:, None]
        kj = torch.arange(Sk)[None, :]
        cmask = kj <= (qi + off)
        scores = torch.where(cmask[None, None], scores, -1e9)
        p = _softmax(scores, axis=-1)
        ctx = torch.einsum("bhqk,bhkd->bhqd", p, v)
        return torch.einsum("bhqd,hdm->bqm", ctx, w_o)

    def _B_ref(x, w1, b1, w2, b2):
        y = _layernorm(x, axis=-1)
        h = _gelu(torch.einsum("bsd,df->bsf", y, w1) + b1)
        return torch.einsum("bsf,fd->bsd", h, w2) + b2

    x = A_x
    xn = _layernorm(x, axis=-1)
    return x + _A_ref(xn, A_c_kv, A_w_q, A_w_uk, A_w_uv, A_w_o) + _B_ref(xn, B_w1, B_b1, B_w2, B_b2)
```

```asm
; @launch grid=(256,1,1) block=(512,1,1) lds=163840
.amdgcn_target "amdgcn-amd-amdhsa--gfx950"
.text
.globl parallel_sum__compressed_kv_cla__mixer_channel_mlp__prompt_kernel
.p2align 8
.type parallel_sum__compressed_kv_cla__mixer_channel_mlp__prompt_kernel,@function
parallel_sum__compressed_kv_cla__mixer_channel_mlp__prompt_kernel:
    s_cmp_ge_u32 s2, 256
    s_cbranch_scc1 L_end
    s_load_dwordx16 s[64:79], s[0:1], 0
    s_load_dwordx8 s[80:87], s[0:1], 64
    s_load_dwordx4 s[88:91], s[0:1], 96
    v_lshrrev_b32 v1, 6, v0
    v_and_b32 v255, 63, v0
    v_readfirstlane_b32 s3, v1
    v_lshlrev_b32 v254, 4, v255
    s_and_b32 s56, s2, 7
    s_lshl_b32 s56, s56, 2
    s_lshr_b32 s57, s2, 3
    s_and_b32 s57, s57, 3
    s_add_u32 s4, s56, s57
    s_lshr_b32 s5, s2, 5
    s_lshl_b32 s6, s4, 3
    s_add_u32 s6, s6, s5
    v_lshrrev_b32 v236, 3, v255
    v_lshlrev_b32 v236, 10, v236
    v_and_b32 v237, 7, v255
    v_lshrrev_b32 v238, 4, v255
    v_xor_b32 v237, v237, v238
    v_lshlrev_b32 v237, 4, v237
    v_add_u32 v198, v236, v237
    v_xor_b32 v237, 64, v237
    v_add_u32 v199, v236, v237
    v_lshrrev_b32 v236, 4, v255
    v_bfe_u32 v237, v255, 1, 3
    v_xor_b32 v237, v237, v236
    v_lshlrev_b32 v237, 5, v237
    v_and_b32 v238, 1, v255
    v_lshl_add_u32 v237, v238, 4, v237
    v_mul_u32_u24 v236, 8192, v236
    v_add_u32 v244, v236, v237
    v_xor_b32 v237, 128, v237
    v_add_u32 v245, v236, v237
    s_lshl_b32 s60, s5, 8
    s_lshl_b32 s93, s3, 5
    s_add_u32 s60, s60, s93
    s_lshl_b32 s60, s60, 10
    s_and_b32 s93, s3, 3
    s_lshl_b32 s61, s93, 17
    s_lshl_b32 s93, s4, 8
    s_add_u32 s61, s61, s93
    s_lshl_b32 s62, s3, 12
    s_add_u32 s63, s62, 32768
    s_waitcnt lgkmcnt(0)
    s_mov_b32 s8, s64
    s_and_b32 s9, s65, 0xffff
    s_mov_b32 s10, 2097152
    s_mov_b32 s11, 0x20000
    s_mov_b32 s12, s66
    s_and_b32 s13, s67, 0xffff
    s_mov_b32 s14, 2097152
    s_mov_b32 s15, 0x20000
    s_mov_b32 s24, s70
    s_and_b32 s25, s71, 0xffff
    s_mov_b32 s26, 4194304
    s_mov_b32 s27, 0x20000
    s_mov_b32 s100, s74
    s_mov_b32 s101, s75
    s_mov_b32 s96, s72
    s_mov_b32 s97, s73
    s_cmp_lt_u32 s3, 4
    s_cselect_b32 s56, s70, s72
    s_cselect_b32 s57, s71, s73
    s_mov_b32 s20, s56
    s_and_b32 s21, s57, 0xffff
    s_mov_b32 s22, 4194304
    s_mov_b32 s23, 0x20000
    s_mov_b32 s52, s90
    s_and_b32 s53, s91, 0xffff
    s_mov_b32 s54, 268435456
    s_mov_b32 s55, 0x20000
    s_lshl_b32 s56, s6, 3
    s_add_u32 s56, s56, s3
    s_lshl_b32 s57, s56, 10
    s_add_u32 m0, s62, 0
    s_add_u32 s93, s60, 0
    buffer_load_dwordx4 v198, s[12:15], s93 offen lds
    s_add_u32 m0, s62, 1024
    s_add_u32 s93, s60, 8192
    buffer_load_dwordx4 v199, s[12:15], s93 offen lds
    s_add_u32 m0, s62, 2048
    s_add_u32 s93, s60, 16384
    buffer_load_dwordx4 v198, s[12:15], s93 offen lds
    s_add_u32 m0, s62, 3072
    s_add_u32 s93, s60, 24576
    buffer_load_dwordx4 v199, s[12:15], s93 offen lds
    s_add_u32 m0, s63, 0
    s_add_u32 s93, s61, 0
    buffer_load_dwordx4 v244, s[20:23], s93 offen lds
    s_add_u32 m0, s63, 1024
    s_add_u32 s93, s61, 32768
    buffer_load_dwordx4 v244, s[20:23], s93 offen lds
    s_add_u32 m0, s63, 2048
    s_add_u32 s93, s61, 65536
    buffer_load_dwordx4 v245, s[20:23], s93 offen lds
    s_add_u32 m0, s63, 3072
    s_add_u32 s93, s61, 98304
    buffer_load_dwordx4 v245, s[20:23], s93 offen lds
    s_add_u32 s60, s60, 128
    s_add_u32 s61, s61, 524288
    s_xor_b32 s62, s62, 0x10000
    s_xor_b32 s63, s63, 0x10000
    buffer_load_dwordx4 v[200:203], v254, s[8:11], s57 offen
    s_cmp_lg_u32 s3, 0
    s_cbranch_scc1 L_pub72
    v_mov_b32 v248, 0
    s_lshl_b32 s93, s6, 7
    s_add_u32 s93, s93, 3145728
    v_mov_b32 v251, s93
    s_mov_b64 s[72:73], exec
    s_mov_b64 exec, 1
    buffer_store_dword v248, v251, s[52:55], 0 offen sc1
    s_mov_b64 exec, s[72:73]
    L_pub72:
L_st_j:
    s_mov_b32 s16, s68
    s_and_b32 s17, s69, 0xffff
    s_mov_b32 s18, 4194304
    s_mov_b32 s19, 0x20000
    s_mov_b32 s24, s100
    s_and_b32 s25, s101, 0xffff
    s_mov_b32 s26, 4194304
    s_mov_b32 s27, 0x20000
    s_mov_b32 s28, s78
    s_and_b32 s29, s79, 0xffff
    s_mov_b32 s30, 1409024
    s_mov_b32 s31, 0x20000
    s_mov_b32 s36, s80
    s_and_b32 s37, s81, 0xffff
    s_mov_b32 s38, 2752
    s_mov_b32 s39, 0x20000
    s_mov_b32 s32, s82
    s_and_b32 s33, s83, 0xffff
    s_mov_b32 s34, 1409024
    s_mov_b32 s35, 0x20000
    s_mov_b32 s40, s84
    s_and_b32 s41, s85, 0xffff
    s_mov_b32 s42, 1024
    s_mov_b32 s43, 0x20000
    s_mov_b32 s44, s86
    s_and_b32 s45, s87, 0xffff
    s_mov_b32 s46, 2097152
    s_mov_b32 s47, 0x20000
    s_mov_b32 s48, s88
    s_and_b32 s49, s89, 0xffff
    s_mov_b32 s50, 256
    s_mov_b32 s51, 0x20000
    s_mov_b32 s64, s96
    s_and_b32 s65, s97, 0xffff
    s_mov_b32 s66, 4194304
    s_mov_b32 s67, 0x20000
    v_lshlrev_b32 v230, 16, v255
    s_lshr_b32 s57, s2, 3
    s_cmp_lg_u32 s3, 3
    s_cbranch_scc1 L_tl9
    s_cmp_lg_u32 s57, 0
    s_cbranch_scc1 L_tl0
    buffer_load_dword v229, v230, s[20:23], 0 offen
    L_tl0:
    s_cmp_lg_u32 s57, 1
    s_cbranch_scc1 L_tl1
    buffer_load_dword v229, v230, s[64:67], 0 offen
    L_tl1:
    s_cmp_lg_u32 s57, 2
    s_cbranch_scc1 L_tl2
    buffer_load_dword v229, v230, s[16:19], 0 offen
    L_tl2:
    s_cmp_lg_u32 s57, 3
    s_cbranch_scc1 L_tl3
    buffer_load_dword v229, v230, s[28:31], 0 offen
    L_tl3:
    s_cmp_lg_u32 s57, 4
    s_cbranch_scc1 L_tl4
    buffer_load_dword v229, v230, s[24:27], 0 offen
    L_tl4:
    s_cmp_lg_u32 s57, 5
    s_cbranch_scc1 L_tl5
    buffer_load_dword v229, v230, s[32:35], 0 offen
    L_tl5:
L_tl9:
    s_and_b32 s93, s3, 1
    s_lshl_b32 s93, s93, 14
    v_and_b32 v236, 15, v255
    v_lshlrev_b32 v237, 7, v236
    v_add_u32 v237, s93, v237
    v_lshrrev_b32 v236, 1, v236
    v_lshrrev_b32 v238, 4, v255
    v_xor_b32 v236, v236, v238
    v_lshl_add_u32 v192, v236, 4, v237
    v_xor_b32 v193, 64, v192
    s_lshr_b32 s56, s3, 2
    s_lshl_b32 s56, s56, 14
    s_add_u32 s56, s56, 32768
    s_bfe_u32 s57, s3, 0x10001
    s_lshl_b32 s57, s57, 2
    v_lshrrev_b32 v236, 4, v255
    v_bfe_u32 v237, v255, 2, 2
    v_lshl_add_u32 v238, v236, 3, v237
    v_lshlrev_b32 v238, 8, v238
    v_and_b32 v239, 3, v255
    v_lshl_add_u32 v238, v239, 3, v238
    v_add_u32 v238, s56, v238
    v_and_b32 v236, 1, v236
    v_lshl_or_b32 v236, v236, 2, v237
    s_add_u32 s93, s57, 0
    v_xor_b32 v239, s93, v236
    v_lshl_add_u32 v194, v239, 5, v238
    s_add_u32 s93, s57, 1
    v_xor_b32 v239, s93, v236
    v_lshl_add_u32 v195, v239, 5, v238
    s_add_u32 s93, s57, 2
    v_xor_b32 v239, s93, v236
    v_lshl_add_u32 v196, v239, 5, v238
    s_add_u32 s93, s57, 3
    v_xor_b32 v239, s93, v236
    v_lshl_add_u32 v197, v239, 5, v238
    s_lshr_b32 s56, s3, 2
    s_and_b32 s57, s3, 3
    s_sub_u32 s58, 15, s5
    s_cmp_eq_u32 s56, 0
    s_cselect_b32 s58, s58, s5
    s_lshl_b32 s99, s58, 3
    s_lshl_b32 s93, s57, 1
    s_add_u32 s99, s99, s93
    s_lshl_b32 s87, s99, 14
    s_lshr_b32 s86, s4, 2
    s_add_u32 s86, s86, s5
    s_and_b32 s86, s86, 7
    s_sub_u32 s93, 64, s4
    s_and_b32 s93, s93, 3
    s_lshl_b32 s93, s93, 3
    s_add_u32 s86, s86, s93
    s_cmp_lt_u32 s86, 22
    s_cselect_b32 s71, 1, 0
    s_lshl_b32 s89, s3, 17
    s_lshl_b32 s93, s4, 8
    s_add_u32 s89, s89, s93
    s_lshl_b32 s70, s3, 12
    s_lshl_b32 s85, s3, 11
    s_mov_b32 s82, 1073741824
    v_lshrrev_b32 v236, 3, v255
    v_mul_u32_u24 v236, 2752, v236
    v_bfe_u32 v237, v255, 1, 2
    v_bfe_u32 v238, v255, 4, 1
    v_xor_b32 v237, v237, v238
    v_lshlrev_b32 v237, 5, v237
    v_and_b32 v238, 1, v255
    v_lshl_add_u32 v237, v238, 4, v237
    v_add_u32 v246, v236, v237
    v_xor_b32 v237, 64, v237
    v_add_u32 v247, v236, v237
    s_mul_i32 s88, s3, 44032
    s_lshl_b32 s93, s86, 7
    s_add_u32 s88, s88, s93
    s_cmp_lg_u32 s71, 0
    s_cselect_b32 s88, s88, s82
    s_lshl_b32 s93, s3, 2
    s_lshr_b32 s83, 0x22211221, s93
    s_and_b32 s83, s83, 15
    s_lshl_b32 s81, 1, s83
    s_mov_b32 s80, 0x40
    s_cmp_eq_u32 s3, 0
    s_cselect_b32 s93, 0x28, 0
    s_or_b32 s81, s81, s93
    s_cmp_eq_u32 s3, 0
    s_cselect_b32 s93, 4, 0
    s_or_b32 s80, s80, s93
    s_cmp_eq_u32 s3, 4
    s_cselect_b32 s93, 0x7c, 0
    s_or_b32 s81, s81, s93
    s_cmp_eq_u32 s3, 5
    s_cselect_b32 s93, 0x38, 0
    s_or_b32 s81, s81, s93
    s_and_b32 s93, s3, 3
    s_cmp_eq_u32 s93, 2
    s_cselect_b32 s93, 0x60, 0
    s_or_b32 s81, s81, s93
    v_lshlrev_b32 v250, 2, v255
    v_lshlrev_b32 v232, 7, v255
    v_lshlrev_b32 v233, 10, v255
    v_lshrrev_b32 v237, 4, v255
    v_lshlrev_b32 v237, 6, v237
    v_bfe_u32 v238, v255, 1, 3
    v_add_u32 v237, v237, v238
    v_lshlrev_b32 v237, 13, v237
    v_and_b32 v238, 1, v255
    v_lshl_add_u32 v234, v238, 7, v237
    v_and_b32 v241, 0xfffff, v234
    v_and_b32 v236, 7, v255
    v_mul_u32_u24 v235, 1040, v236
    v_lshrrev_b32 v238, 3, v255
    v_lshl_add_u32 v235, v238, 4, v235
    s_lshl_b32 s57, s3, 7
    s_add_u32 s57, s57, 131072
    v_add_u32 v235, s57, v235
    v_lshlrev_b32 v240, 8, v238
    v_lshl_add_u32 v240, v236, 4, v240
    s_lshr_b32 s7, s6, 1
    s_lshl_b32 s7, s7, 14
    s_lshl_b32 s58, s3, 11
    s_add_u32 s7, s7, s58
    s_and_b32 s58, s6, 1
    s_lshl_b32 s58, s58, 7
    s_add_u32 s7, s7, s58
    v_mov_b32 v0, 0
    v_mov_b32 v1, 0
    v_mov_b32 v2, 0
    v_mov_b32 v3, 0
    v_mov_b32 v4, 0
    v_mov_b32 v5, 0
    v_mov_b32 v6, 0
    v_mov_b32 v7, 0
    v_mov_b32 v8, 0
    v_mov_b32 v9, 0
    v_mov_b32 v10, 0
    v_mov_b32 v11, 0
    v_mov_b32 v12, 0
    v_mov_b32 v13, 0
    v_mov_b32 v14, 0
    v_mov_b32 v15, 0
    v_mov_b32 v16, 0
    v_mov_b32 v17, 0
    v_mov_b32 v18, 0
    v_mov_b32 v19, 0
    v_mov_b32 v20, 0
    v_mov_b32 v21, 0
    v_mov_b32 v22, 0
    v_mov_b32 v23, 0
    v_mov_b32 v24, 0
    v_mov_b32 v25, 0
    v_mov_b32 v26, 0
    v_mov_b32 v27, 0
    v_mov_b32 v28, 0
    v_mov_b32 v29, 0
    v_mov_b32 v30, 0
    v_mov_b32 v31, 0
    v_mov_b32 v32, 0
    v_mov_b32 v33, 0
    v_mov_b32 v34, 0
    v_mov_b32 v35, 0
    v_mov_b32 v36, 0
    v_mov_b32 v37, 0
    v_mov_b32 v38, 0
    v_mov_b32 v39, 0
    v_mov_b32 v40, 0
    v_mov_b32 v41, 0
    v_mov_b32 v42, 0
    v_mov_b32 v43, 0
    v_mov_b32 v44, 0
    v_mov_b32 v45, 0
    v_mov_b32 v46, 0
    v_mov_b32 v47, 0
    v_mov_b32 v48, 0
    v_mov_b32 v49, 0
    v_mov_b32 v50, 0
    v_mov_b32 v51, 0
    v_mov_b32 v52, 0
    v_mov_b32 v53, 0
    v_mov_b32 v54, 0
    v_mov_b32 v55, 0
    v_mov_b32 v56, 0
    v_mov_b32 v57, 0
    v_mov_b32 v58, 0
    v_mov_b32 v59, 0
    v_mov_b32 v60, 0
    v_mov_b32 v61, 0
    v_mov_b32 v62, 0
    v_mov_b32 v63, 0
    v_mov_b32 v64, 0
    v_mov_b32 v65, 0
    v_mov_b32 v66, 0
    v_mov_b32 v67, 0
    v_mov_b32 v68, 0
    v_mov_b32 v69, 0
    v_mov_b32 v70, 0
    v_mov_b32 v71, 0
    v_mov_b32 v72, 0
    v_mov_b32 v73, 0
    v_mov_b32 v74, 0
    v_mov_b32 v75, 0
    v_mov_b32 v76, 0
    v_mov_b32 v77, 0
    v_mov_b32 v78, 0
    v_mov_b32 v79, 0
    v_mov_b32 v80, 0
    v_mov_b32 v81, 0
    v_mov_b32 v82, 0
    v_mov_b32 v83, 0
    v_mov_b32 v84, 0
    v_mov_b32 v85, 0
    v_mov_b32 v86, 0
    v_mov_b32 v87, 0
    v_mov_b32 v88, 0
    v_mov_b32 v89, 0
    v_mov_b32 v90, 0
    v_mov_b32 v91, 0
    v_mov_b32 v92, 0
    v_mov_b32 v93, 0
    v_mov_b32 v94, 0
    v_mov_b32 v95, 0
    v_mov_b32 v96, 0
    v_mov_b32 v97, 0
    v_mov_b32 v98, 0
    v_mov_b32 v99, 0
    v_mov_b32 v100, 0
    v_mov_b32 v101, 0
    v_mov_b32 v102, 0
    v_mov_b32 v103, 0
    v_mov_b32 v104, 0
    v_mov_b32 v105, 0
    v_mov_b32 v106, 0
    v_mov_b32 v107, 0
    v_mov_b32 v108, 0
    v_mov_b32 v109, 0
    v_mov_b32 v110, 0
    v_mov_b32 v111, 0
    v_mov_b32 v112, 0
    v_mov_b32 v113, 0
    v_mov_b32 v114, 0
    v_mov_b32 v115, 0
    v_mov_b32 v116, 0
    v_mov_b32 v117, 0
    v_mov_b32 v118, 0
    v_mov_b32 v119, 0
    v_mov_b32 v120, 0
    v_mov_b32 v121, 0
    v_mov_b32 v122, 0
    v_mov_b32 v123, 0
    v_mov_b32 v124, 0
    v_mov_b32 v125, 0
    v_mov_b32 v126, 0
    v_mov_b32 v127, 0
    s_add_u32 m0, s62, 0
    s_add_u32 s93, s60, 0
    buffer_load_dwordx4 v198, s[12:15], s93 offen lds
    s_add_u32 m0, s62, 1024
    s_add_u32 s93, s60, 8192
    buffer_load_dwordx4 v199, s[12:15], s93 offen lds
    s_add_u32 m0, s62, 2048
    s_add_u32 s93, s60, 16384
    buffer_load_dwordx4 v198, s[12:15], s93 offen lds
    s_add_u32 m0, s62, 3072
    s_add_u32 s93, s60, 24576
    buffer_load_dwordx4 v199, s[12:15], s93 offen lds
    s_waitcnt vmcnt(4)
    s_barrier
    s_add_u32 m0, s63, 0
    s_add_u32 s93, s61, 0
    buffer_load_dwordx4 v244, s[20:23], s93 offen lds
    s_add_u32 m0, s63, 1024
    s_add_u32 s93, s61, 32768
    buffer_load_dwordx4 v244, s[20:23], s93 offen lds
    s_add_u32 m0, s63, 2048
    s_add_u32 s93, s61, 65536
    buffer_load_dwordx4 v245, s[20:23], s93 offen lds
    s_add_u32 m0, s63, 3072
    s_add_u32 s93, s61, 98304
    buffer_load_dwordx4 v245, s[20:23], s93 offen lds
    s_add_u32 s60, s60, 128
    s_add_u32 s61, s61, 524288
    s_xor_b32 s62, s62, 0x10000
    s_xor_b32 s63, s63, 0x10000
    s_mov_b32 s64, s52
    s_and_b32 s65, s53, 0xffff
    s_mov_b32 s66, 268435456
    s_mov_b32 s67, 0x20000
    v_mov_b32 v230, v232
    s_cmp_eq_u32 s3, 4
    s_cbranch_scc1 L_st_c
    s_lshl_b32 s57, s5, 16
    s_lshl_b32 s58, s4, 8
    s_add_u32 s57, s57, s58
    s_add_u32 s57, s57, 1048576
    s_and_b32 s58, s3, 3
    s_cmp_eq_u32 s58, 2
    s_cselect_b32 s57, s57, s82
    buffer_load_dword v229, v241, s[20:23], s57 offen
    s_branch L_st_a
L_st_c:
    s_lshl_b32 s57, s5, 2
    s_and_b32 s58, s4, 3
    s_add_u32 s57, s57, s58
    s_lshl_b32 s57, s57, 16
    s_add_u32 s57, s57, 256
    buffer_load_dword v229, v233, s[12:15], s57 offen
L_st_a:
    s_cmp_ge_u32 s3, 4
    s_cbranch_scc1 L_p1v
    ds_read_b64_tr_b16 v[128:129], v194 offset:0
    ds_read_b64_tr_b16 v[130:131], v194 offset:1024
    ds_read_b64_tr_b16 v[132:133], v195 offset:0
    ds_read_b64_tr_b16 v[134:135], v195 offset:1024
    ds_read_b128 v[160:163], v192 offset:0
    ds_read_b64_tr_b16 v[136:137], v196 offset:0
    ds_read_b64_tr_b16 v[138:139], v196 offset:1024
    ds_read_b64_tr_b16 v[140:141], v197 offset:0
    ds_read_b64_tr_b16 v[142:143], v197 offset:1024
    ds_read_b128 v[164:167], v192 offset:2048
    ds_read_b128 v[168:171], v192 offset:4096
    ds_read_b128 v[172:175], v192 offset:6144
    ds_read_b128 v[176:179], v192 offset:8192
    ds_read_b128 v[180:183], v192 offset:10240
    ds_read_b128 v[184:187], v192 offset:12288
    s_mov_b32 s92, 6
L_p1_k:
    s_waitcnt lgkmcnt(6)
    v_mfma_f32_16x16x32_bf16 v[0:3], v[128:131], v[160:163], v[0:3]
    v_mfma_f32_16x16x32_bf16 v[4:7], v[132:135], v[160:163], v[4:7]
    v_mfma_f32_16x16x32_bf16 v[8:11], v[136:139], v[160:163], v[8:11]
    v_mfma_f32_16x16x32_bf16 v[12:15], v[140:143], v[160:163], v[12:15]
    ds_read_b128 v[188:191], v192 offset:14336
    s_waitcnt lgkmcnt(6)
    v_mfma_f32_16x16x32_bf16 v[16:19], v[128:131], v[164:167], v[16:19]
    v_mfma_f32_16x16x32_bf16 v[20:23], v[132:135], v[164:167], v[20:23]
    v_mfma_f32_16x16x32_bf16 v[24:27], v[136:139], v[164:167], v[24:27]
    v_mfma_f32_16x16x32_bf16 v[28:31], v[140:143], v[164:167], v[28:31]
    ds_read_b64_tr_b16 v[144:145], v194 offset:8192
    s_waitcnt lgkmcnt(6)
    v_mfma_f32_16x16x32_bf16 v[32:35], v[128:131], v[168:171], v[32:35]
    ds_read_b64_tr_b16 v[146:147], v194 offset:9216
    v_mfma_f32_16x16x32_bf16 v[36:39], v[132:135], v[168:171], v[36:39]
    ds_read_b64_tr_b16 v[148:149], v195 offset:8192
    v_mfma_f32_16x16x32_bf16 v[40:43], v[136:139], v[168:171], v[40:43]
    ds_read_b64_tr_b16 v[150:151], v195 offset:9216
    v_mfma_f32_16x16x32_bf16 v[44:47], v[140:143], v[168:171], v[44:47]
    ds_read_b128 v[160:163], v193 offset:0
    s_waitcnt lgkmcnt(9)
    v_mfma_f32_16x16x32_bf16 v[48:51], v[128:131], v[172:175], v[48:51]
    ds_read_b64_tr_b16 v[152:153], v196 offset:8192
    v_mfma_f32_16x16x32_bf16 v[52:55], v[132:135], v[172:175], v[52:55]
    ds_read_b64_tr_b16 v[154:155], v196 offset:9216
    v_mfma_f32_16x16x32_bf16 v[56:59], v[136:139], v[172:175], v[56:59]
    ds_read_b64_tr_b16 v[156:157], v197 offset:8192
    v_mfma_f32_16x16x32_bf16 v[60:63], v[140:143], v[172:175], v[60:63]
    ds_read_b64_tr_b16 v[158:159], v197 offset:9216
    s_waitcnt lgkmcnt(12)
    v_mfma_f32_16x16x32_bf16 v[64:67], v[128:131], v[176:179], v[64:67]
    ds_read_b128 v[164:167], v193 offset:2048
    v_mfma_f32_16x16x32_bf16 v[68:71], v[132:135], v[176:179], v[68:71]
    ds_read_b128 v[168:171], v193 offset:4096
    v_mfma_f32_16x16x32_bf16 v[72:75], v[136:139], v[176:179], v[72:75]
    v_mfma_f32_16x16x32_bf16 v[76:79], v[140:143], v[176:179], v[76:79]
    ds_read_b128 v[172:175], v193 offset:6144
    s_waitcnt lgkmcnt(14)
    v_mfma_f32_16x16x32_bf16 v[80:83], v[128:131], v[180:183], v[80:83]
    v_mfma_f32_16x16x32_bf16 v[84:87], v[132:135], v[180:183], v[84:87]
    v_mfma_f32_16x16x32_bf16 v[88:91], v[136:139], v[180:183], v[88:91]
    v_mfma_f32_16x16x32_bf16 v[92:95], v[140:143], v[180:183], v[92:95]
    ds_read_b128 v[176:179], v193 offset:8192
    s_waitcnt lgkmcnt(14)
    v_mfma_f32_16x16x32_bf16 v[96:99], v[128:131], v[184:187], v[96:99]
    v_mfma_f32_16x16x32_bf16 v[100:103], v[132:135], v[184:187], v[100:103]
    v_mfma_f32_16x16x32_bf16 v[104:107], v[136:139], v[184:187], v[104:107]
    v_mfma_f32_16x16x32_bf16 v[108:111], v[140:143], v[184:187], v[108:111]
    ds_read_b128 v[180:183], v193 offset:10240
    s_waitcnt lgkmcnt(14)
    v_mfma_f32_16x16x32_bf16 v[112:115], v[128:131], v[188:191], v[112:115]
    v_mfma_f32_16x16x32_bf16 v[116:119], v[132:135], v[188:191], v[116:119]
    v_mfma_f32_16x16x32_bf16 v[120:123], v[136:139], v[188:191], v[120:123]
    v_mfma_f32_16x16x32_bf16 v[124:127], v[140:143], v[188:191], v[124:127]
    ds_read_b128 v[184:187], v193 offset:12288
    s_waitcnt lgkmcnt(6)
    v_mfma_f32_16x16x32_bf16 v[0:3], v[144:147], v[160:163], v[0:3]
    v_mfma_f32_16x16x32_bf16 v[4:7], v[148:151], v[160:163], v[4:7]
    v_mfma_f32_16x16x32_bf16 v[8:11], v[152:155], v[160:163], v[8:11]
    v_mfma_f32_16x16x32_bf16 v[12:15], v[156:159], v[160:163], v[12:15]
    ds_read_b128 v[188:191], v193 offset:14336
    s_waitcnt lgkmcnt(6)
    v_mfma_f32_16x16x32_bf16 v[16:19], v[144:147], v[164:167], v[16:19]
    v_mfma_f32_16x16x32_bf16 v[20:23], v[148:151], v[164:167], v[20:23]
    v_mfma_f32_16x16x32_bf16 v[24:27], v[152:155], v[164:167], v[24:27]
    v_mfma_f32_16x16x32_bf16 v[28:31], v[156:159], v[164:167], v[28:31]
    s_waitcnt lgkmcnt(0)
    s_bitcmp1_b32 s80, s92
    s_cbranch_scc1 L_prek
    L_prebk:
    s_waitcnt vmcnt(1)
    s_barrier
    s_cmp_eq_u32 s92, 6
    s_cbranch_scc1 L_lnsk
    L_lnsbk:
    v_xor_b32 v192, 0x10000, v192
    v_xor_b32 v193, 0x10000, v193
    v_xor_b32 v194, 0x10000, v194
    v_xor_b32 v195, 0x10000, v195
    v_xor_b32 v196, 0x10000, v196
    v_xor_b32 v197, 0x10000, v197
    v_mfma_f32_16x16x32_bf16 v[32:35], v[144:147], v[168:171], v[32:35]
    ds_read_b64_tr_b16 v[128:129], v194 offset:0
    v_mfma_f32_16x16x32_bf16 v[36:39], v[148:151], v[168:171], v[36:39]
    ds_read_b64_tr_b16 v[130:131], v194 offset:1024
    v_mfma_f32_16x16x32_bf16 v[40:43], v[152:155], v[168:171], v[40:43]
    s_add_u32 m0, s62, 0
    s_add_u32 s93, s60, 0
    buffer_load_dwordx4 v198, s[12:15], s93 offen lds
    v_mfma_f32_16x16x32_bf16 v[44:47], v[156:159], v[168:171], v[44:47]
    s_add_u32 m0, s62, 1024
    s_add_u32 s93, s60, 8192
    buffer_load_dwordx4 v199, s[12:15], s93 offen lds
    v_mfma_f32_16x16x32_bf16 v[48:51], v[144:147], v[172:175], v[48:51]
    ds_read_b64_tr_b16 v[132:133], v195 offset:0
    v_mfma_f32_16x16x32_bf16 v[52:55], v[148:151], v[172:175], v[52:55]
    ds_read_b64_tr_b16 v[134:135], v195 offset:1024
    v_mfma_f32_16x16x32_bf16 v[56:59], v[152:155], v[172:175], v[56:59]
    s_add_u32 m0, s62, 2048
    s_add_u32 s93, s60, 16384
    buffer_load_dwordx4 v198, s[12:15], s93 offen lds
    v_mfma_f32_16x16x32_bf16 v[60:63], v[156:159], v[172:175], v[60:63]
    s_add_u32 m0, s62, 3072
    s_add_u32 s93, s60, 24576
    buffer_load_dwordx4 v199, s[12:15], s93 offen lds
    v_mfma_f32_16x16x32_bf16 v[64:67], v[144:147], v[176:179], v[64:67]
    ds_read_b128 v[160:163], v192 offset:0
    v_mfma_f32_16x16x32_bf16 v[68:71], v[148:151], v[176:179], v[68:71]
    s_add_u32 m0, s63, 0
    s_add_u32 s93, s61, 0
    buffer_load_dwordx4 v244, s[20:23], s93 offen lds
    v_mfma_f32_16x16x32_bf16 v[72:75], v[152:155], v[176:179], v[72:75]
    ds_read_b64_tr_b16 v[136:137], v196 offset:0
    v_mfma_f32_16x16x32_bf16 v[76:79], v[156:159], v[176:179], v[76:79]
    ds_read_b64_tr_b16 v[138:139], v196 offset:1024
    v_mfma_f32_16x16x32_bf16 v[80:83], v[144:147], v[180:183], v[80:83]
    s_add_u32 m0, s63, 1024
    s_add_u32 s93, s61, 32768
    buffer_load_dwordx4 v244, s[20:23], s93 offen lds
    v_mfma_f32_16x16x32_bf16 v[84:87], v[148:151], v[180:183], v[84:87]
    s_add_u32 m0, s63, 2048
    s_add_u32 s93, s61, 65536
    buffer_load_dwordx4 v245, s[20:23], s93 offen lds
    v_mfma_f32_16x16x32_bf16 v[88:91], v[152:155], v[180:183], v[88:91]
    ds_read_b64_tr_b16 v[140:141], v197 offset:0
    v_mfma_f32_16x16x32_bf16 v[92:95], v[156:159], v[180:183], v[92:95]
    ds_read_b64_tr_b16 v[142:143], v197 offset:1024
    v_mfma_f32_16x16x32_bf16 v[96:99], v[144:147], v[184:187], v[96:99]
    s_add_u32 m0, s63, 3072
    s_add_u32 s93, s61, 98304
    buffer_load_dwordx4 v245, s[20:23], s93 offen lds
    s_add_u32 s60, s60, 128
    s_add_u32 s61, s61, 524288
    s_xor_b32 s62, s62, 0x10000
    s_xor_b32 s63, s63, 0x10000
    s_mov_b32 s57, s82
    s_bitcmp1_b32 s81, s92
    s_cbranch_scc1 L_postk
    L_postbk:
    buffer_load_dword v229, v230, s[64:67], s57 offen sc1
    v_mfma_f32_16x16x32_bf16 v[100:103], v[148:151], v[184:187], v[100:103]
    ds_read_b128 v[164:167], v192 offset:2048
    v_mfma_f32_16x16x32_bf16 v[104:107], v[152:155], v[184:187], v[104:107]
    ds_read_b128 v[168:171], v192 offset:4096
    v_mfma_f32_16x16x32_bf16 v[108:111], v[156:159], v[184:187], v[108:111]
    ds_read_b128 v[172:175], v192 offset:6144
    v_mfma_f32_16x16x32_bf16 v[112:115], v[144:147], v[188:191], v[112:115]
    ds_read_b128 v[176:179], v192 offset:8192
    v_mfma_f32_16x16x32_bf16 v[116:119], v[148:151], v[188:191], v[116:119]
    ds_read_b128 v[180:183], v192 offset:10240
    v_mfma_f32_16x16x32_bf16 v[120:123], v[152:155], v[188:191], v[120:123]
    v_mfma_f32_16x16x32_bf16 v[124:127], v[156:159], v[188:191], v[124:127]
    ds_read_b128 v[184:187], v192 offset:12288
    s_sub_u32 s92, s92, 1
    s_cmp_lg_u32 s92, 0
    s_cbranch_scc1 L_p1_k
    s_waitcnt lgkmcnt(6)
    v_mfma_f32_16x16x32_bf16 v[0:3], v[128:131], v[160:163], v[0:3]
    v_mfma_f32_16x16x32_bf16 v[4:7], v[132:135], v[160:163], v[4:7]
    v_mfma_f32_16x16x32_bf16 v[8:11], v[136:139], v[160:163], v[8:11]
    v_mfma_f32_16x16x32_bf16 v[12:15], v[140:143], v[160:163], v[12:15]
    ds_read_b128 v[188:191], v192 offset:14336
    s_waitcnt lgkmcnt(6)
    v_mfma_f32_16x16x32_bf16 v[16:19], v[128:131], v[164:167], v[16:19]
    v_mfma_f32_16x16x32_bf16 v[20:23], v[132:135], v[164:167], v[20:23]
    v_mfma_f32_16x16x32_bf16 v[24:27], v[136:139], v[164:167], v[24:27]
    v_mfma_f32_16x16x32_bf16 v[28:31], v[140:143], v[164:167], v[28:31]
    ds_read_b64_tr_b16 v[144:145], v194 offset:8192
    s_waitcnt lgkmcnt(6)
    v_mfma_f32_16x16x32_bf16 v[32:35], v[128:131], v[168:171], v[32:35]
    ds_read_b64_tr_b16 v[146:147], v194 offset:9216
    v_mfma_f32_16x16x32_bf16 v[36:39], v[132:135], v[168:171], v[36:39]
    ds_read_b64_tr_b16 v[148:149], v195 offset:8192
    v_mfma_f32_16x16x32_bf16 v[40:43], v[136:139], v[168:171], v[40:43]
    ds_read_b64_tr_b16 v[150:151], v195 offset:9216
    v_mfma_f32_16x16x32_bf16 v[44:47], v[140:143], v[168:171], v[44:47]
    ds_read_b128 v[160:163], v193 offset:0
    s_waitcnt lgkmcnt(9)
    v_mfma_f32_16x16x32_bf16 v[48:51], v[128:131], v[172:175], v[48:51]
    ds_read_b64_tr_b16 v[152:153], v196 offset:8192
    v_mfma_f32_16x16x32_bf16 v[52:55], v[132:135], v[172:175], v[52:55]
    ds_read_b64_tr_b16 v[154:155], v196 offset:9216
    v_mfma_f32_16x16x32_bf16 v[56:59], v[136:139], v[172:175], v[56:59]
    ds_read_b64_tr_b16 v[156:157], v197 offset:8192
    v_mfma_f32_16x16x32_bf16 v[60:63], v[140:143], v[172:175], v[60:63]
    ds_read_b64_tr_b16 v[158:159], v197 offset:9216
    s_waitcnt lgkmcnt(12)
    v_mfma_f32_16x16x32_bf16 v[64:67], v[128:131], v[176:179], v[64:67]
    ds_read_b128 v[164:167], v193 offset:2048
    v_mfma_f32_16x16x32_bf16 v[68:71], v[132:135], v[176:179], v[68:71]
    ds_read_b128 v[168:171], v193 offset:4096
    v_mfma_f32_16x16x32_bf16 v[72:75], v[136:139], v[176:179], v[72:75]
    v_mfma_f32_16x16x32_bf16 v[76:79], v[140:143], v[176:179], v[76:79]
    ds_read_b128 v[172:175], v193 offset:6144
    s_waitcnt lgkmcnt(14)
    v_mfma_f32_16x16x32_bf16 v[80:83], v[128:131], v[180:183], v[80:83]
    v_mfma_f32_16x16x32_bf16 v[84:87], v[132:135], v[180:183], v[84:87]
    v_mfma_f32_16x16x32_bf16 v[88:91], v[136:139], v[180:183], v[88:91]
    v_mfma_f32_16x16x32_bf16 v[92:95], v[140:143], v[180:183], v[92:95]
    ds_read_b128 v[176:179], v193 offset:8192
    s_waitcnt lgkmcnt(14)
    v_mfma_f32_16x16x32_bf16 v[96:99], v[128:131], v[184:187], v[96:99]
    v_mfma_f32_16x16x32_bf16 v[100:103], v[132:135], v[184:187], v[100:103]
    v_mfma_f32_16x16x32_bf16 v[104:107], v[136:139], v[184:187], v[104:107]
    v_mfma_f32_16x16x32_bf16 v[108:111], v[140:143], v[184:187], v[108:111]
    ds_read_b128 v[180:183], v193 offset:10240
    s_waitcnt lgkmcnt(14)
    v_mfma_f32_16x16x32_bf16 v[112:115], v[128:131], v[188:191], v[112:115]
    v_mfma_f32_16x16x32_bf16 v[116:119], v[132:135], v[188:191], v[116:119]
    v_mfma_f32_16x16x32_bf16 v[120:123], v[136:139], v[188:191], v[120:123]
    v_mfma_f32_16x16x32_bf16 v[124:127], v[140:143], v[188:191], v[124:127]
    ds_read_b128 v[184:187], v193 offset:12288
    s_waitcnt lgkmcnt(6)
    v_mfma_f32_16x16x32_bf16 v[0:3], v[144:147], v[160:163], v[0:3]
    v_mfma_f32_16x16x32_bf16 v[4:7], v[148:151], v[160:163], v[4:7]
    v_mfma_f32_16x16x32_bf16 v[8:11], v[152:155], v[160:163], v[8:11]
    v_mfma_f32_16x16x32_bf16 v[12:15], v[156:159], v[160:163], v[12:15]
    ds_read_b128 v[188:191], v193 offset:14336
    s_waitcnt lgkmcnt(6)
    v_mfma_f32_16x16x32_bf16 v[16:19], v[144:147], v[164:167], v[16:19]
    v_mfma_f32_16x16x32_bf16 v[20:23], v[148:151], v[164:167], v[20:23]
    v_mfma_f32_16x16x32_bf16 v[24:27], v[152:155], v[164:167], v[24:27]
    v_mfma_f32_16x16x32_bf16 v[28:31], v[156:159], v[164:167], v[28:31]
    s_waitcnt lgkmcnt(0)
    s_waitcnt vmcnt(1)
    s_barrier
    v_xor_b32 v192, 0x10000, v192
    v_xor_b32 v193, 0x10000, v193
    v_xor_b32 v194, 0x10000, v194
    v_xor_b32 v195, 0x10000, v195
    v_xor_b32 v196, 0x10000, v196
    v_xor_b32 v197, 0x10000, v197
    v_mfma_f32_16x16x32_bf16 v[32:35], v[144:147], v[168:171], v[32:35]
    ds_read_b64_tr_b16 v[128:129], v194 offset:0
    v_mfma_f32_16x16x32_bf16 v[36:39], v[148:151], v[168:171], v[36:39]
    ds_read_b64_tr_b16 v[130:131], v194 offset:1024
    v_mfma_f32_16x16x32_bf16 v[40:43], v[152:155], v[168:171], v[40:43]
    s_add_u32 m0, s70, 0
    s_add_u32 s93, s89, 0
    buffer_load_dwordx4 v244, s[16:19], s93 offen lds
    v_mfma_f32_16x16x32_bf16 v[44:47], v[156:159], v[168:171], v[44:47]
    s_add_u32 m0, s70, 1024
    s_add_u32 s93, s89, 32768
    buffer_load_dwordx4 v244, s[16:19], s93 offen lds
    v_mfma_f32_16x16x32_bf16 v[48:51], v[144:147], v[172:175], v[48:51]
    ds_read_b64_tr_b16 v[132:133], v195 offset:0
    v_mfma_f32_16x16x32_bf16 v[52:55], v[148:151], v[172:175], v[52:55]
    ds_read_b64_tr_b16 v[134:135], v195 offset:1024
    v_mfma_f32_16x16x32_bf16 v[56:59], v[152:155], v[172:175], v[56:59]
    s_add_u32 m0, s70, 2048
    s_add_u32 s93, s89, 65536
    buffer_load_dwordx4 v245, s[16:19], s93 offen lds
    v_mfma_f32_16x16x32_bf16 v[60:63], v[156:159], v[172:175], v[60:63]
    s_add_u32 m0, s70, 3072
    s_add_u32 s93, s89, 98304
    buffer_load_dwordx4 v245, s[16:19], s93 offen lds
    v_mfma_f32_16x16x32_bf16 v[64:67], v[144:147], v[176:179], v[64:67]
    ds_read_b128 v[160:163], v192 offset:0
    v_mfma_f32_16x16x32_bf16 v[68:71], v[148:151], v[176:179], v[68:71]
    s_add_u32 m0, s85, 32768
    s_add_u32 s93, s88, 0
    buffer_load_dwordx4 v246, s[28:31], s93 offen lds
    v_mfma_f32_16x16x32_bf16 v[72:75], v[152:155], v[176:179], v[72:75]
    ds_read_b64_tr_b16 v[136:137], v196 offset:0
    v_mfma_f32_16x16x32_bf16 v[76:79], v[156:159], v[176:179], v[76:79]
    ds_read_b64_tr_b16 v[138:139], v196 offset:1024
    v_mfma_f32_16x16x32_bf16 v[80:83], v[144:147], v[180:183], v[80:83]
    s_add_u32 m0, s85, 33792
    s_add_u32 s93, s88, 22016
    buffer_load_dwordx4 v247, s[28:31], s93 offen lds
    v_mfma_f32_16x16x32_bf16 v[84:87], v[148:151], v[180:183], v[84:87]
    ds_read_b64_tr_b16 v[140:141], v197 offset:0
    v_mfma_f32_16x16x32_bf16 v[88:91], v[152:155], v[180:183], v[88:91]
    ds_read_b64_tr_b16 v[142:143], v197 offset:1024
    v_mfma_f32_16x16x32_bf16 v[92:95], v[156:159], v[180:183], v[92:95]
    ds_read_b128 v[164:167], v192 offset:2048
    v_mfma_f32_16x16x32_bf16 v[96:99], v[144:147], v[184:187], v[96:99]
    ds_read_b128 v[168:171], v192 offset:4096
    v_mfma_f32_16x16x32_bf16 v[100:103], v[148:151], v[184:187], v[100:103]
    ds_read_b128 v[172:175], v192 offset:6144
    v_mfma_f32_16x16x32_bf16 v[104:107], v[152:155], v[184:187], v[104:107]
    ds_read_b128 v[176:179], v192 offset:8192
    v_mfma_f32_16x16x32_bf16 v[108:111], v[156:159], v[184:187], v[108:111]
    ds_read_b128 v[180:183], v192 offset:10240
    v_mfma_f32_16x16x32_bf16 v[112:115], v[144:147], v[188:191], v[112:115]
    v_mfma_f32_16x16x32_bf16 v[116:119], v[148:151], v[188:191], v[116:119]
    v_mfma_f32_16x16x32_bf16 v[120:123], v[152:155], v[188:191], v[120:123]
    v_mfma_f32_16x16x32_bf16 v[124:127], v[156:159], v[188:191], v[124:127]
    ds_read_b128 v[184:187], v192 offset:12288
    s_waitcnt lgkmcnt(6)
    v_mfma_f32_16x16x32_bf16 v[0:3], v[128:131], v[160:163], v[0:3]
    v_mfma_f32_16x16x32_bf16 v[4:7], v[132:135], v[160:163], v[4:7]
    v_mfma_f32_16x16x32_bf16 v[8:11], v[136:139], v[160:163], v[8:11]
    s_add_u32 s93, s87, 0
    buffer_load_dwordx4 v[200:203], v254, s[52:55], s93 offen offset:0 sc1
    v_mfma_f32_16x16x32_bf16 v[12:15], v[140:143], v[160:163], v[12:15]
    ds_read_b128 v[188:191], v192 offset:14336
    s_waitcnt lgkmcnt(6)
    v_mfma_f32_16x16x32_bf16 v[16:19], v[128:131], v[164:167], v[16:19]
    v_mfma_f32_16x16x32_bf16 v[20:23], v[132:135], v[164:167], v[20:23]
    s_add_u32 s93, s87, 16384
    buffer_load_dwordx4 v[204:207], v254, s[52:55], s93 offen offset:0 sc1
    v_mfma_f32_16x16x32_bf16 v[24:27], v[136:139], v[164:167], v[24:27]
    v_mfma_f32_16x16x32_bf16 v[28:31], v[140:143], v[164:167], v[28:31]
    ds_read_b64_tr_b16 v[144:145], v194 offset:8192
    s_waitcnt lgkmcnt(6)
    v_mfma_f32_16x16x32_bf16 v[32:35], v[128:131], v[168:171], v[32:35]
    ds_read_b64_tr_b16 v[146:147], v194 offset:9216
    s_add_u32 s93, s87, 0
    buffer_load_dwordx4 v[208:211], v254, s[52:55], s93 offen offset:1024 sc1
    v_mfma_f32_16x16x32_bf16 v[36:39], v[132:135], v[168:171], v[36:39]
    ds_read_b64_tr_b16 v[148:149], v195 offset:8192
    v_mfma_f32_16x16x32_bf16 v[40:43], v[136:139], v[168:171], v[40:43]
    ds_read_b64_tr_b16 v[150:151], v195 offset:9216
    v_mfma_f32_16x16x32_bf16 v[44:47], v[140:143], v[168:171], v[44:47]
    ds_read_b128 v[160:163], v193 offset:0
    s_add_u32 s93, s87, 16384
    buffer_load_dwordx4 v[212:215], v254, s[52:55], s93 offen offset:1024 sc1
    s_waitcnt lgkmcnt(9)
    v_mfma_f32_16x16x32_bf16 v[48:51], v[128:131], v[172:175], v[48:51]
    ds_read_b64_tr_b16 v[152:153], v196 offset:8192
    v_mfma_f32_16x16x32_bf16 v[52:55], v[132:135], v[172:175], v[52:55]
    ds_read_b64_tr_b16 v[154:155], v196 offset:9216
    v_mfma_f32_16x16x32_bf16 v[56:59], v[136:139], v[172:175], v[56:59]
    ds_read_b64_tr_b16 v[156:157], v197 offset:8192
    s_add_u32 s93, s87, 0
    buffer_load_dwordx4 v[216:219], v254, s[52:55], s93 offen offset:2048 sc1
    v_mfma_f32_16x16x32_bf16 v[60:63], v[140:143], v[172:175], v[60:63]
    ds_read_b64_tr_b16 v[158:159], v197 offset:9216
    s_waitcnt lgkmcnt(12)
    v_mfma_f32_16x16x32_bf16 v[64:67], v[128:131], v[176:179], v[64:67]
    ds_read_b128 v[164:167], v193 offset:2048
    v_mfma_f32_16x16x32_bf16 v[68:71], v[132:135], v[176:179], v[68:71]
    ds_read_b128 v[168:171], v193 offset:4096
    s_add_u32 s93, s87, 16384
    buffer_load_dwordx4 v[220:223], v254, s[52:55], s93 offen offset:2048 sc1
    v_mfma_f32_16x16x32_bf16 v[72:75], v[136:139], v[176:179], v[72:75]
    v_mfma_f32_16x16x32_bf16 v[76:79], v[140:143], v[176:179], v[76:79]
    ds_read_b128 v[172:175], v193 offset:6144
    s_waitcnt lgkmcnt(14)
    v_mfma_f32_16x16x32_bf16 v[80:83], v[128:131], v[180:183], v[80:83]
    s_add_u32 s93, s87, 0
    buffer_load_dwordx4 v[224:227], v254, s[52:55], s93 offen offset:3072 sc1
    v_mfma_f32_16x16x32_bf16 v[84:87], v[132:135], v[180:183], v[84:87]
    v_mfma_f32_16x16x32_bf16 v[88:91], v[136:139], v[180:183], v[88:91]
    v_mfma_f32_16x16x32_bf16 v[92:95], v[140:143], v[180:183], v[92:95]
    ds_read_b128 v[176:179], v193 offset:8192
    s_add_u32 s93, s87, 16384
    buffer_load_dwordx4 v[228:231], v254, s[52:55], s93 offen offset:3072 sc1
    s_waitcnt lgkmcnt(14)
    v_mfma_f32_16x16x32_bf16 v[96:99], v[128:131], v[184:187], v[96:99]
    v_mfma_f32_16x16x32_bf16 v[100:103], v[132:135], v[184:187], v[100:103]
    v_mfma_f32_16x16x32_bf16 v[104:107], v[136:139], v[184:187], v[104:107]
    s_add_u32 s93, s87, 4096
    buffer_load_dwordx4 v[232:235], v254, s[52:55], s93 offen offset:0 sc1
    v_mfma_f32_16x16x32_bf16 v[108:111], v[140:143], v[184:187], v[108:111]
    ds_read_b128 v[180:183], v193 offset:10240
    s_waitcnt lgkmcnt(14)
    v_mfma_f32_16x16x32_bf16 v[112:115], v[128:131], v[188:191], v[112:115]
    v_mfma_f32_16x16x32_bf16 v[116:119], v[132:135], v[188:191], v[116:119]
    s_add_u32 s93, s87, 20480
    buffer_load_dwordx4 v[236:239], v254, s[52:55], s93 offen offset:0 sc1
    v_mfma_f32_16x16x32_bf16 v[120:123], v[136:139], v[188:191], v[120:123]
    v_mfma_f32_16x16x32_bf16 v[124:127], v[140:143], v[188:191], v[124:127]
    ds_read_b128 v[184:187], v193 offset:12288
    s_waitcnt lgkmcnt(6)
    v_mfma_f32_16x16x32_bf16 v[0:3], v[144:147], v[160:163], v[0:3]
    v_mfma_f32_16x16x32_bf16 v[4:7], v[148:151], v[160:163], v[4:7]
    v_mfma_f32_16x16x32_bf16 v[8:11], v[152:155], v[160:163], v[8:11]
    v_mfma_f32_16x16x32_bf16 v[12:15], v[156:159], v[160:163], v[12:15]
    ds_read_b128 v[188:191], v193 offset:14336
    s_waitcnt lgkmcnt(6)
    v_mfma_f32_16x16x32_bf16 v[16:19], v[144:147], v[164:167], v[16:19]
    v_mfma_f32_16x16x32_bf16 v[20:23], v[148:151], v[164:167], v[20:23]
    v_mfma_f32_16x16x32_bf16 v[24:27], v[152:155], v[164:167], v[24:27]
    v_mfma_f32_16x16x32_bf16 v[28:31], v[156:159], v[164:167], v[28:31]
    s_waitcnt lgkmcnt(5)
    v_mfma_f32_16x16x32_bf16 v[32:35], v[144:147], v[168:171], v[32:35]
    v_mfma_f32_16x16x32_bf16 v[36:39], v[148:151], v[168:171], v[36:39]
    v_mfma_f32_16x16x32_bf16 v[40:43], v[152:155], v[168:171], v[40:43]
    v_mfma_f32_16x16x32_bf16 v[44:47], v[156:159], v[168:171], v[44:47]
    s_waitcnt lgkmcnt(0)
    s_waitcnt vmcnt(0)
    s_barrier
    s_add_u32 m0, s70, 65536
    s_add_u32 s93, s89, 1048576
    buffer_load_dwordx4 v244, s[16:19], s93 offen lds
    s_add_u32 m0, s70, 66560
    s_add_u32 s93, s89, 1081344
    buffer_load_dwordx4 v244, s[16:19], s93 offen lds
    s_add_u32 m0, s70, 67584
    s_add_u32 s93, s89, 1114112
    buffer_load_dwordx4 v245, s[16:19], s93 offen lds
    s_add_u32 m0, s70, 68608
    s_add_u32 s93, s89, 1146880
    buffer_load_dwordx4 v245, s[16:19], s93 offen lds
    s_add_u32 m0, s85, 98304
    s_add_u32 s93, s88, 352256
    buffer_load_dwordx4 v246, s[28:31], s93 offen lds
    s_add_u32 m0, s85, 99328
    s_add_u32 s93, s88, 374272
    buffer_load_dwordx4 v247, s[28:31], s93 offen lds
    v_mfma_f32_16x16x32_bf16 v[48:51], v[144:147], v[172:175], v[48:51]
    v_mfma_f32_16x16x32_bf16 v[52:55], v[148:151], v[172:175], v[52:55]
    v_mfma_f32_16x16x32_bf16 v[56:59], v[152:155], v[172:175], v[56:59]
    v_mfma_f32_16x16x32_bf16 v[60:63], v[156:159], v[172:175], v[60:63]
    v_mfma_f32_16x16x32_bf16 v[64:67], v[144:147], v[176:179], v[64:67]
    v_mfma_f32_16x16x32_bf16 v[68:71], v[148:151], v[176:179], v[68:71]
    v_mfma_f32_16x16x32_bf16 v[72:75], v[152:155], v[176:179], v[72:75]
    v_mfma_f32_16x16x32_bf16 v[76:79], v[156:159], v[176:179], v[76:79]
    v_mfma_f32_16x16x32_bf16 v[80:83], v[144:147], v[180:183], v[80:83]
    v_mfma_f32_16x16x32_bf16 v[84:87], v[148:151], v[180:183], v[84:87]
    v_mfma_f32_16x16x32_bf16 v[88:91], v[152:155], v[180:183], v[88:91]
    v_mfma_f32_16x16x32_bf16 v[92:95], v[156:159], v[180:183], v[92:95]
    v_mfma_f32_16x16x32_bf16 v[96:99], v[144:147], v[184:187], v[96:99]
    v_mfma_f32_16x16x32_bf16 v[100:103], v[148:151], v[184:187], v[100:103]
    v_mfma_f32_16x16x32_bf16 v[104:107], v[152:155], v[184:187], v[104:107]
    v_mfma_f32_16x16x32_bf16 v[108:111], v[156:159], v[184:187], v[108:111]
    v_mfma_f32_16x16x32_bf16 v[112:115], v[144:147], v[188:191], v[112:115]
    v_mfma_f32_16x16x32_bf16 v[116:119], v[148:151], v[188:191], v[116:119]
    v_mfma_f32_16x16x32_bf16 v[120:123], v[152:155], v[188:191], v[120:123]
    v_mfma_f32_16x16x32_bf16 v[124:127], v[156:159], v[188:191], v[124:127]
    s_branch L_p1_done
    L_prek:
    s_cmp_lg_u32 s92, 6
    s_cbranch_scc1 L_pre1k
    s_call_b64 s[94:95], L_ln
    s_branch L_prebk
    L_pre1k:
    s_waitcnt vmcnt(0)
    s_mov_b32 s90, 0
    L_pl73:
    v_cmp_ne_u32 vcc, 0x01010101, v249
    s_cbranch_vccz L_pd73
    s_add_u32 s90, s90, 1
    s_cmp_gt_u32 s90, 0x40000
    s_cbranch_scc1 L_pd73
    s_sleep 8
    buffer_load_dword v249, v250, s[48:51], 0 offen sc1
    s_waitcnt vmcnt(0)
    s_branch L_pl73
    L_pd73:
    s_branch L_prebk
    L_postk:
    s_cmp_lg_u32 s92, s83
    s_cbranch_scc1 L_q1k
    s_lshr_b32 s57, s2, 3
    s_lshl_b32 s57, s57, 16
    s_lshl_b32 s58, s3, 13
    s_add_u32 s57, s57, s58
    s_mov_b32 s64, s52
    s_mov_b32 s65, s53
    s_mov_b32 s66, s54
    v_mov_b32 v230, v232
    s_branch L_postbk
    L_q1k:
    s_and_b32 s57, s3, 3
    s_cmp_lg_u32 s57, 2
    s_cbranch_scc1 L_q0k
    s_sub_u32 s57, 8, s92
    s_lshl_b32 s57, s57, 20
    s_lshl_b32 s58, s5, 16
    s_add_u32 s57, s57, s58
    s_lshl_b32 s58, s4, 8
    s_add_u32 s57, s57, s58
    s_mov_b32 s64, s20
    s_mov_b32 s65, s21
    s_mov_b32 s66, s22
    v_mov_b32 v230, v241
    s_branch L_postbk
    L_q0k:
    s_cmp_eq_u32 s92, 5
    s_cbranch_scc0 L_q2k
    s_cmp_lg_u32 s3, 0
    s_cbranch_scc1 L_pub74
    v_mov_b32 v248, 1
    v_mov_b32 v251, s6
    s_mov_b64 s[72:73], exec
    s_mov_b64 exec, 1
    buffer_store_byte v248, v251, s[48:51], 0 offen sc1
    s_mov_b64 exec, s[72:73]
    L_pub74:
    s_branch L_postbk
    L_q2k:
    buffer_load_dword v249, v250, s[48:51], 0 offen sc1
    s_branch L_postbk
    L_lnsk:
    ds_read_b128 v[200:203], v235
    s_lshl_b32 s57, s6, 3
    s_add_u32 s57, s57, s3
    s_lshl_b32 s57, s57, 3
    s_add_u32 s57, s57, 2097152
    s_mov_b64 s[72:73], exec
    s_mov_b64 exec, 1
    buffer_store_dwordx2 v[226:227], v255, s[52:55], s57 offen sc1
    s_mov_b64 exec, s[72:73]
    s_waitcnt lgkmcnt(0)
    buffer_store_dwordx4 v[200:203], v240, s[52:55], s7 offen sc1
    s_branch L_lnsbk
L_ln:
    v_lshlrev_b32 v204, 16, v200
    v_and_b32 v205, 0xffff0000, v200
    v_lshlrev_b32 v206, 16, v201
    v_and_b32 v207, 0xffff0000, v201
    v_lshlrev_b32 v208, 16, v202
    v_and_b32 v209, 0xffff0000, v202
    v_lshlrev_b32 v210, 16, v203
    v_and_b32 v211, 0xffff0000, v203
    v_add_f32 v212, v204, v205
    v_add_f32 v213, v206, v207
    v_add_f32 v214, v208, v209
    v_add_f32 v215, v210, v211
    v_add_f32 v212, v212, v213
    v_add_f32 v214, v214, v215
    v_add_f32 v212, v212, v214
    s_nop 1
    v_add_f32_dpp v212, v212, v212 quad_perm:[1,0,3,2] row_mask:0xf bank_mask:0xf
    s_nop 1
    v_add_f32_dpp v212, v212, v212 quad_perm:[2,3,0,1] row_mask:0xf bank_mask:0xf
    s_nop 1
    v_add_f32_dpp v212, v212, v212 row_half_mirror row_mask:0xf bank_mask:0xf
    s_nop 1
    v_add_f32_dpp v212, v212, v212 row_mirror row_mask:0xf bank_mask:0xf
    v_mov_b32 v214, v212
    s_nop 1
    v_permlane16_swap_b32 v212, v214
    v_add_f32 v212, v212, v214
    v_mov_b32 v214, v212
    s_nop 1
    v_permlane32_swap_b32 v212, v214
    v_add_f32 v212, v212, v214
    v_mul_f32 v212, 0x3b000000, v212
    v_sub_f32 v216, v204, v212
    v_sub_f32 v217, v205, v212
    v_sub_f32 v218, v206, v212
    v_sub_f32 v219, v207, v212
    v_sub_f32 v220, v208, v212
    v_sub_f32 v221, v209, v212
    v_sub_f32 v222, v210, v212
    v_sub_f32 v223, v211, v212
    v_mul_f32 v213, v216, v216
    v_mul_f32 v215, v217, v217
    v_fmac_f32 v213, v218, v218
    v_fmac_f32 v215, v219, v219
    v_fmac_f32 v213, v220, v220
    v_fmac_f32 v215, v221, v221
    v_fmac_f32 v213, v222, v222
    v_fmac_f32 v215, v223, v223
    v_add_f32 v213, v213, v215
    s_nop 1
    v_add_f32_dpp v213, v213, v213 quad_perm:[1,0,3,2] row_mask:0xf bank_mask:0xf
    s_nop 1
    v_add_f32_dpp v213, v213, v213 quad_perm:[2,3,0,1] row_mask:0xf bank_mask:0xf
    s_nop 1
    v_add_f32_dpp v213, v213, v213 row_half_mirror row_mask:0xf bank_mask:0xf
    s_nop 1
    v_add_f32_dpp v213, v213, v213 row_mirror row_mask:0xf bank_mask:0xf
    v_mov_b32 v214, v213
    s_nop 1
    v_permlane16_swap_b32 v213, v214
    v_add_f32 v213, v213, v214
    v_mov_b32 v214, v213
    s_nop 1
    v_permlane32_swap_b32 v213, v214
    v_add_f32 v213, v213, v214
    v_mul_f32 v213, 0x3b000000, v213
    v_cvt_pk_bf16_f32 v212, v212, v212
    v_lshlrev_b32 v212, 16, v212
    v_cvt_pk_bf16_f32 v213, v213, v213
    v_lshlrev_b32 v213, 16, v213
    v_add_f32 v213, 0x3727c5ac, v213
    v_cvt_pk_bf16_f32 v213, v213, v213
    v_lshlrev_b32 v213, 16, v213
    v_sqrt_f32 v213, v213
    s_nop 0
    v_cvt_pk_bf16_f32 v213, v213, v213
    v_lshlrev_b32 v213, 16, v213
    v_rcp_f32 v215, v213
    v_sub_f32 v216, v204, v212
    v_sub_f32 v217, v205, v212
    v_sub_f32 v218, v206, v212
    v_sub_f32 v219, v207, v212
    v_sub_f32 v220, v208, v212
    v_sub_f32 v221, v209, v212
    v_sub_f32 v222, v210, v212
    v_sub_f32 v223, v211, v212
    v_cvt_pk_bf16_f32 v200, v216, v217
    v_cvt_pk_bf16_f32 v201, v218, v219
    v_cvt_pk_bf16_f32 v202, v220, v221
    v_cvt_pk_bf16_f32 v203, v222, v223
    v_lshlrev_b32 v216, 16, v200
    v_and_b32 v217, 0xffff0000, v200
    v_lshlrev_b32 v218, 16, v201
    v_and_b32 v219, 0xffff0000, v201
    v_lshlrev_b32 v220, 16, v202
    v_and_b32 v221, 0xffff0000, v202
    v_lshlrev_b32 v222, 16, v203
    v_and_b32 v223, 0xffff0000, v203
    v_mul_f32 v204, v216, v215
    v_fma_f32 v216, -v204, v213, v216
    v_fmac_f32 v204, v216, v215
    v_mul_f32 v205, v217, v215
    v_fma_f32 v217, -v205, v213, v217
    v_fmac_f32 v205, v217, v215
    v_mul_f32 v206, v218, v215
    v_fma_f32 v218, -v206, v213, v218
    v_fmac_f32 v206, v218, v215
    v_mul_f32 v207, v219, v215
    v_fma_f32 v219, -v207, v213, v219
    v_fmac_f32 v207, v219, v215
    v_mul_f32 v208, v220, v215
    v_fma_f32 v220, -v208, v213, v220
    v_fmac_f32 v208, v220, v215
    v_mul_f32 v209, v221, v215
    v_fma_f32 v221, -v209, v213, v221
    v_fmac_f32 v209, v221, v215
    v_mul_f32 v210, v222, v215
    v_fma_f32 v222, -v210, v213, v222
    v_fmac_f32 v210, v222, v215
    v_mul_f32 v211, v223, v215
    v_fma_f32 v223, -v211, v213, v223
    v_fmac_f32 v211, v223, v215
    v_cvt_pk_bf16_f32 v200, v204, v205
    v_cvt_pk_bf16_f32 v201, v206, v207
    v_cvt_pk_bf16_f32 v202, v208, v209
    v_cvt_pk_bf16_f32 v203, v210, v211
    v_lshlrev_b32 v204, 16, v200
    v_and_b32 v205, 0xffff0000, v200
    v_lshlrev_b32 v206, 16, v201
    v_and_b32 v207, 0xffff0000, v201
    v_lshlrev_b32 v208, 16, v202
    v_and_b32 v209, 0xffff0000, v202
    v_lshlrev_b32 v210, 16, v203
    v_and_b32 v211, 0xffff0000, v203
    v_add_f32 v212, v204, v205
    v_add_f32 v213, v206, v207
    v_add_f32 v214, v208, v209
    v_add_f32 v215, v210, v211
    v_add_f32 v212, v212, v213
    v_add_f32 v214, v214, v215
    v_add_f32 v212, v212, v214
    s_nop 1
    v_add_f32_dpp v212, v212, v212 quad_perm:[1,0,3,2] row_mask:0xf bank_mask:0xf
    s_nop 1
    v_add_f32_dpp v212, v212, v212 quad_perm:[2,3,0,1] row_mask:0xf bank_mask:0xf
    s_nop 1
    v_add_f32_dpp v212, v212, v212 row_half_mirror row_mask:0xf bank_mask:0xf
    s_nop 1
    v_add_f32_dpp v212, v212, v212 row_mirror row_mask:0xf bank_mask:0xf
    v_mov_b32 v214, v212
    s_nop 1
    v_permlane16_swap_b32 v212, v214
    v_add_f32 v212, v212, v214
    v_mov_b32 v214, v212
    s_nop 1
    v_permlane32_swap_b32 v212, v214
    v_add_f32 v212, v212, v214
    v_mul_f32 v212, 0x3b000000, v212
    v_sub_f32 v216, v204, v212
    v_sub_f32 v217, v205, v212
    v_sub_f32 v218, v206, v212
    v_sub_f32 v219, v207, v212
    v_sub_f32 v220, v208, v212
    v_sub_f32 v221, v209, v212
    v_sub_f32 v222, v210, v212
    v_sub_f32 v223, v211, v212
    v_mul_f32 v213, v216, v216
    v_mul_f32 v215, v217, v217
    v_fmac_f32 v213, v218, v218
    v_fmac_f32 v215, v219, v219
    v_fmac_f32 v213, v220, v220
    v_fmac_f32 v215, v221, v221
    v_fmac_f32 v213, v222, v222
    v_fmac_f32 v215, v223, v223
    v_add_f32 v213, v213, v215
    s_nop 1
    v_add_f32_dpp v213, v213, v213 quad_perm:[1,0,3,2] row_mask:0xf bank_mask:0xf
    s_nop 1
    v_add_f32_dpp v213, v213, v213 quad_perm:[2,3,0,1] row_mask:0xf bank_mask:0xf
    s_nop 1
    v_add_f32_dpp v213, v213, v213 row_half_mirror row_mask:0xf bank_mask:0xf
    s_nop 1
    v_add_f32_dpp v213, v213, v213 row_mirror row_mask:0xf bank_mask:0xf
    v_mov_b32 v214, v213
    s_nop 1
    v_permlane16_swap_b32 v213, v214
    v_add_f32 v213, v213, v214
    v_mov_b32 v214, v213
    s_nop 1
    v_permlane32_swap_b32 v213, v214
    v_add_f32 v213, v213, v214
    v_mul_f32 v213, 0x3b000000, v213
    v_cvt_pk_bf16_f32 v212, v212, v212
    v_lshlrev_b32 v212, 16, v212
    v_cvt_pk_bf16_f32 v213, v213, v213
    v_lshlrev_b32 v213, 16, v213
    v_add_f32 v213, 0x3727c5ac, v213
    v_cvt_pk_bf16_f32 v213, v213, v213
    v_lshlrev_b32 v213, 16, v213
    v_sqrt_f32 v213, v213
    s_nop 0
    v_cvt_pk_bf16_f32 v213, v213, v213
    v_lshlrev_b32 v213, 16, v213
    v_rcp_f32 v215, v213
    v_mov_b32 v226, v212
    v_mov_b32 v227, v215
    s_mul_i32 s57, s3, 1040
    s_add_u32 s57, s57, 131072
    v_add_u32 v204, s57, v254
    ds_write_b128 v204, v[200:203]
    s_waitcnt lgkmcnt(0)
    s_setpc_b64 s[94:95]
L_p1v:
    s_call_b64 s[94:95], L_ln
    ds_read_b64_tr_b16 v[128:129], v194 offset:0
    ds_read_b64_tr_b16 v[130:131], v194 offset:1024
    ds_read_b64_tr_b16 v[132:133], v195 offset:0
    ds_read_b64_tr_b16 v[134:135], v195 offset:1024
    ds_read_b128 v[160:163], v192 offset:0
    ds_read_b64_tr_b16 v[136:137], v196 offset:0
    ds_read_b64_tr_b16 v[138:139], v196 offset:1024
    ds_read_b64_tr_b16 v[140:141], v197 offset:0
    ds_read_b64_tr_b16 v[142:143], v197 offset:1024
    ds_read_b128 v[164:167], v192 offset:2048
    ds_read_b128 v[168:171], v192 offset:4096
    ds_read_b128 v[172:175], v192 offset:6144
    ds_read_b128 v[176:179], v192 offset:8192
    ds_read_b128 v[180:183], v192 offset:10240
    ds_read_b128 v[184:187], v192 offset:12288
    s_mov_b32 s92, 6
L_p1_v:
    s_waitcnt lgkmcnt(6)
    v_mfma_f32_16x16x32_bf16 v[0:3], v[160:163], v[128:131], v[0:3]
    v_mfma_f32_16x16x32_bf16 v[8:11], v[160:163], v[132:135], v[8:11]
    v_mfma_f32_16x16x32_bf16 v[16:19], v[160:163], v[136:139], v[16:19]
    v_mfma_f32_16x16x32_bf16 v[24:27], v[160:163], v[140:143], v[24:27]
    ds_read_b128 v[188:191], v192 offset:14336
    s_waitcnt lgkmcnt(6)
    v_mfma_f32_16x16x32_bf16 v[4:7], v[164:167], v[128:131], v[4:7]
    v_mfma_f32_16x16x32_bf16 v[12:15], v[164:167], v[132:135], v[12:15]
    v_mfma_f32_16x16x32_bf16 v[20:23], v[164:167], v[136:139], v[20:23]
    v_mfma_f32_16x16x32_bf16 v[28:31], v[164:167], v[140:143], v[28:31]
    ds_read_b64_tr_b16 v[144:145], v194 offset:8192
    s_waitcnt lgkmcnt(6)
    v_mfma_f32_16x16x32_bf16 v[32:35], v[168:171], v[128:131], v[32:35]
    ds_read_b64_tr_b16 v[146:147], v194 offset:9216
    v_mfma_f32_16x16x32_bf16 v[40:43], v[168:171], v[132:135], v[40:43]
    ds_read_b64_tr_b16 v[148:149], v195 offset:8192
    v_mfma_f32_16x16x32_bf16 v[48:51], v[168:171], v[136:139], v[48:51]
    ds_read_b64_tr_b16 v[150:151], v195 offset:9216
    v_mfma_f32_16x16x32_bf16 v[56:59], v[168:171], v[140:143], v[56:59]
    ds_read_b128 v[160:163], v193 offset:0
    s_waitcnt lgkmcnt(9)
    v_mfma_f32_16x16x32_bf16 v[36:39], v[172:175], v[128:131], v[36:39]
    ds_read_b64_tr_b16 v[152:153], v196 offset:8192
    v_mfma_f32_16x16x32_bf16 v[44:47], v[172:175], v[132:135], v[44:47]
    ds_read_b64_tr_b16 v[154:155], v196 offset:9216
    v_mfma_f32_16x16x32_bf16 v[52:55], v[172:175], v[136:139], v[52:55]
    ds_read_b64_tr_b16 v[156:157], v197 offset:8192
    v_mfma_f32_16x16x32_bf16 v[60:63], v[172:175], v[140:143], v[60:63]
    ds_read_b64_tr_b16 v[158:159], v197 offset:9216
    s_waitcnt lgkmcnt(12)
    v_mfma_f32_16x16x32_bf16 v[64:67], v[176:179], v[128:131], v[64:67]
    ds_read_b128 v[164:167], v193 offset:2048
    v_mfma_f32_16x16x32_bf16 v[72:75], v[176:179], v[132:135], v[72:75]
    ds_read_b128 v[168:171], v193 offset:4096
    v_mfma_f32_16x16x32_bf16 v[80:83], v[176:179], v[136:139], v[80:83]
    v_mfma_f32_16x16x32_bf16 v[88:91], v[176:179], v[140:143], v[88:91]
    ds_read_b128 v[172:175], v193 offset:6144
    s_waitcnt lgkmcnt(14)
    v_mfma_f32_16x16x32_bf16 v[68:71], v[180:183], v[128:131], v[68:71]
    v_mfma_f32_16x16x32_bf16 v[76:79], v[180:183], v[132:135], v[76:79]
    v_mfma_f32_16x16x32_bf16 v[84:87], v[180:183], v[136:139], v[84:87]
    v_mfma_f32_16x16x32_bf16 v[92:95], v[180:183], v[140:143], v[92:95]
    ds_read_b128 v[176:179], v193 offset:8192
    s_waitcnt lgkmcnt(14)
    v_mfma_f32_16x16x32_bf16 v[96:99], v[184:187], v[128:131], v[96:99]
    v_mfma_f32_16x16x32_bf16 v[104:107], v[184:187], v[132:135], v[104:107]
    v_mfma_f32_16x16x32_bf16 v[112:115], v[184:187], v[136:139], v[112:115]
    v_mfma_f32_16x16x32_bf16 v[120:123], v[184:187], v[140:143], v[120:123]
    ds_read_b128 v[180:183], v193 offset:10240
    s_waitcnt lgkmcnt(14)
    v_mfma_f32_16x16x32_bf16 v[100:103], v[188:191], v[128:131], v[100:103]
    v_mfma_f32_16x16x32_bf16 v[108:111], v[188:191], v[132:135], v[108:111]
    v_mfma_f32_16x16x32_bf16 v[116:119], v[188:191], v[136:139], v[116:119]
    v_mfma_f32_16x16x32_bf16 v[124:127], v[188:191], v[140:143], v[124:127]
    ds_read_b128 v[184:187], v193 offset:12288
    s_waitcnt lgkmcnt(6)
    v_mfma_f32_16x16x32_bf16 v[0:3], v[160:163], v[144:147], v[0:3]
    v_mfma_f32_16x16x32_bf16 v[8:11], v[160:163], v[148:151], v[8:11]
    v_mfma_f32_16x16x32_bf16 v[16:19], v[160:163], v[152:155], v[16:19]
    v_mfma_f32_16x16x32_bf16 v[24:27], v[160:163], v[156:159], v[24:27]
    ds_read_b128 v[188:191], v193 offset:14336
    s_waitcnt lgkmcnt(6)
    v_mfma_f32_16x16x32_bf16 v[4:7], v[164:167], v[144:147], v[4:7]
    v_mfma_f32_16x16x32_bf16 v[12:15], v[164:167], v[148:151], v[12:15]
    v_mfma_f32_16x16x32_bf16 v[20:23], v[164:167], v[152:155], v[20:23]
    v_mfma_f32_16x16x32_bf16 v[28:31], v[164:167], v[156:159], v[28:31]
    s_waitcnt lgkmcnt(0)
    s_waitcnt vmcnt(1)
    s_barrier
    s_cmp_eq_u32 s92, 6
    s_cbranch_scc1 L_lnsv
    L_lnsbv:
    s_add_u32 m0, s62, 0
    s_add_u32 s93, s60, 0
    buffer_load_dwordx4 v198, s[12:15], s93 offen lds
    s_add_u32 m0, s62, 1024
    s_add_u32 s93, s60, 8192
    buffer_load_dwordx4 v199, s[12:15], s93 offen lds
    s_add_u32 m0, s62, 2048
    s_add_u32 s93, s60, 16384
    buffer_load_dwordx4 v198, s[12:15], s93 offen lds
    s_add_u32 m0, s62, 3072
    s_add_u32 s93, s60, 24576
    buffer_load_dwordx4 v199, s[12:15], s93 offen lds
    s_add_u32 m0, s63, 0
    s_add_u32 s93, s61, 0
    buffer_load_dwordx4 v244, s[20:23], s93 offen lds
    s_add_u32 m0, s63, 1024
    s_add_u32 s93, s61, 32768
    buffer_load_dwordx4 v244, s[20:23], s93 offen lds
    s_add_u32 m0, s63, 2048
    s_add_u32 s93, s61, 65536
    buffer_load_dwordx4 v245, s[20:23], s93 offen lds
    s_add_u32 m0, s63, 3072
    s_add_u32 s93, s61, 98304
    buffer_load_dwordx4 v245, s[20:23], s93 offen lds
    s_add_u32 s60, s60, 128
    s_add_u32 s61, s61, 524288
    s_xor_b32 s62, s62, 0x10000
    s_xor_b32 s63, s63, 0x10000
    s_mov_b32 s57, s82
    s_bitcmp1_b32 s81, s92
    s_cbranch_scc1 L_postv
    L_postbv:
    buffer_load_dword v229, v230, s[64:67], s57 offen sc1
    v_xor_b32 v192, 0x10000, v192
    v_xor_b32 v193, 0x10000, v193
    v_xor_b32 v194, 0x10000, v194
    v_xor_b32 v195, 0x10000, v195
    v_xor_b32 v196, 0x10000, v196
    v_xor_b32 v197, 0x10000, v197
    v_mfma_f32_16x16x32_bf16 v[32:35], v[168:171], v[144:147], v[32:35]
    ds_read_b64_tr_b16 v[128:129], v194 offset:0
    v_mfma_f32_16x16x32_bf16 v[40:43], v[168:171], v[148:151], v[40:43]
    ds_read_b64_tr_b16 v[130:131], v194 offset:1024
    v_mfma_f32_16x16x32_bf16 v[48:51], v[168:171], v[152:155], v[48:51]
    ds_read_b64_tr_b16 v[132:133], v195 offset:0
    v_mfma_f32_16x16x32_bf16 v[56:59], v[168:171], v[156:159], v[56:59]
    ds_read_b64_tr_b16 v[134:135], v195 offset:1024
    v_mfma_f32_16x16x32_bf16 v[36:39], v[172:175], v[144:147], v[36:39]
    ds_read_b128 v[160:163], v192 offset:0
    v_mfma_f32_16x16x32_bf16 v[44:47], v[172:175], v[148:151], v[44:47]
    ds_read_b64_tr_b16 v[136:137], v196 offset:0
    v_mfma_f32_16x16x32_bf16 v[52:55], v[172:175], v[152:155], v[52:55]
    ds_read_b64_tr_b16 v[138:139], v196 offset:1024
    v_mfma_f32_16x16x32_bf16 v[60:63], v[172:175], v[156:159], v[60:63]
    ds_read_b64_tr_b16 v[140:141], v197 offset:0
    v_mfma_f32_16x16x32_bf16 v[64:67], v[176:179], v[144:147], v[64:67]
    ds_read_b64_tr_b16 v[142:143], v197 offset:1024
    v_mfma_f32_16x16x32_bf16 v[72:75], v[176:179], v[148:151], v[72:75]
    ds_read_b128 v[164:167], v192 offset:2048
    v_mfma_f32_16x16x32_bf16 v[80:83], v[176:179], v[152:155], v[80:83]
    ds_read_b128 v[168:171], v192 offset:4096
    v_mfma_f32_16x16x32_bf16 v[88:91], v[176:179], v[156:159], v[88:91]
    ds_read_b128 v[172:175], v192 offset:6144
    v_mfma_f32_16x16x32_bf16 v[68:71], v[180:183], v[144:147], v[68:71]
    v_mfma_f32_16x16x32_bf16 v[76:79], v[180:183], v[148:151], v[76:79]
    v_mfma_f32_16x16x32_bf16 v[84:87], v[180:183], v[152:155], v[84:87]
    v_mfma_f32_16x16x32_bf16 v[92:95], v[180:183], v[156:159], v[92:95]
    ds_read_b128 v[176:179], v192 offset:8192
    v_mfma_f32_16x16x32_bf16 v[96:99], v[184:187], v[144:147], v[96:99]
    v_mfma_f32_16x16x32_bf16 v[104:107], v[184:187], v[148:151], v[104:107]
    v_mfma_f32_16x16x32_bf16 v[112:115], v[184:187], v[152:155], v[112:115]
    v_mfma_f32_16x16x32_bf16 v[120:123], v[184:187], v[156:159], v[120:123]
    ds_read_b128 v[180:183], v192 offset:10240
    v_mfma_f32_16x16x32_bf16 v[100:103], v[188:191], v[144:147], v[100:103]
    v_mfma_f32_16x16x32_bf16 v[108:111], v[188:191], v[148:151], v[108:111]
    v_mfma_f32_16x16x32_bf16 v[116:119], v[188:191], v[152:155], v[116:119]
    v_mfma_f32_16x16x32_bf16 v[124:127], v[188:191], v[156:159], v[124:127]
    ds_read_b128 v[184:187], v192 offset:12288
    s_sub_u32 s92, s92, 1
    s_cmp_lg_u32 s92, 0
    s_cbranch_scc1 L_p1_v
    s_waitcnt lgkmcnt(6)
    v_mfma_f32_16x16x32_bf16 v[0:3], v[160:163], v[128:131], v[0:3]
    v_mfma_f32_16x16x32_bf16 v[8:11], v[160:163], v[132:135], v[8:11]
    v_mfma_f32_16x16x32_bf16 v[16:19], v[160:163], v[136:139], v[16:19]
    v_mfma_f32_16x16x32_bf16 v[24:27], v[160:163], v[140:143], v[24:27]
    ds_read_b128 v[188:191], v192 offset:14336
    s_waitcnt lgkmcnt(6)
    v_mfma_f32_16x16x32_bf16 v[4:7], v[164:167], v[128:131], v[4:7]
    v_mfma_f32_16x16x32_bf16 v[12:15], v[164:167], v[132:135], v[12:15]
    v_mfma_f32_16x16x32_bf16 v[20:23], v[164:167], v[136:139], v[20:23]
    v_mfma_f32_16x16x32_bf16 v[28:31], v[164:167], v[140:143], v[28:31]
    ds_read_b64_tr_b16 v[144:145], v194 offset:8192
    s_waitcnt lgkmcnt(6)
    v_mfma_f32_16x16x32_bf16 v[32:35], v[168:171], v[128:131], v[32:35]
    ds_read_b64_tr_b16 v[146:147], v194 offset:9216
    v_mfma_f32_16x16x32_bf16 v[40:43], v[168:171], v[132:135], v[40:43]
    ds_read_b64_tr_b16 v[148:149], v195 offset:8192
    v_mfma_f32_16x16x32_bf16 v[48:51], v[168:171], v[136:139], v[48:51]
    ds_read_b64_tr_b16 v[150:151], v195 offset:9216
    v_mfma_f32_16x16x32_bf16 v[56:59], v[168:171], v[140:143], v[56:59]
    ds_read_b128 v[160:163], v193 offset:0
    s_waitcnt lgkmcnt(9)
    v_mfma_f32_16x16x32_bf16 v[36:39], v[172:175], v[128:131], v[36:39]
    ds_read_b64_tr_b16 v[152:153], v196 offset:8192
    v_mfma_f32_16x16x32_bf16 v[44:47], v[172:175], v[132:135], v[44:47]
    ds_read_b64_tr_b16 v[154:155], v196 offset:9216
    v_mfma_f32_16x16x32_bf16 v[52:55], v[172:175], v[136:139], v[52:55]
    ds_read_b64_tr_b16 v[156:157], v197 offset:8192
    v_mfma_f32_16x16x32_bf16 v[60:63], v[172:175], v[140:143], v[60:63]
    ds_read_b64_tr_b16 v[158:159], v197 offset:9216
    s_waitcnt lgkmcnt(12)
    v_mfma_f32_16x16x32_bf16 v[64:67], v[176:179], v[128:131], v[64:67]
    ds_read_b128 v[164:167], v193 offset:2048
    v_mfma_f32_16x16x32_bf16 v[72:75], v[176:179], v[132:135], v[72:75]
    ds_read_b128 v[168:171], v193 offset:4096
    v_mfma_f32_16x16x32_bf16 v[80:83], v[176:179], v[136:139], v[80:83]
    v_mfma_f32_16x16x32_bf16 v[88:91], v[176:179], v[140:143], v[88:91]
    ds_read_b128 v[172:175], v193 offset:6144
    s_waitcnt lgkmcnt(14)
    v_mfma_f32_16x16x32_bf16 v[68:71], v[180:183], v[128:131], v[68:71]
    v_mfma_f32_16x16x32_bf16 v[76:79], v[180:183], v[132:135], v[76:79]
    v_mfma_f32_16x16x32_bf16 v[84:87], v[180:183], v[136:139], v[84:87]
    v_mfma_f32_16x16x32_bf16 v[92:95], v[180:183], v[140:143], v[92:95]
    ds_read_b128 v[176:179], v193 offset:8192
    s_waitcnt lgkmcnt(14)
    v_mfma_f32_16x16x32_bf16 v[96:99], v[184:187], v[128:131], v[96:99]
    v_mfma_f32_16x16x32_bf16 v[104:107], v[184:187], v[132:135], v[104:107]
    v_mfma_f32_16x16x32_bf16 v[112:115], v[184:187], v[136:139], v[112:115]
    v_mfma_f32_16x16x32_bf16 v[120:123], v[184:187], v[140:143], v[120:123]
    ds_read_b128 v[180:183], v193 offset:10240
    s_waitcnt lgkmcnt(14)
    v_mfma_f32_16x16x32_bf16 v[100:103], v[188:191], v[128:131], v[100:103]
    v_mfma_f32_16x16x32_bf16 v[108:111], v[188:191], v[132:135], v[108:111]
    v_mfma_f32_16x16x32_bf16 v[116:119], v[188:191], v[136:139], v[116:119]
    v_mfma_f32_16x16x32_bf16 v[124:127], v[188:191], v[140:143], v[124:127]
    ds_read_b128 v[184:187], v193 offset:12288
    s_waitcnt lgkmcnt(6)
    v_mfma_f32_16x16x32_bf16 v[0:3], v[160:163], v[144:147], v[0:3]
    v_mfma_f32_16x16x32_bf16 v[8:11], v[160:163], v[148:151], v[8:11]
    v_mfma_f32_16x16x32_bf16 v[16:19], v[160:163], v[152:155], v[16:19]
    v_mfma_f32_16x16x32_bf16 v[24:27], v[160:163], v[156:159], v[24:27]
    ds_read_b128 v[188:191], v193 offset:14336
    s_waitcnt lgkmcnt(6)
    v_mfma_f32_16x16x32_bf16 v[4:7], v[164:167], v[144:147], v[4:7]
    v_mfma_f32_16x16x32_bf16 v[12:15], v[164:167], v[148:151], v[12:15]
    v_mfma_f32_16x16x32_bf16 v[20:23], v[164:167], v[152:155], v[20:23]
    v_mfma_f32_16x16x32_bf16 v[28:31], v[164:167], v[156:159], v[28:31]
    s_waitcnt lgkmcnt(0)
    s_waitcnt vmcnt(1)
    s_barrier
    s_add_u32 m0, s70, 0
    s_add_u32 s93, s89, 0
    buffer_load_dwordx4 v244, s[16:19], s93 offen lds
    s_add_u32 m0, s70, 1024
    s_add_u32 s93, s89, 32768
    buffer_load_dwordx4 v244, s[16:19], s93 offen lds
    s_add_u32 m0, s70, 2048
    s_add_u32 s93, s89, 65536
    buffer_load_dwordx4 v245, s[16:19], s93 offen lds
    s_add_u32 m0, s70, 3072
    s_add_u32 s93, s89, 98304
    buffer_load_dwordx4 v245, s[16:19], s93 offen lds
    s_add_u32 m0, s85, 32768
    s_add_u32 s93, s88, 0
    buffer_load_dwordx4 v246, s[28:31], s93 offen lds
    s_add_u32 m0, s85, 33792
    s_add_u32 s93, s88, 22016
    buffer_load_dwordx4 v247, s[28:31], s93 offen lds
    v_xor_b32 v192, 0x10000, v192
    v_xor_b32 v193, 0x10000, v193
    v_xor_b32 v194, 0x10000, v194
    v_xor_b32 v195, 0x10000, v195
    v_xor_b32 v196, 0x10000, v196
    v_xor_b32 v197, 0x10000, v197
    v_mfma_f32_16x16x32_bf16 v[32:35], v[168:171], v[144:147], v[32:35]
    ds_read_b64_tr_b16 v[128:129], v194 offset:0
    v_mfma_f32_16x16x32_bf16 v[40:43], v[168:171], v[148:151], v[40:43]
    ds_read_b64_tr_b16 v[130:131], v194 offset:1024
    v_mfma_f32_16x16x32_bf16 v[48:51], v[168:171], v[152:155], v[48:51]
    ds_read_b64_tr_b16 v[132:133], v195 offset:0
    v_mfma_f32_16x16x32_bf16 v[56:59], v[168:171], v[156:159], v[56:59]
    ds_read_b64_tr_b16 v[134:135], v195 offset:1024
    v_mfma_f32_16x16x32_bf16 v[36:39], v[172:175], v[144:147], v[36:39]
    ds_read_b128 v[160:163], v192 offset:0
    v_mfma_f32_16x16x32_bf16 v[44:47], v[172:175], v[148:151], v[44:47]
    ds_read_b64_tr_b16 v[136:137], v196 offset:0
    v_mfma_f32_16x16x32_bf16 v[52:55], v[172:175], v[152:155], v[52:55]
    ds_read_b64_tr_b16 v[138:139], v196 offset:1024
    v_mfma_f32_16x16x32_bf16 v[60:63], v[172:175], v[156:159], v[60:63]
    ds_read_b64_tr_b16 v[140:141], v197 offset:0
    v_mfma_f32_16x16x32_bf16 v[64:67], v[176:179], v[144:147], v[64:67]
    ds_read_b64_tr_b16 v[142:143], v197 offset:1024
    v_mfma_f32_16x16x32_bf16 v[72:75], v[176:179], v[148:151], v[72:75]
    ds_read_b128 v[164:167], v192 offset:2048
    v_mfma_f32_16x16x32_bf16 v[80:83], v[176:179], v[152:155], v[80:83]
    ds_read_b128 v[168:171], v192 offset:4096
    v_mfma_f32_16x16x32_bf16 v[88:91], v[176:179], v[156:159], v[88:91]
    ds_read_b128 v[172:175], v192 offset:6144
    v_mfma_f32_16x16x32_bf16 v[68:71], v[180:183], v[144:147], v[68:71]
    v_mfma_f32_16x16x32_bf16 v[76:79], v[180:183], v[148:151], v[76:79]
    v_mfma_f32_16x16x32_bf16 v[84:87], v[180:183], v[152:155], v[84:87]
    v_mfma_f32_16x16x32_bf16 v[92:95], v[180:183], v[156:159], v[92:95]
    ds_read_b128 v[176:179], v192 offset:8192
    v_mfma_f32_16x16x32_bf16 v[96:99], v[184:187], v[144:147], v[96:99]
    v_mfma_f32_16x16x32_bf16 v[104:107], v[184:187], v[148:151], v[104:107]
    v_mfma_f32_16x16x32_bf16 v[112:115], v[184:187], v[152:155], v[112:115]
    v_mfma_f32_16x16x32_bf16 v[120:123], v[184:187], v[156:159], v[120:123]
    ds_read_b128 v[180:183], v192 offset:10240
    v_mfma_f32_16x16x32_bf16 v[100:103], v[188:191], v[144:147], v[100:103]
    v_mfma_f32_16x16x32_bf16 v[108:111], v[188:191], v[148:151], v[108:111]
    v_mfma_f32_16x16x32_bf16 v[116:119], v[188:191], v[152:155], v[116:119]
    v_mfma_f32_16x16x32_bf16 v[124:127], v[188:191], v[156:159], v[124:127]
    ds_read_b128 v[184:187], v192 offset:12288
    s_waitcnt lgkmcnt(6)
    v_mfma_f32_16x16x32_bf16 v[0:3], v[160:163], v[128:131], v[0:3]
    v_mfma_f32_16x16x32_bf16 v[8:11], v[160:163], v[132:135], v[8:11]
    v_mfma_f32_16x16x32_bf16 v[16:19], v[160:163], v[136:139], v[16:19]
    s_add_u32 s93, s87, 0
    buffer_load_dwordx4 v[200:203], v254, s[52:55], s93 offen offset:0 sc1
    v_mfma_f32_16x16x32_bf16 v[24:27], v[160:163], v[140:143], v[24:27]
    ds_read_b128 v[188:191], v192 offset:14336
    s_waitcnt lgkmcnt(6)
    v_mfma_f32_16x16x32_bf16 v[4:7], v[164:167], v[128:131], v[4:7]
    v_mfma_f32_16x16x32_bf16 v[12:15], v[164:167], v[132:135], v[12:15]
    s_add_u32 s93, s87, 16384
    buffer_load_dwordx4 v[204:207], v254, s[52:55], s93 offen offset:0 sc1
    v_mfma_f32_16x16x32_bf16 v[20:23], v[164:167], v[136:139], v[20:23]
    v_mfma_f32_16x16x32_bf16 v[28:31], v[164:167], v[140:143], v[28:31]
    ds_read_b64_tr_b16 v[144:145], v194 offset:8192
    s_waitcnt lgkmcnt(6)
    v_mfma_f32_16x16x32_bf16 v[32:35], v[168:171], v[128:131], v[32:35]
    ds_read_b64_tr_b16 v[146:147], v194 offset:9216
    s_add_u32 s93, s87, 0
    buffer_load_dwordx4 v[208:211], v254, s[52:55], s93 offen offset:1024 sc1
    v_mfma_f32_16x16x32_bf16 v[40:43], v[168:171], v[132:135], v[40:43]
    ds_read_b64_tr_b16 v[148:149], v195 offset:8192
    v_mfma_f32_16x16x32_bf16 v[48:51], v[168:171], v[136:139], v[48:51]
    ds_read_b64_tr_b16 v[150:151], v195 offset:9216
    v_mfma_f32_16x16x32_bf16 v[56:59], v[168:171], v[140:143], v[56:59]
    ds_read_b128 v[160:163], v193 offset:0
    s_add_u32 s93, s87, 16384
    buffer_load_dwordx4 v[212:215], v254, s[52:55], s93 offen offset:1024 sc1
    s_waitcnt lgkmcnt(9)
    v_mfma_f32_16x16x32_bf16 v[36:39], v[172:175], v[128:131], v[36:39]
    ds_read_b64_tr_b16 v[152:153], v196 offset:8192
    v_mfma_f32_16x16x32_bf16 v[44:47], v[172:175], v[132:135], v[44:47]
    ds_read_b64_tr_b16 v[154:155], v196 offset:9216
    v_mfma_f32_16x16x32_bf16 v[52:55], v[172:175], v[136:139], v[52:55]
    ds_read_b64_tr_b16 v[156:157], v197 offset:8192
    s_add_u32 s93, s87, 0
    buffer_load_dwordx4 v[216:219], v254, s[52:55], s93 offen offset:2048 sc1
    v_mfma_f32_16x16x32_bf16 v[60:63], v[172:175], v[140:143], v[60:63]
    ds_read_b64_tr_b16 v[158:159], v197 offset:9216
    s_waitcnt lgkmcnt(12)
    v_mfma_f32_16x16x32_bf16 v[64:67], v[176:179], v[128:131], v[64:67]
    ds_read_b128 v[164:167], v193 offset:2048
    v_mfma_f32_16x16x32_bf16 v[72:75], v[176:179], v[132:135], v[72:75]
    ds_read_b128 v[168:171], v193 offset:4096
    s_add_u32 s93, s87, 16384
    buffer_load_dwordx4 v[220:223], v254, s[52:55], s93 offen offset:2048 sc1
    v_mfma_f32_16x16x32_bf16 v[80:83], v[176:179], v[136:139], v[80:83]
    v_mfma_f32_16x16x32_bf16 v[88:91], v[176:179], v[140:143], v[88:91]
    ds_read_b128 v[172:175], v193 offset:6144
    s_waitcnt lgkmcnt(14)
    v_mfma_f32_16x16x32_bf16 v[68:71], v[180:183], v[128:131], v[68:71]
    s_add_u32 s93, s87, 0
    buffer_load_dwordx4 v[224:227], v254, s[52:55], s93 offen offset:3072 sc1
    v_mfma_f32_16x16x32_bf16 v[76:79], v[180:183], v[132:135], v[76:79]
    v_mfma_f32_16x16x32_bf16 v[84:87], v[180:183], v[136:139], v[84:87]
    v_mfma_f32_16x16x32_bf16 v[92:95], v[180:183], v[140:143], v[92:95]
    ds_read_b128 v[176:179], v193 offset:8192
    s_add_u32 s93, s87, 16384
    buffer_load_dwordx4 v[228:231], v254, s[52:55], s93 offen offset:3072 sc1
    s_waitcnt lgkmcnt(14)
    v_mfma_f32_16x16x32_bf16 v[96:99], v[184:187], v[128:131], v[96:99]
    v_mfma_f32_16x16x32_bf16 v[104:107], v[184:187], v[132:135], v[104:107]
    v_mfma_f32_16x16x32_bf16 v[112:115], v[184:187], v[136:139], v[112:115]
    s_add_u32 s93, s87, 4096
    buffer_load_dwordx4 v[232:235], v254, s[52:55], s93 offen offset:0 sc1
    v_mfma_f32_16x16x32_bf16 v[120:123], v[184:187], v[140:143], v[120:123]
    ds_read_b128 v[180:183], v193 offset:10240
    s_waitcnt lgkmcnt(14)
    v_mfma_f32_16x16x32_bf16 v[100:103], v[188:191], v[128:131], v[100:103]
    v_mfma_f32_16x16x32_bf16 v[108:111], v[188:191], v[132:135], v[108:111]
    s_add_u32 s93, s87, 20480
    buffer_load_dwordx4 v[236:239], v254, s[52:55], s93 offen offset:0 sc1
    v_mfma_f32_16x16x32_bf16 v[116:119], v[188:191], v[136:139], v[116:119]
    v_mfma_f32_16x16x32_bf16 v[124:127], v[188:191], v[140:143], v[124:127]
    ds_read_b128 v[184:187], v193 offset:12288
    s_waitcnt lgkmcnt(6)
    v_mfma_f32_16x16x32_bf16 v[0:3], v[160:163], v[144:147], v[0:3]
    v_mfma_f32_16x16x32_bf16 v[8:11], v[160:163], v[148:151], v[8:11]
    v_mfma_f32_16x16x32_bf16 v[16:19], v[160:163], v[152:155], v[16:19]
    v_mfma_f32_16x16x32_bf16 v[24:27], v[160:163], v[156:159], v[24:27]
    ds_read_b128 v[188:191], v193 offset:14336
    s_waitcnt lgkmcnt(6)
    v_mfma_f32_16x16x32_bf16 v[4:7], v[164:167], v[144:147], v[4:7]
    v_mfma_f32_16x16x32_bf16 v[12:15], v[164:167], v[148:151], v[12:15]
    v_mfma_f32_16x16x32_bf16 v[20:23], v[164:167], v[152:155], v[20:23]
    v_mfma_f32_16x16x32_bf16 v[28:31], v[164:167], v[156:159], v[28:31]
    s_waitcnt lgkmcnt(5)
    v_mfma_f32_16x16x32_bf16 v[32:35], v[168:171], v[144:147], v[32:35]
    v_mfma_f32_16x16x32_bf16 v[40:43], v[168:171], v[148:151], v[40:43]
    v_mfma_f32_16x16x32_bf16 v[48:51], v[168:171], v[152:155], v[48:51]
    v_mfma_f32_16x16x32_bf16 v[56:59], v[168:171], v[156:159], v[56:59]
    s_waitcnt lgkmcnt(0)
    s_waitcnt vmcnt(0)
    s_barrier
    s_add_u32 m0, s70, 65536
    s_add_u32 s93, s89, 1048576
    buffer_load_dwordx4 v244, s[16:19], s93 offen lds
    s_add_u32 m0, s70, 66560
    s_add_u32 s93, s89, 1081344
    buffer_load_dwordx4 v244, s[16:19], s93 offen lds
    s_add_u32 m0, s70, 67584
    s_add_u32 s93, s89, 1114112
    buffer_load_dwordx4 v245, s[16:19], s93 offen lds
    s_add_u32 m0, s70, 68608
    s_add_u32 s93, s89, 1146880
    buffer_load_dwordx4 v245, s[16:19], s93 offen lds
    s_add_u32 m0, s85, 98304
    s_add_u32 s93, s88, 352256
    buffer_load_dwordx4 v246, s[28:31], s93 offen lds
    s_add_u32 m0, s85, 99328
    s_add_u32 s93, s88, 374272
    buffer_load_dwordx4 v247, s[28:31], s93 offen lds
    v_mfma_f32_16x16x32_bf16 v[36:39], v[172:175], v[144:147], v[36:39]
    v_mfma_f32_16x16x32_bf16 v[44:47], v[172:175], v[148:151], v[44:47]
    v_mfma_f32_16x16x32_bf16 v[52:55], v[172:175], v[152:155], v[52:55]
    v_mfma_f32_16x16x32_bf16 v[60:63], v[172:175], v[156:159], v[60:63]
    v_mfma_f32_16x16x32_bf16 v[64:67], v[176:179], v[144:147], v[64:67]
    v_mfma_f32_16x16x32_bf16 v[72:75], v[176:179], v[148:151], v[72:75]
    v_mfma_f32_16x16x32_bf16 v[80:83], v[176:179], v[152:155], v[80:83]
    v_mfma_f32_16x16x32_bf16 v[88:91], v[176:179], v[156:159], v[88:91]
    v_mfma_f32_16x16x32_bf16 v[68:71], v[180:183], v[144:147], v[68:71]
    v_mfma_f32_16x16x32_bf16 v[76:79], v[180:183], v[148:151], v[76:79]
    v_mfma_f32_16x16x32_bf16 v[84:87], v[180:183], v[152:155], v[84:87]
    v_mfma_f32_16x16x32_bf16 v[92:95], v[180:183], v[156:159], v[92:95]
    v_mfma_f32_16x16x32_bf16 v[96:99], v[184:187], v[144:147], v[96:99]
    v_mfma_f32_16x16x32_bf16 v[104:107], v[184:187], v[148:151], v[104:107]
    v_mfma_f32_16x16x32_bf16 v[112:115], v[184:187], v[152:155], v[112:115]
    v_mfma_f32_16x16x32_bf16 v[120:123], v[184:187], v[156:159], v[120:123]
    v_mfma_f32_16x16x32_bf16 v[100:103], v[188:191], v[144:147], v[100:103]
    v_mfma_f32_16x16x32_bf16 v[108:111], v[188:191], v[148:151], v[108:111]
    v_mfma_f32_16x16x32_bf16 v[116:119], v[188:191], v[152:155], v[116:119]
    v_mfma_f32_16x16x32_bf16 v[124:127], v[188:191], v[156:159], v[124:127]
    s_branch L_p1_done
    L_postv:
    s_cmp_lg_u32 s92, s83
    s_cbranch_scc1 L_q1v
    s_lshr_b32 s57, s2, 3
    s_lshl_b32 s57, s57, 16
    s_lshl_b32 s58, s3, 13
    s_add_u32 s57, s57, s58
    s_mov_b32 s64, s52
    s_mov_b32 s65, s53
    s_mov_b32 s66, s54
    v_mov_b32 v230, v232
    s_branch L_postbv
    L_q1v:
    s_and_b32 s57, s3, 3
    s_cmp_lg_u32 s57, 2
    s_cbranch_scc1 L_q0v
    s_sub_u32 s57, 8, s92
    s_lshl_b32 s57, s57, 20
    s_lshl_b32 s58, s5, 16
    s_add_u32 s57, s57, s58
    s_lshl_b32 s58, s4, 8
    s_add_u32 s57, s57, s58
    s_mov_b32 s64, s20
    s_mov_b32 s65, s21
    s_mov_b32 s66, s22
    v_mov_b32 v230, v241
    s_branch L_postbv
    L_q0v:
    s_cmp_lg_u32 s3, 4
    s_cbranch_scc1 L_q2v
    s_lshl_b32 s57, s5, 2
    s_and_b32 s58, s4, 3
    s_add_u32 s57, s57, s58
    s_lshl_b32 s57, s57, 16
    s_sub_u32 s58, 9, s92
    s_lshl_b32 s58, s58, 7
    s_add_u32 s57, s57, s58
    s_mov_b32 s64, s12
    s_mov_b32 s65, s13
    s_mov_b32 s66, s14
    v_mov_b32 v230, v233
    s_branch L_postbv
    L_q2v:
    s_cmp_eq_u32 s92, 3
    s_cbranch_scc1 L_q3v
    s_and_b32 s57, s92, 1
    s_lshl_b32 s57, s57, 21
    s_lshl_b32 s58, s5, 16
    s_add_u32 s57, s57, s58
    s_lshl_b32 s58, s4, 8
    s_add_u32 s57, s57, s58
    s_mov_b32 s64, s16
    s_mov_b32 s65, s17
    s_mov_b32 s66, s18
    v_mov_b32 v230, v234
    s_branch L_postbv
    L_q3v:
    s_lshl_b32 s57, s2, 13
    s_mov_b32 s64, s28
    s_mov_b32 s65, s29
    s_mov_b32 s66, s30
    v_mov_b32 v230, v232
    s_branch L_postbv
    L_lnsv:
    ds_read_b128 v[200:203], v235
    s_lshl_b32 s57, s6, 3
    s_add_u32 s57, s57, s3
    s_lshl_b32 s57, s57, 3
    s_add_u32 s57, s57, 2097152
    s_mov_b64 s[72:73], exec
    s_mov_b64 exec, 1
    buffer_store_dwordx2 v[226:227], v255, s[52:55], s57 offen sc1
    s_mov_b64 exec, s[72:73]
    s_waitcnt lgkmcnt(0)
    buffer_store_dwordx4 v[200:203], v240, s[52:55], s7 offen sc1
    s_branch L_lnsbv
    L_cs1:
    v_mfma_f32_16x16x32_bf16 v[124:127], v[116:119], v[248:251], v[124:127]
    s_branch L_cb1
    L_cs2:
    v_mfma_f32_16x16x32_bf16 v[124:127], v[120:123], v[248:251], v[124:127]
    s_branch L_cb2
    L_cs3:
    v_mfma_f32_16x16x32_bf16 v[124:127], v[104:107], v[248:251], v[124:127]
    s_branch L_cb3
    L_cs4:
    v_mfma_f32_16x16x32_bf16 v[124:127], v[108:111], v[248:251], v[124:127]
    s_branch L_cb4
    L_cs5:
    v_mfma_f32_16x16x32_bf16 v[124:127], v[104:107], v[248:251], v[124:127]
    s_branch L_cb5
    L_cs6:
    v_mfma_f32_16x16x32_bf16 v[124:127], v[108:111], v[248:251], v[124:127]
    s_branch L_cb6
    L_cs7:
    v_mfma_f32_16x16x32_bf16 v[124:127], v[112:115], v[248:251], v[124:127]
    s_branch L_cb7
    L_cs8:
    v_mfma_f32_16x16x32_bf16 v[124:127], v[116:119], v[248:251], v[124:127]
    s_branch L_cb8
    L_cs9:
    v_mfma_f32_16x16x32_bf16 v[124:127], v[112:115], v[248:251], v[124:127]
    s_branch L_cb9
    L_cs10:
    v_mfma_f32_16x16x32_bf16 v[124:127], v[116:119], v[248:251], v[124:127]
    s_branch L_cb10
    L_cs11:
    v_mfma_f32_16x16x32_bf16 v[124:127], v[120:123], v[248:251], v[124:127]
    s_branch L_cb11
    L_cs12:
    v_mfma_f32_16x16x32_bf16 v[124:127], v[104:107], v[248:251], v[124:127]
    s_branch L_cb12
    L_cs13:
    v_mfma_f32_16x16x32_bf16 v[124:127], v[120:123], v[248:251], v[124:127]
    s_branch L_cb13
    L_cs14:
    v_mfma_f32_16x16x32_bf16 v[124:127], v[104:107], v[248:251], v[124:127]
    s_branch L_cb14
    L_cs15:
    v_mfma_f32_16x16x32_bf16 v[124:127], v[108:111], v[248:251], v[124:127]
    s_branch L_cb15
    L_cs16:
    v_mfma_f32_16x16x32_bf16 v[124:127], v[112:115], v[248:251], v[124:127]
    s_branch L_cb16
    L_cs18:
    v_mfma_f32_16x16x32_bf16 v[124:127], v[108:111], v[248:251], v[124:127]
    s_branch L_cb18
    L_cs19:
    v_mfma_f32_16x16x32_bf16 v[124:127], v[112:115], v[248:251], v[124:127]
    s_branch L_cb19
    L_cs20:
    v_mfma_f32_16x16x32_bf16 v[124:127], v[116:119], v[248:251], v[124:127]
    s_branch L_cb20
    L_cs21:
    v_mfma_f32_16x16x32_bf16 v[124:127], v[120:123], v[248:251], v[124:127]
    s_branch L_cb21
    L_cs22:
    v_mfma_f32_16x16x32_bf16 v[124:127], v[116:119], v[248:251], v[124:127]
    s_branch L_cb22
    L_cs23:
    v_mfma_f32_16x16x32_bf16 v[124:127], v[120:123], v[248:251], v[124:127]
    s_branch L_cb23
    L_cs24:
    v_mfma_f32_16x16x32_bf16 v[124:127], v[104:107], v[248:251], v[124:127]
    s_branch L_cb24
    L_cs25:
    v_mfma_f32_16x16x32_bf16 v[124:127], v[108:111], v[248:251], v[124:127]
    s_branch L_cb25
    L_cs26:
    v_mfma_f32_16x16x32_bf16 v[124:127], v[104:107], v[248:251], v[124:127]
    s_branch L_cb26
    L_cs27:
    v_mfma_f32_16x16x32_bf16 v[124:127], v[108:111], v[248:251], v[124:127]
    s_branch L_cb27
    L_cs28:
    v_mfma_f32_16x16x32_bf16 v[124:127], v[112:115], v[248:251], v[124:127]
    s_branch L_cb28
    L_cs29:
    v_mfma_f32_16x16x32_bf16 v[124:127], v[116:119], v[248:251], v[124:127]
    s_branch L_cb29
    L_cs30:
    v_mfma_f32_16x16x32_bf16 v[124:127], v[112:115], v[248:251], v[124:127]
    s_branch L_cb30
    L_cs31:
    v_mfma_f32_16x16x32_bf16 v[124:127], v[116:119], v[248:251], v[124:127]
    s_branch L_cb31
    L_cs32:
    v_mfma_f32_16x16x32_bf16 v[124:127], v[120:123], v[248:251], v[124:127]
    s_branch L_cb32
    L_cs33:
    v_mfma_f32_16x16x32_bf16 v[124:127], v[104:107], v[248:251], v[124:127]
    s_branch L_cb33
    L_cs35:
    v_mfma_f32_16x16x32_bf16 v[124:127], v[120:123], v[248:251], v[124:127]
    s_branch L_cb35
    L_cs36:
    v_mfma_f32_16x16x32_bf16 v[124:127], v[104:107], v[248:251], v[124:127]
    s_branch L_cb36
    L_cs37:
    v_mfma_f32_16x16x32_bf16 v[124:127], v[108:111], v[248:251], v[124:127]
    s_branch L_cb37
    L_cs38:
    v_mfma_f32_16x16x32_bf16 v[124:127], v[112:115], v[248:251], v[124:127]
    s_branch L_cb38
    L_cs39:
    v_mfma_f32_16x16x32_bf16 v[124:127], v[108:111], v[248:251], v[124:127]
    s_branch L_cb39
    L_cs40:
    v_mfma_f32_16x16x32_bf16 v[124:127], v[112:115], v[248:251], v[124:127]
    s_branch L_cb40
    L_cs41:
    v_mfma_f32_16x16x32_bf16 v[124:127], v[116:119], v[248:251], v[124:127]
    s_branch L_cb41
    L_cs42:
    v_mfma_f32_16x16x32_bf16 v[124:127], v[120:123], v[248:251], v[124:127]
    s_branch L_cb42
    L_cs43:
    v_mfma_f32_16x16x32_bf16 v[124:127], v[116:119], v[248:251], v[124:127]
    s_branch L_cb43
    L_cs44:
    v_mfma_f32_16x16x32_bf16 v[124:127], v[120:123], v[248:251], v[124:127]
    s_branch L_cb44
    L_cs45:
    v_mfma_f32_16x16x32_bf16 v[124:127], v[104:107], v[248:251], v[124:127]
    s_branch L_cb45
    L_cs46:
    v_mfma_f32_16x16x32_bf16 v[124:127], v[108:111], v[248:251], v[124:127]
    s_branch L_cb46
    L_cs47:
    v_mfma_f32_16x16x32_bf16 v[124:127], v[104:107], v[248:251], v[124:127]
    s_branch L_cb47
    L_cs48:
    v_mfma_f32_16x16x32_bf16 v[124:127], v[108:111], v[248:251], v[124:127]
    s_branch L_cb48
    L_cs49:
    v_mfma_f32_16x16x32_bf16 v[124:127], v[112:115], v[248:251], v[124:127]
    s_branch L_cb49
    L_cs50:
    v_mfma_f32_16x16x32_bf16 v[124:127], v[116:119], v[248:251], v[124:127]
    s_branch L_cb50
    L_cs52:
    v_mfma_f32_16x16x32_bf16 v[124:127], v[112:115], v[248:251], v[124:127]
    s_branch L_cb52
    L_cs53:
    v_mfma_f32_16x16x32_bf16 v[124:127], v[116:119], v[248:251], v[124:127]
    s_branch L_cb53
    L_cs54:
    v_mfma_f32_16x16x32_bf16 v[124:127], v[120:123], v[248:251], v[124:127]
    s_branch L_cb54
    L_cs55:
    v_mfma_f32_16x16x32_bf16 v[124:127], v[104:107], v[248:251], v[124:127]
    s_branch L_cb55
    L_cs56:
    v_mfma_f32_16x16x32_bf16 v[124:127], v[120:123], v[248:251], v[124:127]
    s_branch L_cb56
    L_cs57:
    v_mfma_f32_16x16x32_bf16 v[124:127], v[104:107], v[248:251], v[124:127]
    s_branch L_cb57
    L_cs58:
    v_mfma_f32_16x16x32_bf16 v[124:127], v[108:111], v[248:251], v[124:127]
    s_branch L_cb58
    L_cs59:
    v_mfma_f32_16x16x32_bf16 v[124:127], v[112:115], v[248:251], v[124:127]
    s_branch L_cb59
    L_cs60:
    v_mfma_f32_16x16x32_bf16 v[124:127], v[108:111], v[248:251], v[124:127]
    s_branch L_cb60
    L_cs61:
    v_mfma_f32_16x16x32_bf16 v[124:127], v[112:115], v[248:251], v[124:127]
    s_branch L_cb61
    L_cs62:
    v_mfma_f32_16x16x32_bf16 v[124:127], v[116:119], v[248:251], v[124:127]
    s_branch L_cb62
    L_cs63:
    v_mfma_f32_16x16x32_bf16 v[124:127], v[120:123], v[248:251], v[124:127]
    s_branch L_cb63
    L_cs64:
    v_mfma_f32_16x16x32_bf16 v[124:127], v[104:107], v[248:251], v[124:127]
    s_branch L_cb64
    L_cs65:
    v_mfma_f32_16x16x32_bf16 v[124:127], v[108:111], v[248:251], v[124:127]
    s_branch L_cb65
    L_cs66:
    v_mfma_f32_16x16x32_bf16 v[124:127], v[112:115], v[248:251], v[124:127]
    s_branch L_cb66
    L_cs67:
    v_mfma_f32_16x16x32_bf16 v[124:127], v[116:119], v[248:251], v[124:127]
    s_branch L_cb67
L_p1_done:
    s_lshl_b32 s64, s4, 19
    s_lshl_b32 s93, s5, 16
    s_add_u32 s64, s64, s93
    s_and_b32 s93, s3, 1
    s_lshl_b32 s93, s93, 15
    s_add_u32 s64, s64, s93
    s_bfe_u32 s66, s3, 0x10001
    s_lshl_b32 s67, s66, 12
    s_lshl_b32 s66, s66, 11
    s_add_u32 s66, s66, 4194304
    s_add_u32 s67, s67, 20971520
    s_cmp_lt_u32 s3, 4
    s_cselect_b32 s66, s66, s67
    s_cselect_b32 s65, 2, 1
    s_lshl_b32 s65, s65, 11
    s_add_u32 s64, s64, s66
    s_add_u32 s65, s65, s64
    v_cvt_pk_bf16_f32 v0, v0, v1
    v_cvt_pk_bf16_f32 v1, v2, v3
    v_cvt_pk_bf16_f32 v2, v4, v5
    v_cvt_pk_bf16_f32 v3, v6, v7
    v_cvt_pk_bf16_f32 v4, v8, v9
    v_cvt_pk_bf16_f32 v5, v10, v11
    v_cvt_pk_bf16_f32 v6, v12, v13
    v_cvt_pk_bf16_f32 v7, v14, v15
    v_cvt_pk_bf16_f32 v8, v16, v17
    v_cvt_pk_bf16_f32 v9, v18, v19
    v_cvt_pk_bf16_f32 v10, v20, v21
    v_cvt_pk_bf16_f32 v11, v22, v23
    v_cvt_pk_bf16_f32 v12, v24, v25
    v_cvt_pk_bf16_f32 v13, v26, v27
    v_cvt_pk_bf16_f32 v14, v28, v29
    v_cvt_pk_bf16_f32 v15, v30, v31
    v_cvt_pk_bf16_f32 v16, v32, v33
    v_cvt_pk_bf16_f32 v17, v34, v35
    v_cvt_pk_bf16_f32 v18, v36, v37
    v_cvt_pk_bf16_f32 v19, v38, v39
    v_cvt_pk_bf16_f32 v20, v40, v41
    v_cvt_pk_bf16_f32 v21, v42, v43
    v_cvt_pk_bf16_f32 v22, v44, v45
    v_cvt_pk_bf16_f32 v23, v46, v47
    v_cvt_pk_bf16_f32 v24, v48, v49
    v_cvt_pk_bf16_f32 v25, v50, v51
    v_cvt_pk_bf16_f32 v26, v52, v53
    v_cvt_pk_bf16_f32 v27, v54, v55
    v_cvt_pk_bf16_f32 v28, v56, v57
    v_cvt_pk_bf16_f32 v29, v58, v59
    v_cvt_pk_bf16_f32 v30, v60, v61
    v_cvt_pk_bf16_f32 v31, v62, v63
    v_cvt_pk_bf16_f32 v32, v64, v65
    v_cvt_pk_bf16_f32 v33, v66, v67
    v_cvt_pk_bf16_f32 v34, v68, v69
    v_cvt_pk_bf16_f32 v35, v70, v71
    v_cvt_pk_bf16_f32 v36, v72, v73
    v_cvt_pk_bf16_f32 v37, v74, v75
    v_cvt_pk_bf16_f32 v38, v76, v77
    v_cvt_pk_bf16_f32 v39, v78, v79
    v_cvt_pk_bf16_f32 v40, v80, v81
    v_cvt_pk_bf16_f32 v41, v82, v83
    v_cvt_pk_bf16_f32 v42, v84, v85
    v_cvt_pk_bf16_f32 v43, v86, v87
    v_cvt_pk_bf16_f32 v44, v88, v89
    v_cvt_pk_bf16_f32 v45, v90, v91
    v_cvt_pk_bf16_f32 v46, v92, v93
    v_cvt_pk_bf16_f32 v47, v94, v95
    v_cvt_pk_bf16_f32 v48, v96, v97
    v_cvt_pk_bf16_f32 v49, v98, v99
    v_cvt_pk_bf16_f32 v50, v100, v101
    v_cvt_pk_bf16_f32 v51, v102, v103
    v_cvt_pk_bf16_f32 v52, v104, v105
    v_cvt_pk_bf16_f32 v53, v106, v107
    v_cvt_pk_bf16_f32 v54, v108, v109
    v_cvt_pk_bf16_f32 v55, v110, v111
    v_cvt_pk_bf16_f32 v56, v112, v113
    v_cvt_pk_bf16_f32 v57, v114, v115
    v_cvt_pk_bf16_f32 v58, v116, v117
    v_cvt_pk_bf16_f32 v59, v118, v119
    v_cvt_pk_bf16_f32 v60, v120, v121
    v_cvt_pk_bf16_f32 v61, v122, v123
    v_cvt_pk_bf16_f32 v62, v124, v125
    v_cvt_pk_bf16_f32 v63, v126, v127
    s_lshr_b32 s56, s3, 2
    s_and_b32 s57, s3, 3
    s_sub_u32 s58, 15, s5
    s_cmp_eq_u32 s56, 0
    s_cselect_b32 s58, s58, s5
    s_lshl_b32 s99, s58, 3
    s_lshl_b32 s93, s57, 1
    s_add_u32 s99, s99, s93
    s_lshl_b32 s59, s58, 1
    s_lshr_b32 s93, s57, 1
    s_add_u32 s59, s59, s93
    s_add_u32 s59, s59, 1
    s_lshl_b32 s93, s5, 1
    s_sub_u32 s60, 32, s93
    s_lshl_b32 s92, s57, 12
    s_lshl_b32 s62, s4, 19
    s_add_u32 s62, s62, s92
    s_add_u32 s63, s62, 20971520
    s_add_u32 s62, s62, 4194304
    s_mov_b32 s100, 0
    v_lshrrev_b32 v72, 4, v255
    v_bfe_u32 v73, v255, 2, 2
    v_lshl_add_u32 v74, v72, 3, v73
    v_lshlrev_b32 v74, 8, v74
    v_and_b32 v75, 3, v255
    v_lshl_add_u32 v74, v75, 3, v74
    v_add_u32 v74, s100, v74
    v_and_b32 v72, 1, v72
    v_lshl_or_b32 v72, v72, 2, v73
    s_add_u32 s93, s100, 0
    v_xor_b32 v75, s93, v72
    v_lshl_add_u32 v192, v75, 5, v74
    s_add_u32 s93, s100, 1
    v_xor_b32 v75, s93, v72
    v_lshl_add_u32 v193, v75, 5, v74
    s_add_u32 s93, s100, 2
    v_xor_b32 v75, s93, v72
    v_lshl_add_u32 v194, v75, 5, v74
    s_add_u32 s93, s100, 3
    v_xor_b32 v75, s93, v72
    v_lshl_add_u32 v195, v75, 5, v74
    s_add_u32 s93, s100, 4
    v_xor_b32 v75, s93, v72
    v_lshl_add_u32 v196, v75, 5, v74
    s_add_u32 s93, s100, 5
    v_xor_b32 v75, s93, v72
    v_lshl_add_u32 v197, v75, 5, v74
    s_add_u32 s93, s100, 6
    v_xor_b32 v75, s93, v72
    v_lshl_add_u32 v198, v75, 5, v74
    s_add_u32 s93, s100, 7
    v_xor_b32 v75, s93, v72
    v_lshl_add_u32 v199, v75, 5, v74
    v_lshrrev_b32 v72, 4, v255
    v_bfe_u32 v73, v255, 2, 2
    v_lshl_add_u32 v74, v72, 3, v73
    v_lshlrev_b32 v74, 7, v74
    v_and_b32 v75, 3, v255
    v_lshl_add_u32 v74, v75, 3, v74
    v_add_u32 v74, 32768, v74
    v_and_b32 v72, 1, v72
    v_lshrrev_b32 v73, 1, v73
    v_lshl_or_b32 v72, v72, 1, v73
    v_xor_b32 v75, 0, v72
    v_lshl_add_u32 v240, v75, 5, v74
    v_xor_b32 v75, 1, v72
    v_lshl_add_u32 v241, v75, 5, v74
    v_xor_b32 v75, 2, v72
    v_lshl_add_u32 v242, v75, 5, v74
    v_xor_b32 v75, 3, v72
    v_lshl_add_u32 v243, v75, 5, v74
    v_mov_b32 v124, 0
    v_mov_b32 v125, 0
    v_mov_b32 v126, 0
    v_mov_b32 v127, 0
    v_mov_b32 v248, 0x3f803f80
    v_mov_b32 v249, 0x3f803f80
    v_mov_b32 v250, 0x3f803f80
    v_mov_b32 v251, 0x3f803f80
    ds_read_b64_tr_b16 v[104:105], v192 offset:0
    ds_read_b64_tr_b16 v[106:107], v192 offset:1024
    ds_read_b64_tr_b16 v[108:109], v193 offset:0
    ds_read_b64_tr_b16 v[110:111], v193 offset:1024
    ds_read_b64_tr_b16 v[112:113], v194 offset:0
    ds_read_b64_tr_b16 v[114:115], v194 offset:1024
    ds_read_b64_tr_b16 v[116:117], v195 offset:0
    ds_read_b64_tr_b16 v[118:119], v195 offset:1024
    ds_read_b64_tr_b16 v[120:121], v196 offset:0
    ds_read_b64_tr_b16 v[122:123], v196 offset:1024
    s_waitcnt vmcnt(14)
    s_waitcnt lgkmcnt(6)
    v_mfma_f32_16x16x32_bf16 v[128:131], v[104:107], v[200:203], 0
    v_mfma_f32_16x16x32_bf16 v[160:163], v[104:107], v[204:207], 0
    ds_read_b64_tr_b16 v[104:105], v197 offset:0
    ds_read_b64_tr_b16 v[106:107], v197 offset:1024
    v_mfma_f32_16x16x32_bf16 v[132:135], v[108:111], v[200:203], 0
    s_add_u32 s93, s64, 0
    buffer_store_dwordx4 v[0:3], v254, s[52:55], s93 offen offset:0 sc1
    v_mfma_f32_16x16x32_bf16 v[164:167], v[108:111], v[204:207], 0
    ds_read_b64_tr_b16 v[108:109], v198 offset:0
    ds_read_b64_tr_b16 v[110:111], v198 offset:1024
    s_waitcnt lgkmcnt(6)
    v_mfma_f32_16x16x32_bf16 v[136:139], v[112:115], v[200:203], 0
    s_add_u32 m0, s70, 114688
    s_add_u32 s93, s89, 2097152
    buffer_load_dwordx4 v244, s[16:19], s93 offen lds
    v_mfma_f32_16x16x32_bf16 v[168:171], v[112:115], v[204:207], 0
    ds_read_b64_tr_b16 v[112:113], v199 offset:0
    ds_read_b64_tr_b16 v[114:115], v199 offset:1024
    s_add_u32 s93, s87, 4096
    buffer_load_dwordx4 v[64:67], v254, s[52:55], s93 offen offset:1024 sc1
    v_mfma_f32_16x16x32_bf16 v[140:143], v[116:119], v[200:203], 0
    v_mfma_f32_16x16x32_bf16 v[172:175], v[116:119], v[204:207], 0
    ds_read_b64_tr_b16 v[116:117], v240 offset:0
    ds_read_b64_tr_b16 v[118:119], v240 offset:512
    s_waitcnt lgkmcnt(6)
    v_mfma_f32_16x16x32_bf16 v[144:147], v[120:123], v[200:203], 0
    v_mfma_f32_16x16x32_bf16 v[176:179], v[120:123], v[204:207], 0
    ds_read_b64_tr_b16 v[120:121], v241 offset:0
    ds_read_b64_tr_b16 v[122:123], v241 offset:512
    v_mfma_f32_16x16x32_bf16 v[148:151], v[104:107], v[200:203], 0
    v_mfma_f32_16x16x32_bf16 v[180:183], v[104:107], v[204:207], 0
    ds_read_b64_tr_b16 v[104:105], v242 offset:0
    ds_read_b64_tr_b16 v[106:107], v242 offset:512
    s_waitcnt lgkmcnt(6)
    v_mfma_f32_16x16x32_bf16 v[152:155], v[108:111], v[200:203], 0
    s_add_u32 m0, s70, 115712
    s_add_u32 s93, s89, 2129920
    buffer_load_dwordx4 v244, s[16:19], s93 offen lds
    v_mfma_f32_16x16x32_bf16 v[184:187], v[108:111], v[204:207], 0
    ds_read_b64_tr_b16 v[108:109], v243 offset:0
    ds_read_b64_tr_b16 v[110:111], v243 offset:512
    v_mfma_f32_16x16x32_bf16 v[156:159], v[112:115], v[200:203], 0
    v_mfma_f32_16x16x32_bf16 v[188:191], v[112:115], v[204:207], 0
    ds_read_b64_tr_b16 v[112:113], v192 offset:8192
    ds_read_b64_tr_b16 v[114:115], v192 offset:9216
    s_waitcnt lgkmcnt(6)
    v_mfma_f32_16x16x32_bf16 v[72:75], v[116:119], v[200:203], 0
    s_cmp_eq_u32 s3, 0
    s_cbranch_scc1 L_cs1
    L_cb1:
    v_mfma_f32_16x16x32_bf16 v[88:91], v[116:119], v[204:207], 0
    ds_read_b64_tr_b16 v[116:117], v193 offset:8192
    ds_read_b64_tr_b16 v[118:119], v193 offset:9216
    s_add_u32 s93, s87, 20480
    buffer_load_dwordx4 v[68:71], v254, s[52:55], s93 offen offset:1024 sc1
    v_mfma_f32_16x16x32_bf16 v[76:79], v[120:123], v[200:203], 0
    s_add_u32 s93, s64, 0
    buffer_store_dwordx4 v[4:7], v254, s[52:55], s93 offen offset:1024 sc1
    s_cmp_eq_u32 s3, 1
    s_cbranch_scc1 L_cs2
    L_cb2:
    v_mfma_f32_16x16x32_bf16 v[92:95], v[120:123], v[204:207], 0
    ds_read_b64_tr_b16 v[120:121], v194 offset:8192
    ds_read_b64_tr_b16 v[122:123], v194 offset:9216
    s_waitcnt lgkmcnt(6)
    v_mfma_f32_16x16x32_bf16 v[80:83], v[104:107], v[200:203], 0
    s_add_u32 m0, s70, 116736
    s_add_u32 s93, s89, 2162688
    buffer_load_dwordx4 v245, s[16:19], s93 offen lds
    s_cmp_eq_u32 s3, 2
    s_cbranch_scc1 L_cs3
    L_cb3:
    v_mfma_f32_16x16x32_bf16 v[96:99], v[104:107], v[204:207], 0
    ds_read_b64_tr_b16 v[104:105], v195 offset:8192
    ds_read_b64_tr_b16 v[106:107], v195 offset:9216
    v_mfma_f32_16x16x32_bf16 v[84:87], v[108:111], v[200:203], 0
    s_cmp_eq_u32 s3, 3
    s_cbranch_scc1 L_cs4
    L_cb4:
    v_mfma_f32_16x16x32_bf16 v[100:103], v[108:111], v[204:207], 0
    ds_read_b64_tr_b16 v[108:109], v196 offset:8192
    ds_read_b64_tr_b16 v[110:111], v196 offset:9216
    s_waitcnt vmcnt(19)
    s_waitcnt lgkmcnt(6)
    v_mfma_f32_16x16x32_bf16 v[128:131], v[112:115], v[208:211], v[128:131]
    v_mfma_f32_16x16x32_bf16 v[160:163], v[112:115], v[212:215], v[160:163]
    ds_read_b64_tr_b16 v[112:113], v197 offset:8192
    ds_read_b64_tr_b16 v[114:115], v197 offset:9216
    v_mfma_f32_16x16x32_bf16 v[132:135], v[116:119], v[208:211], v[132:135]
    v_mfma_f32_16x16x32_bf16 v[164:167], v[116:119], v[212:215], v[164:167]
    ds_read_b64_tr_b16 v[116:117], v198 offset:8192
    ds_read_b64_tr_b16 v[118:119], v198 offset:9216
    s_waitcnt lgkmcnt(6)
    v_mfma_f32_16x16x32_bf16 v[136:139], v[120:123], v[208:211], v[136:139]
    s_add_u32 m0, s70, 117760
    s_add_u32 s93, s89, 2195456
    buffer_load_dwordx4 v245, s[16:19], s93 offen lds
    v_mfma_f32_16x16x32_bf16 v[168:171], v[120:123], v[212:215], v[168:171]
    ds_read_b64_tr_b16 v[120:121], v199 offset:8192
    ds_read_b64_tr_b16 v[122:123], v199 offset:9216
    s_add_u32 s93, s87, 4096
    buffer_load_dwordx4 v[200:203], v254, s[52:55], s93 offen offset:2048 sc1
    v_mfma_f32_16x16x32_bf16 v[140:143], v[104:107], v[208:211], v[140:143]
    v_mfma_f32_16x16x32_bf16 v[172:175], v[104:107], v[212:215], v[172:175]
    ds_read_b64_tr_b16 v[104:105], v240 offset:4096
    ds_read_b64_tr_b16 v[106:107], v240 offset:4608
    s_waitcnt lgkmcnt(6)
    v_mfma_f32_16x16x32_bf16 v[144:147], v[108:111], v[208:211], v[144:147]
    v_mfma_f32_16x16x32_bf16 v[176:179], v[108:111], v[212:215], v[176:179]
    ds_read_b64_tr_b16 v[108:109], v241 offset:4096
    ds_read_b64_tr_b16 v[110:111], v241 offset:4608
    v_mfma_f32_16x16x32_bf16 v[148:151], v[112:115], v[208:211], v[148:151]
    s_add_u32 s93, s65, 0
    buffer_store_dwordx4 v[8:11], v254, s[52:55], s93 offen offset:0 sc1
    v_mfma_f32_16x16x32_bf16 v[180:183], v[112:115], v[212:215], v[180:183]
    ds_read_b64_tr_b16 v[112:113], v242 offset:4096
    ds_read_b64_tr_b16 v[114:115], v242 offset:4608
    s_waitcnt lgkmcnt(6)
    v_mfma_f32_16x16x32_bf16 v[152:155], v[116:119], v[208:211], v[152:155]
    s_add_u32 m0, s85, 147456
    s_add_u32 s93, s88, 704512
    buffer_load_dwordx4 v246, s[28:31], s93 offen lds
    v_mfma_f32_16x16x32_bf16 v[184:187], v[116:119], v[212:215], v[184:187]
    ds_read_b64_tr_b16 v[116:117], v243 offset:4096
    ds_read_b64_tr_b16 v[118:119], v243 offset:4608
    v_mfma_f32_16x16x32_bf16 v[156:159], v[120:123], v[208:211], v[156:159]
    v_mfma_f32_16x16x32_bf16 v[188:191], v[120:123], v[212:215], v[188:191]
    ds_read_b64_tr_b16 v[120:121], v192 offset:16384
    ds_read_b64_tr_b16 v[122:123], v192 offset:17408
    s_waitcnt lgkmcnt(6)
    v_mfma_f32_16x16x32_bf16 v[72:75], v[104:107], v[208:211], v[72:75]
    s_cmp_eq_u32 s3, 0
    s_cbranch_scc1 L_cs5
    L_cb5:
    v_mfma_f32_16x16x32_bf16 v[88:91], v[104:107], v[212:215], v[88:91]
    ds_read_b64_tr_b16 v[104:105], v193 offset:16384
    ds_read_b64_tr_b16 v[106:107], v193 offset:17408
    s_add_u32 s93, s87, 20480
    buffer_load_dwordx4 v[204:207], v254, s[52:55], s93 offen offset:2048 sc1
    v_mfma_f32_16x16x32_bf16 v[76:79], v[108:111], v[208:211], v[76:79]
    s_cmp_eq_u32 s3, 1
    s_cbranch_scc1 L_cs6
    L_cb6:
    v_mfma_f32_16x16x32_bf16 v[92:95], v[108:111], v[212:215], v[92:95]
    ds_read_b64_tr_b16 v[108:109], v194 offset:16384
    ds_read_b64_tr_b16 v[110:111], v194 offset:17408
    s_waitcnt lgkmcnt(6)
    v_mfma_f32_16x16x32_bf16 v[80:83], v[112:115], v[208:211], v[80:83]
    s_add_u32 m0, s85, 148480
    s_add_u32 s93, s88, 726528
    buffer_load_dwordx4 v247, s[28:31], s93 offen lds
    s_cmp_eq_u32 s3, 2
    s_cbranch_scc1 L_cs7
    L_cb7:
    v_mfma_f32_16x16x32_bf16 v[96:99], v[112:115], v[212:215], v[96:99]
    ds_read_b64_tr_b16 v[112:113], v195 offset:16384
    ds_read_b64_tr_b16 v[114:115], v195 offset:17408
    v_mfma_f32_16x16x32_bf16 v[84:87], v[116:119], v[208:211], v[84:87]
    s_cmp_eq_u32 s3, 3
    s_cbranch_scc1 L_cs8
    L_cb8:
    v_mfma_f32_16x16x32_bf16 v[100:103], v[116:119], v[212:215], v[100:103]
    ds_read_b64_tr_b16 v[116:117], v196 offset:16384
    ds_read_b64_tr_b16 v[118:119], v196 offset:17408
    s_waitcnt vmcnt(23)
    s_waitcnt lgkmcnt(6)
    v_mfma_f32_16x16x32_bf16 v[128:131], v[120:123], v[216:219], v[128:131]
    v_mfma_f32_16x16x32_bf16 v[160:163], v[120:123], v[220:223], v[160:163]
    ds_read_b64_tr_b16 v[120:121], v197 offset:16384
    ds_read_b64_tr_b16 v[122:123], v197 offset:17408
    v_mfma_f32_16x16x32_bf16 v[132:135], v[104:107], v[216:219], v[132:135]
    s_add_u32 s93, s65, 0
    buffer_store_dwordx4 v[12:15], v254, s[52:55], s93 offen offset:1024 sc1
    v_mfma_f32_16x16x32_bf16 v[164:167], v[104:107], v[220:223], v[164:167]
    ds_read_b64_tr_b16 v[104:105], v198 offset:16384
    ds_read_b64_tr_b16 v[106:107], v198 offset:17408
    s_waitcnt lgkmcnt(6)
    v_mfma_f32_16x16x32_bf16 v[136:139], v[108:111], v[216:219], v[136:139]
    v_mfma_f32_16x16x32_bf16 v[168:171], v[108:111], v[220:223], v[168:171]
    ds_read_b64_tr_b16 v[108:109], v199 offset:16384
    ds_read_b64_tr_b16 v[110:111], v199 offset:17408
    s_add_u32 s93, s87, 4096
    buffer_load_dwordx4 v[208:211], v254, s[52:55], s93 offen offset:3072 sc1
    v_mfma_f32_16x16x32_bf16 v[140:143], v[112:115], v[216:219], v[140:143]
    v_mfma_f32_16x16x32_bf16 v[172:175], v[112:115], v[220:223], v[172:175]
    ds_read_b64_tr_b16 v[112:113], v240 offset:8192
    ds_read_b64_tr_b16 v[114:115], v240 offset:8704
    s_waitcnt lgkmcnt(6)
    v_mfma_f32_16x16x32_bf16 v[144:147], v[116:119], v[216:219], v[144:147]
    v_mfma_f32_16x16x32_bf16 v[176:179], v[116:119], v[220:223], v[176:179]
    ds_read_b64_tr_b16 v[116:117], v241 offset:8192
    ds_read_b64_tr_b16 v[118:119], v241 offset:8704
    v_mfma_f32_16x16x32_bf16 v[148:151], v[120:123], v[216:219], v[148:151]
    v_mfma_f32_16x16x32_bf16 v[180:183], v[120:123], v[220:223], v[180:183]
    ds_read_b64_tr_b16 v[120:121], v242 offset:8192
    ds_read_b64_tr_b16 v[122:123], v242 offset:8704
    s_waitcnt lgkmcnt(6)
    v_mfma_f32_16x16x32_bf16 v[152:155], v[104:107], v[216:219], v[152:155]
    v_mfma_f32_16x16x32_bf16 v[184:187], v[104:107], v[220:223], v[184:187]
    ds_read_b64_tr_b16 v[104:105], v243 offset:8192
    ds_read_b64_tr_b16 v[106:107], v243 offset:8704
    v_mfma_f32_16x16x32_bf16 v[156:159], v[108:111], v[216:219], v[156:159]
    v_mfma_f32_16x16x32_bf16 v[188:191], v[108:111], v[220:223], v[188:191]
    ds_read_b64_tr_b16 v[108:109], v192 offset:24576
    ds_read_b64_tr_b16 v[110:111], v192 offset:25600
    s_waitcnt lgkmcnt(6)
    v_mfma_f32_16x16x32_bf16 v[72:75], v[112:115], v[216:219], v[72:75]
    s_cmp_eq_u32 s3, 0
    s_cbranch_scc1 L_cs9
    L_cb9:
    v_mfma_f32_16x16x32_bf16 v[88:91], v[112:115], v[220:223], v[88:91]
    ds_read_b64_tr_b16 v[112:113], v193 offset:24576
    ds_read_b64_tr_b16 v[114:115], v193 offset:25600
    s_add_u32 s93, s87, 20480
    buffer_load_dwordx4 v[212:215], v254, s[52:55], s93 offen offset:3072 sc1
    v_mfma_f32_16x16x32_bf16 v[76:79], v[116:119], v[216:219], v[76:79]
    s_add_u32 s93, s64, 8192
    buffer_store_dwordx4 v[16:19], v254, s[52:55], s93 offen offset:0 sc1
    s_cmp_eq_u32 s3, 1
    s_cbranch_scc1 L_cs10
    L_cb10:
    v_mfma_f32_16x16x32_bf16 v[92:95], v[116:119], v[220:223], v[92:95]
    ds_read_b64_tr_b16 v[116:117], v194 offset:24576
    ds_read_b64_tr_b16 v[118:119], v194 offset:25600
    s_waitcnt lgkmcnt(6)
    v_mfma_f32_16x16x32_bf16 v[80:83], v[120:123], v[216:219], v[80:83]
    s_cmp_eq_u32 s3, 2
    s_cbranch_scc1 L_cs11
    L_cb11:
    v_mfma_f32_16x16x32_bf16 v[96:99], v[120:123], v[220:223], v[96:99]
    ds_read_b64_tr_b16 v[120:121], v195 offset:24576
    ds_read_b64_tr_b16 v[122:123], v195 offset:25600
    v_mfma_f32_16x16x32_bf16 v[84:87], v[104:107], v[216:219], v[84:87]
    s_cmp_eq_u32 s3, 3
    s_cbranch_scc1 L_cs12
    L_cb12:
    v_mfma_f32_16x16x32_bf16 v[100:103], v[104:107], v[220:223], v[100:103]
    ds_read_b64_tr_b16 v[104:105], v196 offset:24576
    ds_read_b64_tr_b16 v[106:107], v196 offset:25600
    s_waitcnt vmcnt(25)
    s_waitcnt lgkmcnt(6)
    v_mfma_f32_16x16x32_bf16 v[128:131], v[108:111], v[224:227], v[128:131]
    v_mfma_f32_16x16x32_bf16 v[160:163], v[108:111], v[228:231], v[160:163]
    ds_read_b64_tr_b16 v[108:109], v197 offset:24576
    ds_read_b64_tr_b16 v[110:111], v197 offset:25600
    v_mfma_f32_16x16x32_bf16 v[132:135], v[112:115], v[224:227], v[132:135]
    v_mfma_f32_16x16x32_bf16 v[164:167], v[112:115], v[228:231], v[164:167]
    ds_read_b64_tr_b16 v[112:113], v198 offset:24576
    ds_read_b64_tr_b16 v[114:115], v198 offset:25600
    s_waitcnt lgkmcnt(6)
    v_mfma_f32_16x16x32_bf16 v[136:139], v[116:119], v[224:227], v[136:139]
    v_mfma_f32_16x16x32_bf16 v[168:171], v[116:119], v[228:231], v[168:171]
    ds_read_b64_tr_b16 v[116:117], v199 offset:24576
    ds_read_b64_tr_b16 v[118:119], v199 offset:25600
    s_add_u32 s93, s87, 8192
    buffer_load_dwordx4 v[216:219], v254, s[52:55], s93 offen offset:0 sc1
    v_mfma_f32_16x16x32_bf16 v[140:143], v[120:123], v[224:227], v[140:143]
    v_mfma_f32_16x16x32_bf16 v[172:175], v[120:123], v[228:231], v[172:175]
    ds_read_b64_tr_b16 v[120:121], v240 offset:12288
    ds_read_b64_tr_b16 v[122:123], v240 offset:12800
    s_waitcnt lgkmcnt(6)
    v_mfma_f32_16x16x32_bf16 v[144:147], v[104:107], v[224:227], v[144:147]
    v_mfma_f32_16x16x32_bf16 v[176:179], v[104:107], v[228:231], v[176:179]
    ds_read_b64_tr_b16 v[104:105], v241 offset:12288
    ds_read_b64_tr_b16 v[106:107], v241 offset:12800
    v_mfma_f32_16x16x32_bf16 v[148:151], v[108:111], v[224:227], v[148:151]
    v_mfma_f32_16x16x32_bf16 v[180:183], v[108:111], v[228:231], v[180:183]
    ds_read_b64_tr_b16 v[108:109], v242 offset:12288
    ds_read_b64_tr_b16 v[110:111], v242 offset:12800
    s_add_u32 s93, s64, 8192
    buffer_store_dwordx4 v[20:23], v254, s[52:55], s93 offen offset:1024 sc1
    s_waitcnt lgkmcnt(6)
    v_mfma_f32_16x16x32_bf16 v[152:155], v[112:115], v[224:227], v[152:155]
    v_mfma_f32_16x16x32_bf16 v[184:187], v[112:115], v[228:231], v[184:187]
    ds_read_b64_tr_b16 v[112:113], v243 offset:12288
    ds_read_b64_tr_b16 v[114:115], v243 offset:12800
    v_mfma_f32_16x16x32_bf16 v[156:159], v[116:119], v[224:227], v[156:159]
    v_mfma_f32_16x16x32_bf16 v[188:191], v[116:119], v[228:231], v[188:191]
    s_waitcnt vmcnt(19)
    s_barrier
    v_add_u32 v192, 65536, v192
    v_add_u32 v193, 65536, v193
    v_add_u32 v194, 65536, v194
    v_add_u32 v195, 65536, v195
    v_add_u32 v196, 65536, v196
    v_add_u32 v197, 65536, v197
    v_add_u32 v198, 65536, v198
    v_add_u32 v199, 65536, v199
    v_add_u32 v240, 65536, v240
    v_add_u32 v241, 65536, v241
    v_add_u32 v242, 65536, v242
    v_add_u32 v243, 65536, v243
    ds_read_b64_tr_b16 v[116:117], v192 offset:0
    s_waitcnt lgkmcnt(5)
    v_mfma_f32_16x16x32_bf16 v[72:75], v[120:123], v[224:227], v[72:75]
    ds_read_b64_tr_b16 v[118:119], v192 offset:1024
    s_cmp_eq_u32 s3, 0
    s_cbranch_scc1 L_cs13
    L_cb13:
    v_mfma_f32_16x16x32_bf16 v[88:91], v[120:123], v[228:231], v[88:91]
    ds_read_b64_tr_b16 v[120:121], v193 offset:0
    ds_read_b64_tr_b16 v[122:123], v193 offset:1024
    s_add_u32 s93, s87, 24576
    buffer_load_dwordx4 v[220:223], v254, s[52:55], s93 offen offset:0 sc1
    v_mfma_f32_16x16x32_bf16 v[76:79], v[104:107], v[224:227], v[76:79]
    s_cmp_eq_u32 s3, 1
    s_cbranch_scc1 L_cs14
    L_cb14:
    v_mfma_f32_16x16x32_bf16 v[92:95], v[104:107], v[228:231], v[92:95]
    ds_read_b64_tr_b16 v[104:105], v194 offset:0
    ds_read_b64_tr_b16 v[106:107], v194 offset:1024
    s_waitcnt lgkmcnt(6)
    v_mfma_f32_16x16x32_bf16 v[80:83], v[108:111], v[224:227], v[80:83]
    s_cmp_eq_u32 s3, 2
    s_cbranch_scc1 L_cs15
    L_cb15:
    v_mfma_f32_16x16x32_bf16 v[96:99], v[108:111], v[228:231], v[96:99]
    ds_read_b64_tr_b16 v[108:109], v195 offset:0
    ds_read_b64_tr_b16 v[110:111], v195 offset:1024
    v_mfma_f32_16x16x32_bf16 v[84:87], v[112:115], v[224:227], v[84:87]
    s_cmp_eq_u32 s3, 3
    s_cbranch_scc1 L_cs16
    L_cb16:
    v_mfma_f32_16x16x32_bf16 v[100:103], v[112:115], v[228:231], v[100:103]
    ds_read_b64_tr_b16 v[112:113], v196 offset:0
    ds_read_b64_tr_b16 v[114:115], v196 offset:1024
    s_waitcnt vmcnt(26)
    s_waitcnt lgkmcnt(6)
    v_mfma_f32_16x16x32_bf16 v[128:131], v[116:119], v[232:235], v[128:131]
    v_mfma_f32_16x16x32_bf16 v[160:163], v[116:119], v[236:239], v[160:163]
    ds_read_b64_tr_b16 v[116:117], v197 offset:0
    ds_read_b64_tr_b16 v[118:119], v197 offset:1024
    v_mfma_f32_16x16x32_bf16 v[132:135], v[120:123], v[232:235], v[132:135]
    v_mfma_f32_16x16x32_bf16 v[164:167], v[120:123], v[236:239], v[164:167]
    ds_read_b64_tr_b16 v[120:121], v198 offset:0
    ds_read_b64_tr_b16 v[122:123], v198 offset:1024
    s_add_u32 s93, s65, 8192
    buffer_store_dwordx4 v[24:27], v254, s[52:55], s93 offen offset:0 sc1
    s_waitcnt lgkmcnt(6)
    v_mfma_f32_16x16x32_bf16 v[136:139], v[104:107], v[232:235], v[136:139]
    v_mfma_f32_16x16x32_bf16 v[168:171], v[104:107], v[236:239], v[168:171]
    ds_read_b64_tr_b16 v[104:105], v199 offset:0
    ds_read_b64_tr_b16 v[106:107], v199 offset:1024
    s_add_u32 s93, s87, 8192
    buffer_load_dwordx4 v[224:227], v254, s[52:55], s93 offen offset:1024 sc1
    v_mfma_f32_16x16x32_bf16 v[140:143], v[108:111], v[232:235], v[140:143]
    v_mfma_f32_16x16x32_bf16 v[172:175], v[108:111], v[236:239], v[172:175]
    ds_read_b64_tr_b16 v[108:109], v240 offset:0
    ds_read_b64_tr_b16 v[110:111], v240 offset:512
    s_waitcnt lgkmcnt(6)
    v_mfma_f32_16x16x32_bf16 v[144:147], v[112:115], v[232:235], v[144:147]
    v_mfma_f32_16x16x32_bf16 v[176:179], v[112:115], v[236:239], v[176:179]
    ds_read_b64_tr_b16 v[112:113], v241 offset:0
    ds_read_b64_tr_b16 v[114:115], v241 offset:512
    v_mfma_f32_16x16x32_bf16 v[148:151], v[116:119], v[232:235], v[148:151]
    v_mfma_f32_16x16x32_bf16 v[180:183], v[116:119], v[236:239], v[180:183]
    ds_read_b64_tr_b16 v[116:117], v242 offset:0
    ds_read_b64_tr_b16 v[118:119], v242 offset:512
    s_waitcnt lgkmcnt(6)
    v_mfma_f32_16x16x32_bf16 v[152:155], v[120:123], v[232:235], v[152:155]
    v_mfma_f32_16x16x32_bf16 v[184:187], v[120:123], v[236:239], v[184:187]
    ds_read_b64_tr_b16 v[120:121], v243 offset:0
    ds_read_b64_tr_b16 v[122:123], v243 offset:512
    v_mfma_f32_16x16x32_bf16 v[156:159], v[104:107], v[232:235], v[156:159]
    v_mfma_f32_16x16x32_bf16 v[188:191], v[104:107], v[236:239], v[188:191]
    ds_read_b64_tr_b16 v[104:105], v192 offset:8192
    ds_read_b64_tr_b16 v[106:107], v192 offset:9216
    s_waitcnt lgkmcnt(6)
    v_mfma_f32_16x16x32_bf16 v[72:75], v[108:111], v[232:235], v[72:75]
    s_cmp_eq_u32 s3, 0
    s_cbranch_scc1 L_cs18
    L_cb18:
    v_mfma_f32_16x16x32_bf16 v[88:91], v[108:111], v[236:239], v[88:91]
    ds_read_b64_tr_b16 v[108:109], v193 offset:8192
    ds_read_b64_tr_b16 v[110:111], v193 offset:9216
    s_add_u32 s93, s87, 24576
    buffer_load_dwordx4 v[228:231], v254, s[52:55], s93 offen offset:1024 sc1
    v_mfma_f32_16x16x32_bf16 v[76:79], v[112:115], v[232:235], v[76:79]
    s_cmp_eq_u32 s3, 1
    s_cbranch_scc1 L_cs19
    L_cb19:
    v_mfma_f32_16x16x32_bf16 v[92:95], v[112:115], v[236:239], v[92:95]
    ds_read_b64_tr_b16 v[112:113], v194 offset:8192
    ds_read_b64_tr_b16 v[114:115], v194 offset:9216
    s_add_u32 s93, s65, 8192
    buffer_store_dwordx4 v[28:31], v254, s[52:55], s93 offen offset:1024 sc1
    s_waitcnt lgkmcnt(6)
    v_mfma_f32_16x16x32_bf16 v[80:83], v[116:119], v[232:235], v[80:83]
    s_cmp_eq_u32 s3, 2
    s_cbranch_scc1 L_cs20
    L_cb20:
    v_mfma_f32_16x16x32_bf16 v[96:99], v[116:119], v[236:239], v[96:99]
    ds_read_b64_tr_b16 v[116:117], v195 offset:8192
    ds_read_b64_tr_b16 v[118:119], v195 offset:9216
    v_mfma_f32_16x16x32_bf16 v[84:87], v[120:123], v[232:235], v[84:87]
    s_cmp_eq_u32 s3, 3
    s_cbranch_scc1 L_cs21
    L_cb21:
    v_mfma_f32_16x16x32_bf16 v[100:103], v[120:123], v[236:239], v[100:103]
    ds_read_b64_tr_b16 v[120:121], v196 offset:8192
    ds_read_b64_tr_b16 v[122:123], v196 offset:9216
    s_waitcnt vmcnt(19)
    s_waitcnt lgkmcnt(6)
    v_mfma_f32_16x16x32_bf16 v[128:131], v[104:107], v[64:67], v[128:131]
    v_mfma_f32_16x16x32_bf16 v[160:163], v[104:107], v[68:71], v[160:163]
    ds_read_b64_tr_b16 v[104:105], v197 offset:8192
    ds_read_b64_tr_b16 v[106:107], v197 offset:9216
    v_mfma_f32_16x16x32_bf16 v[132:135], v[108:111], v[64:67], v[132:135]
    v_mfma_f32_16x16x32_bf16 v[164:167], v[108:111], v[68:71], v[164:167]
    ds_read_b64_tr_b16 v[108:109], v198 offset:8192
    ds_read_b64_tr_b16 v[110:111], v198 offset:9216
    s_waitcnt lgkmcnt(6)
    v_mfma_f32_16x16x32_bf16 v[136:139], v[112:115], v[64:67], v[136:139]
    v_mfma_f32_16x16x32_bf16 v[168:171], v[112:115], v[68:71], v[168:171]
    ds_read_b64_tr_b16 v[112:113], v199 offset:8192
    ds_read_b64_tr_b16 v[114:115], v199 offset:9216
    s_add_u32 s93, s87, 8192
    buffer_load_dwordx4 v[232:235], v254, s[52:55], s93 offen offset:2048 sc1
    v_mfma_f32_16x16x32_bf16 v[140:143], v[116:119], v[64:67], v[140:143]
    v_mfma_f32_16x16x32_bf16 v[172:175], v[116:119], v[68:71], v[172:175]
    ds_read_b64_tr_b16 v[116:117], v240 offset:4096
    ds_read_b64_tr_b16 v[118:119], v240 offset:4608
    s_waitcnt lgkmcnt(6)
    v_mfma_f32_16x16x32_bf16 v[144:147], v[120:123], v[64:67], v[144:147]
    v_mfma_f32_16x16x32_bf16 v[176:179], v[120:123], v[68:71], v[176:179]
    ds_read_b64_tr_b16 v[120:121], v241 offset:4096
    ds_read_b64_tr_b16 v[122:123], v241 offset:4608
    v_mfma_f32_16x16x32_bf16 v[148:151], v[104:107], v[64:67], v[148:151]
    v_mfma_f32_16x16x32_bf16 v[180:183], v[104:107], v[68:71], v[180:183]
    ds_read_b64_tr_b16 v[104:105], v242 offset:4096
    ds_read_b64_tr_b16 v[106:107], v242 offset:4608
    s_add_u32 s93, s64, 16384
    buffer_store_dwordx4 v[32:35], v254, s[52:55], s93 offen offset:0 sc1
    s_waitcnt lgkmcnt(6)
    v_mfma_f32_16x16x32_bf16 v[152:155], v[108:111], v[64:67], v[152:155]
    v_mfma_f32_16x16x32_bf16 v[184:187], v[108:111], v[68:71], v[184:187]
    ds_read_b64_tr_b16 v[108:109], v243 offset:4096
    ds_read_b64_tr_b16 v[110:111], v243 offset:4608
    v_mfma_f32_16x16x32_bf16 v[156:159], v[112:115], v[64:67], v[156:159]
    v_mfma_f32_16x16x32_bf16 v[188:191], v[112:115], v[68:71], v[188:191]
    ds_read_b64_tr_b16 v[112:113], v192 offset:16384
    ds_read_b64_tr_b16 v[114:115], v192 offset:17408
    s_waitcnt lgkmcnt(6)
    v_mfma_f32_16x16x32_bf16 v[72:75], v[116:119], v[64:67], v[72:75]
    s_cmp_eq_u32 s3, 0
    s_cbranch_scc1 L_cs22
    L_cb22:
    v_mfma_f32_16x16x32_bf16 v[88:91], v[116:119], v[68:71], v[88:91]
    ds_read_b64_tr_b16 v[116:117], v193 offset:16384
    ds_read_b64_tr_b16 v[118:119], v193 offset:17408
    s_add_u32 s93, s87, 24576
    buffer_load_dwordx4 v[236:239], v254, s[52:55], s93 offen offset:2048 sc1
    v_mfma_f32_16x16x32_bf16 v[76:79], v[120:123], v[64:67], v[76:79]
    s_cmp_eq_u32 s3, 1
    s_cbranch_scc1 L_cs23
    L_cb23:
    v_mfma_f32_16x16x32_bf16 v[92:95], v[120:123], v[68:71], v[92:95]
    ds_read_b64_tr_b16 v[120:121], v194 offset:16384
    ds_read_b64_tr_b16 v[122:123], v194 offset:17408
    s_waitcnt lgkmcnt(6)
    v_mfma_f32_16x16x32_bf16 v[80:83], v[104:107], v[64:67], v[80:83]
    s_cmp_eq_u32 s3, 2
    s_cbranch_scc1 L_cs24
    L_cb24:
    v_mfma_f32_16x16x32_bf16 v[96:99], v[104:107], v[68:71], v[96:99]
    ds_read_b64_tr_b16 v[104:105], v195 offset:16384
    ds_read_b64_tr_b16 v[106:107], v195 offset:17408
    v_mfma_f32_16x16x32_bf16 v[84:87], v[108:111], v[64:67], v[84:87]
    s_cmp_eq_u32 s3, 3
    s_cbranch_scc1 L_cs25
    L_cb25:
    v_mfma_f32_16x16x32_bf16 v[100:103], v[108:111], v[68:71], v[100:103]
    ds_read_b64_tr_b16 v[108:109], v196 offset:16384
    ds_read_b64_tr_b16 v[110:111], v196 offset:17408
    s_waitcnt vmcnt(15)
    s_waitcnt lgkmcnt(6)
    v_mfma_f32_16x16x32_bf16 v[128:131], v[112:115], v[200:203], v[128:131]
    v_mfma_f32_16x16x32_bf16 v[160:163], v[112:115], v[204:207], v[160:163]
    ds_read_b64_tr_b16 v[112:113], v197 offset:16384
    ds_read_b64_tr_b16 v[114:115], v197 offset:17408
    v_and_b32 v4, 15, v255
    v_lshlrev_b32 v4, 3, v4
    s_lshl_b32 s93, s99, 7
    s_add_u32 s93, s93, 2097152
    buffer_load_dwordx2 v[8:9], v4, s[52:55], s93 offen sc1
    buffer_load_dwordx2 v[10:11], v4, s[52:55], s93 offen offset:128 sc1
    v_mfma_f32_16x16x32_bf16 v[132:135], v[116:119], v[200:203], v[132:135]
    v_mfma_f32_16x16x32_bf16 v[164:167], v[116:119], v[204:207], v[164:167]
    ds_read_b64_tr_b16 v[116:117], v198 offset:16384
    ds_read_b64_tr_b16 v[118:119], v198 offset:17408
    s_add_u32 s93, s64, 16384
    buffer_store_dwordx4 v[36:39], v254, s[52:55], s93 offen offset:1024 sc1
    s_waitcnt lgkmcnt(6)
    v_mfma_f32_16x16x32_bf16 v[136:139], v[120:123], v[200:203], v[136:139]
    v_mfma_f32_16x16x32_bf16 v[168:171], v[120:123], v[204:207], v[168:171]
    ds_read_b64_tr_b16 v[120:121], v199 offset:16384
    ds_read_b64_tr_b16 v[122:123], v199 offset:17408
    s_add_u32 s93, s87, 8192
    buffer_load_dwordx4 v[64:67], v254, s[52:55], s93 offen offset:3072 sc1
    v_mfma_f32_16x16x32_bf16 v[140:143], v[104:107], v[200:203], v[140:143]
    v_mfma_f32_16x16x32_bf16 v[172:175], v[104:107], v[204:207], v[172:175]
    ds_read_b64_tr_b16 v[104:105], v240 offset:8192
    ds_read_b64_tr_b16 v[106:107], v240 offset:8704
    s_waitcnt lgkmcnt(6)
    v_mfma_f32_16x16x32_bf16 v[144:147], v[108:111], v[200:203], v[144:147]
    v_mfma_f32_16x16x32_bf16 v[176:179], v[108:111], v[204:207], v[176:179]
    ds_read_b64_tr_b16 v[108:109], v241 offset:8192
    ds_read_b64_tr_b16 v[110:111], v241 offset:8704
    v_mfma_f32_16x16x32_bf16 v[148:151], v[112:115], v[200:203], v[148:151]
    v_mfma_f32_16x16x32_bf16 v[180:183], v[112:115], v[204:207], v[180:183]
    ds_read_b64_tr_b16 v[112:113], v242 offset:8192
    ds_read_b64_tr_b16 v[114:115], v242 offset:8704
    s_waitcnt lgkmcnt(6)
    v_mfma_f32_16x16x32_bf16 v[152:155], v[116:119], v[200:203], v[152:155]
    v_mfma_f32_16x16x32_bf16 v[184:187], v[116:119], v[204:207], v[184:187]
    ds_read_b64_tr_b16 v[116:117], v243 offset:8192
    ds_read_b64_tr_b16 v[118:119], v243 offset:8704
    v_mfma_f32_16x16x32_bf16 v[156:159], v[120:123], v[200:203], v[156:159]
    v_mfma_f32_16x16x32_bf16 v[188:191], v[120:123], v[204:207], v[188:191]
    ds_read_b64_tr_b16 v[120:121], v192 offset:24576
    ds_read_b64_tr_b16 v[122:123], v192 offset:25600
    s_waitcnt lgkmcnt(6)
    v_mfma_f32_16x16x32_bf16 v[72:75], v[104:107], v[200:203], v[72:75]
    s_cmp_eq_u32 s3, 0
    s_cbranch_scc1 L_cs26
    L_cb26:
    v_mfma_f32_16x16x32_bf16 v[88:91], v[104:107], v[204:207], v[88:91]
    ds_read_b64_tr_b16 v[104:105], v193 offset:24576
    ds_read_b64_tr_b16 v[106:107], v193 offset:25600
    s_add_u32 s93, s87, 24576
    buffer_load_dwordx4 v[68:71], v254, s[52:55], s93 offen offset:3072 sc1
    v_mfma_f32_16x16x32_bf16 v[76:79], v[108:111], v[200:203], v[76:79]
    s_cmp_eq_u32 s3, 1
    s_cbranch_scc1 L_cs27
    L_cb27:
    v_mfma_f32_16x16x32_bf16 v[92:95], v[108:111], v[204:207], v[92:95]
    ds_read_b64_tr_b16 v[108:109], v194 offset:24576
    ds_read_b64_tr_b16 v[110:111], v194 offset:25600
    s_waitcnt lgkmcnt(6)
    v_mfma_f32_16x16x32_bf16 v[80:83], v[112:115], v[200:203], v[80:83]
    s_add_u32 s93, s65, 16384
    buffer_store_dwordx4 v[40:43], v254, s[52:55], s93 offen offset:0 sc1
    s_cmp_eq_u32 s3, 2
    s_cbranch_scc1 L_cs28
    L_cb28:
    v_mfma_f32_16x16x32_bf16 v[96:99], v[112:115], v[204:207], v[96:99]
    ds_read_b64_tr_b16 v[112:113], v195 offset:24576
    ds_read_b64_tr_b16 v[114:115], v195 offset:25600
    v_mfma_f32_16x16x32_bf16 v[84:87], v[116:119], v[200:203], v[84:87]
    s_cmp_eq_u32 s3, 3
    s_cbranch_scc1 L_cs29
    L_cb29:
    v_mfma_f32_16x16x32_bf16 v[100:103], v[116:119], v[204:207], v[100:103]
    ds_read_b64_tr_b16 v[116:117], v196 offset:24576
    ds_read_b64_tr_b16 v[118:119], v196 offset:25600
    s_waitcnt vmcnt(17)
    s_waitcnt lgkmcnt(6)
    v_mfma_f32_16x16x32_bf16 v[128:131], v[120:123], v[208:211], v[128:131]
    v_mfma_f32_16x16x32_bf16 v[160:163], v[120:123], v[212:215], v[160:163]
    ds_read_b64_tr_b16 v[120:121], v197 offset:24576
    ds_read_b64_tr_b16 v[122:123], v197 offset:25600
    v_lshrrev_b32 v5, 4, v255
    v_lshlrev_b32 v5, 3, v5
    s_lshl_b32 s93, s86, 7
    buffer_load_dwordx2 v[12:13], v5, s[36:39], s93 offen offset:0
    buffer_load_dwordx2 v[14:15], v5, s[36:39], s93 offen offset:32
    buffer_load_dwordx2 v[16:17], v5, s[36:39], s93 offen offset:64
    buffer_load_dwordx2 v[18:19], v5, s[36:39], s93 offen offset:96
    v_mfma_f32_16x16x32_bf16 v[132:135], v[104:107], v[208:211], v[132:135]
    v_mfma_f32_16x16x32_bf16 v[164:167], v[104:107], v[212:215], v[164:167]
    ds_read_b64_tr_b16 v[104:105], v198 offset:24576
    ds_read_b64_tr_b16 v[106:107], v198 offset:25600
    s_waitcnt lgkmcnt(6)
    v_mfma_f32_16x16x32_bf16 v[136:139], v[108:111], v[208:211], v[136:139]
    v_mfma_f32_16x16x32_bf16 v[168:171], v[108:111], v[212:215], v[168:171]
    ds_read_b64_tr_b16 v[108:109], v199 offset:24576
    ds_read_b64_tr_b16 v[110:111], v199 offset:25600
    s_add_u32 s93, s87, 12288
    buffer_load_dwordx4 v[200:203], v254, s[52:55], s93 offen offset:0 sc1
    v_mfma_f32_16x16x32_bf16 v[140:143], v[112:115], v[208:211], v[140:143]
    v_mfma_f32_16x16x32_bf16 v[172:175], v[112:115], v[212:215], v[172:175]
    ds_read_b64_tr_b16 v[112:113], v240 offset:12288
    ds_read_b64_tr_b16 v[114:115], v240 offset:12800
    s_waitcnt lgkmcnt(6)
    v_mfma_f32_16x16x32_bf16 v[144:147], v[116:119], v[208:211], v[144:147]
    v_mfma_f32_16x16x32_bf16 v[176:179], v[116:119], v[212:215], v[176:179]
    ds_read_b64_tr_b16 v[116:117], v241 offset:12288
    ds_read_b64_tr_b16 v[118:119], v241 offset:12800
    v_mfma_f32_16x16x32_bf16 v[148:151], v[120:123], v[208:211], v[148:151]
    v_mfma_f32_16x16x32_bf16 v[180:183], v[120:123], v[212:215], v[180:183]
    ds_read_b64_tr_b16 v[120:121], v242 offset:12288
    ds_read_b64_tr_b16 v[122:123], v242 offset:12800
    s_waitcnt lgkmcnt(6)
    v_mfma_f32_16x16x32_bf16 v[152:155], v[104:107], v[208:211], v[152:155]
    s_add_u32 s93, s65, 16384
    buffer_store_dwordx4 v[44:47], v254, s[52:55], s93 offen offset:1024 sc1
    v_mfma_f32_16x16x32_bf16 v[184:187], v[104:107], v[212:215], v[184:187]
    ds_read_b64_tr_b16 v[104:105], v243 offset:12288
    ds_read_b64_tr_b16 v[106:107], v243 offset:12800
    v_mfma_f32_16x16x32_bf16 v[156:159], v[108:111], v[208:211], v[156:159]
    v_mfma_f32_16x16x32_bf16 v[188:191], v[108:111], v[212:215], v[188:191]
    s_waitcnt vmcnt(26)
    s_barrier
    v_add_u32 v192, 49152, v192
    v_add_u32 v193, 49152, v193
    v_add_u32 v194, 49152, v194
    v_add_u32 v195, 49152, v195
    v_add_u32 v196, 49152, v196
    v_add_u32 v197, 49152, v197
    v_add_u32 v198, 49152, v198
    v_add_u32 v199, 49152, v199
    v_add_u32 v240, 49152, v240
    v_add_u32 v241, 49152, v241
    v_add_u32 v242, 49152, v242
    v_add_u32 v243, 49152, v243
    ds_read_b64_tr_b16 v[108:109], v192 offset:0
    s_waitcnt lgkmcnt(5)
    v_mfma_f32_16x16x32_bf16 v[72:75], v[112:115], v[208:211], v[72:75]
    ds_read_b64_tr_b16 v[110:111], v192 offset:1024
    s_cmp_eq_u32 s3, 0
    s_cbranch_scc1 L_cs30
    L_cb30:
    v_mfma_f32_16x16x32_bf16 v[88:91], v[112:115], v[212:215], v[88:91]
    ds_read_b64_tr_b16 v[112:113], v193 offset:0
    ds_read_b64_tr_b16 v[114:115], v193 offset:1024
    s_add_u32 s93, s87, 28672
    buffer_load_dwordx4 v[204:207], v254, s[52:55], s93 offen offset:0 sc1
    v_mfma_f32_16x16x32_bf16 v[76:79], v[116:119], v[208:211], v[76:79]
    s_cmp_eq_u32 s3, 1
    s_cbranch_scc1 L_cs31
    L_cb31:
    v_mfma_f32_16x16x32_bf16 v[92:95], v[116:119], v[212:215], v[92:95]
    ds_read_b64_tr_b16 v[116:117], v194 offset:0
    ds_read_b64_tr_b16 v[118:119], v194 offset:1024
    s_waitcnt lgkmcnt(6)
    v_mfma_f32_16x16x32_bf16 v[80:83], v[120:123], v[208:211], v[80:83]
    s_cmp_eq_u32 s3, 2
    s_cbranch_scc1 L_cs32
    L_cb32:
    v_mfma_f32_16x16x32_bf16 v[96:99], v[120:123], v[212:215], v[96:99]
    ds_read_b64_tr_b16 v[120:121], v195 offset:0
    ds_read_b64_tr_b16 v[122:123], v195 offset:1024
    v_mfma_f32_16x16x32_bf16 v[84:87], v[104:107], v[208:211], v[84:87]
    s_cmp_eq_u32 s3, 3
    s_cbranch_scc1 L_cs33
    L_cb33:
    v_mfma_f32_16x16x32_bf16 v[100:103], v[104:107], v[212:215], v[100:103]
    ds_read_b64_tr_b16 v[104:105], v196 offset:0
    ds_read_b64_tr_b16 v[106:107], v196 offset:1024
    s_waitcnt vmcnt(20)
    s_waitcnt lgkmcnt(6)
    v_mfma_f32_16x16x32_bf16 v[128:131], v[108:111], v[216:219], v[128:131]
    v_mfma_f32_16x16x32_bf16 v[160:163], v[108:111], v[220:223], v[160:163]
    ds_read_b64_tr_b16 v[108:109], v197 offset:0
    ds_read_b64_tr_b16 v[110:111], v197 offset:1024
    s_add_u32 m0, s70, 0
    s_add_u32 s93, s89, 3145728
    buffer_load_dwordx4 v244, s[16:19], s93 offen lds
    v_mfma_f32_16x16x32_bf16 v[132:135], v[112:115], v[216:219], v[132:135]
    v_mfma_f32_16x16x32_bf16 v[164:167], v[112:115], v[220:223], v[164:167]
    ds_read_b64_tr_b16 v[112:113], v198 offset:0
    ds_read_b64_tr_b16 v[114:115], v198 offset:1024
    s_waitcnt lgkmcnt(6)
    v_mfma_f32_16x16x32_bf16 v[136:139], v[116:119], v[216:219], v[136:139]
    s_add_u32 s93, s64, 24576
    buffer_store_dwordx4 v[48:51], v254, s[52:55], s93 offen offset:0 sc1
    s_add_u32 m0, s70, 1024
    s_add_u32 s93, s89, 3178496
    buffer_load_dwordx4 v244, s[16:19], s93 offen lds
    v_mfma_f32_16x16x32_bf16 v[168:171], v[116:119], v[220:223], v[168:171]
    ds_read_b64_tr_b16 v[116:117], v199 offset:0
    ds_read_b64_tr_b16 v[118:119], v199 offset:1024
    s_add_u32 s93, s87, 12288
    buffer_load_dwordx4 v[208:211], v254, s[52:55], s93 offen offset:1024 sc1
    v_mfma_f32_16x16x32_bf16 v[140:143], v[120:123], v[216:219], v[140:143]
    v_mfma_f32_16x16x32_bf16 v[172:175], v[120:123], v[220:223], v[172:175]
    ds_read_b64_tr_b16 v[120:121], v240 offset:0
    ds_read_b64_tr_b16 v[122:123], v240 offset:512
    s_add_u32 m0, s70, 2048
    s_add_u32 s93, s89, 3211264
    buffer_load_dwordx4 v245, s[16:19], s93 offen lds
    s_waitcnt lgkmcnt(6)
    v_mfma_f32_16x16x32_bf16 v[144:147], v[104:107], v[216:219], v[144:147]
    v_mfma_f32_16x16x32_bf16 v[176:179], v[104:107], v[220:223], v[176:179]
    ds_read_b64_tr_b16 v[104:105], v241 offset:0
    ds_read_b64_tr_b16 v[106:107], v241 offset:512
    v_mfma_f32_16x16x32_bf16 v[148:151], v[108:111], v[216:219], v[148:151]
    s_add_u32 m0, s70, 3072
    s_add_u32 s93, s89, 3244032
    buffer_load_dwordx4 v245, s[16:19], s93 offen lds
    v_mfma_f32_16x16x32_bf16 v[180:183], v[108:111], v[220:223], v[180:183]
    ds_read_b64_tr_b16 v[108:109], v242 offset:0
    ds_read_b64_tr_b16 v[110:111], v242 offset:512
    s_waitcnt lgkmcnt(6)
    v_mfma_f32_16x16x32_bf16 v[152:155], v[112:115], v[216:219], v[152:155]
    v_mfma_f32_16x16x32_bf16 v[184:187], v[112:115], v[220:223], v[184:187]
    ds_read_b64_tr_b16 v[112:113], v243 offset:0
    ds_read_b64_tr_b16 v[114:115], v243 offset:512
    s_add_u32 m0, s85, 32768
    s_add_u32 s93, s88, 1056768
    buffer_load_dwordx4 v246, s[28:31], s93 offen lds
    v_mfma_f32_16x16x32_bf16 v[156:159], v[116:119], v[216:219], v[156:159]
    v_mfma_f32_16x16x32_bf16 v[188:191], v[116:119], v[220:223], v[188:191]
    ds_read_b64_tr_b16 v[116:117], v192 offset:8192
    ds_read_b64_tr_b16 v[118:119], v192 offset:9216
    s_waitcnt lgkmcnt(6)
    v_mfma_f32_16x16x32_bf16 v[72:75], v[120:123], v[216:219], v[72:75]
    s_add_u32 m0, s85, 33792
    s_add_u32 s93, s88, 1078784
    buffer_load_dwordx4 v247, s[28:31], s93 offen lds
    s_cmp_eq_u32 s3, 4
    s_cbranch_scc1 L_cs35
    L_cb35:
    v_mfma_f32_16x16x32_bf16 v[88:91], v[120:123], v[220:223], v[88:91]
    ds_read_b64_tr_b16 v[120:121], v193 offset:8192
    ds_read_b64_tr_b16 v[122:123], v193 offset:9216
    s_add_u32 s93, s87, 28672
    buffer_load_dwordx4 v[212:215], v254, s[52:55], s93 offen offset:1024 sc1
    v_mfma_f32_16x16x32_bf16 v[76:79], v[104:107], v[216:219], v[76:79]
    s_cmp_eq_u32 s3, 5
    s_cbranch_scc1 L_cs36
    L_cb36:
    v_mfma_f32_16x16x32_bf16 v[92:95], v[104:107], v[220:223], v[92:95]
    ds_read_b64_tr_b16 v[104:105], v194 offset:8192
    ds_read_b64_tr_b16 v[106:107], v194 offset:9216
    s_waitcnt lgkmcnt(6)
    v_mfma_f32_16x16x32_bf16 v[80:83], v[108:111], v[216:219], v[80:83]
    s_add_u32 s93, s64, 24576
    buffer_store_dwordx4 v[52:55], v254, s[52:55], s93 offen offset:1024 sc1
    s_cmp_eq_u32 s3, 6
    s_cbranch_scc1 L_cs37
    L_cb37:
    v_mfma_f32_16x16x32_bf16 v[96:99], v[108:111], v[220:223], v[96:99]
    ds_read_b64_tr_b16 v[108:109], v195 offset:8192
    ds_read_b64_tr_b16 v[110:111], v195 offset:9216
    v_mfma_f32_16x16x32_bf16 v[84:87], v[112:115], v[216:219], v[84:87]
    s_cmp_eq_u32 s3, 7
    s_cbranch_scc1 L_cs38
    L_cb38:
    v_mfma_f32_16x16x32_bf16 v[100:103], v[112:115], v[220:223], v[100:103]
    ds_read_b64_tr_b16 v[112:113], v196 offset:8192
    ds_read_b64_tr_b16 v[114:115], v196 offset:9216
    s_waitcnt vmcnt(27)
    s_waitcnt lgkmcnt(6)
    v_mfma_f32_16x16x32_bf16 v[128:131], v[116:119], v[224:227], v[128:131]
    v_mfma_f32_16x16x32_bf16 v[160:163], v[116:119], v[228:231], v[160:163]
    ds_read_b64_tr_b16 v[116:117], v197 offset:8192
    ds_read_b64_tr_b16 v[118:119], v197 offset:9216
    v_mfma_f32_16x16x32_bf16 v[132:135], v[120:123], v[224:227], v[132:135]
    v_mfma_f32_16x16x32_bf16 v[164:167], v[120:123], v[228:231], v[164:167]
    ds_read_b64_tr_b16 v[120:121], v198 offset:8192
    ds_read_b64_tr_b16 v[122:123], v198 offset:9216
    s_waitcnt lgkmcnt(6)
    v_mfma_f32_16x16x32_bf16 v[136:139], v[104:107], v[224:227], v[136:139]
    v_mfma_f32_16x16x32_bf16 v[168:171], v[104:107], v[228:231], v[168:171]
    ds_read_b64_tr_b16 v[104:105], v199 offset:8192
    ds_read_b64_tr_b16 v[106:107], v199 offset:9216
    s_add_u32 s93, s87, 12288
    buffer_load_dwordx4 v[216:219], v254, s[52:55], s93 offen offset:2048 sc1
    v_mfma_f32_16x16x32_bf16 v[140:143], v[108:111], v[224:227], v[140:143]
    v_mfma_f32_16x16x32_bf16 v[172:175], v[108:111], v[228:231], v[172:175]
    ds_read_b64_tr_b16 v[108:109], v240 offset:4096
    ds_read_b64_tr_b16 v[110:111], v240 offset:4608
    s_waitcnt lgkmcnt(6)
    v_mfma_f32_16x16x32_bf16 v[144:147], v[112:115], v[224:227], v[144:147]
    v_mfma_f32_16x16x32_bf16 v[176:179], v[112:115], v[228:231], v[176:179]
    ds_read_b64_tr_b16 v[112:113], v241 offset:4096
    ds_read_b64_tr_b16 v[114:115], v241 offset:4608
    v_mfma_f32_16x16x32_bf16 v[148:151], v[116:119], v[224:227], v[148:151]
    v_mfma_f32_16x16x32_bf16 v[180:183], v[116:119], v[228:231], v[180:183]
    ds_read_b64_tr_b16 v[116:117], v242 offset:4096
    ds_read_b64_tr_b16 v[118:119], v242 offset:4608
    s_waitcnt lgkmcnt(6)
    v_mfma_f32_16x16x32_bf16 v[152:155], v[120:123], v[224:227], v[152:155]
    s_add_u32 s93, s65, 24576
    buffer_store_dwordx4 v[56:59], v254, s[52:55], s93 offen offset:0 sc1
    v_mfma_f32_16x16x32_bf16 v[184:187], v[120:123], v[228:231], v[184:187]
    ds_read_b64_tr_b16 v[120:121], v243 offset:4096
    ds_read_b64_tr_b16 v[122:123], v243 offset:4608
    v_mfma_f32_16x16x32_bf16 v[156:159], v[104:107], v[224:227], v[156:159]
    v_mfma_f32_16x16x32_bf16 v[188:191], v[104:107], v[228:231], v[188:191]
    ds_read_b64_tr_b16 v[104:105], v192 offset:16384
    ds_read_b64_tr_b16 v[106:107], v192 offset:17408
    s_waitcnt lgkmcnt(6)
    v_mfma_f32_16x16x32_bf16 v[72:75], v[108:111], v[224:227], v[72:75]
    s_cmp_eq_u32 s3, 4
    s_cbranch_scc1 L_cs39
    L_cb39:
    v_mfma_f32_16x16x32_bf16 v[88:91], v[108:111], v[228:231], v[88:91]
    ds_read_b64_tr_b16 v[108:109], v193 offset:16384
    ds_read_b64_tr_b16 v[110:111], v193 offset:17408
    s_add_u32 s93, s87, 28672
    buffer_load_dwordx4 v[220:223], v254, s[52:55], s93 offen offset:2048 sc1
    v_mfma_f32_16x16x32_bf16 v[76:79], v[112:115], v[224:227], v[76:79]
    s_cmp_eq_u32 s3, 5
    s_cbranch_scc1 L_cs40
    L_cb40:
    v_mfma_f32_16x16x32_bf16 v[92:95], v[112:115], v[228:231], v[92:95]
    ds_read_b64_tr_b16 v[112:113], v194 offset:16384
    ds_read_b64_tr_b16 v[114:115], v194 offset:17408
    s_waitcnt lgkmcnt(6)
    v_mfma_f32_16x16x32_bf16 v[80:83], v[116:119], v[224:227], v[80:83]
    s_cmp_eq_u32 s3, 6
    s_cbranch_scc1 L_cs41
    L_cb41:
    v_mfma_f32_16x16x32_bf16 v[96:99], v[116:119], v[228:231], v[96:99]
    ds_read_b64_tr_b16 v[116:117], v195 offset:16384
    ds_read_b64_tr_b16 v[118:119], v195 offset:17408
    v_mfma_f32_16x16x32_bf16 v[84:87], v[120:123], v[224:227], v[84:87]
    s_cmp_eq_u32 s3, 7
    s_cbranch_scc1 L_cs42
    L_cb42:
    v_mfma_f32_16x16x32_bf16 v[100:103], v[120:123], v[228:231], v[100:103]
    ds_read_b64_tr_b16 v[120:121], v196 offset:16384
    ds_read_b64_tr_b16 v[122:123], v196 offset:17408
    s_waitcnt vmcnt(26)
    s_waitcnt lgkmcnt(6)
    v_mfma_f32_16x16x32_bf16 v[128:131], v[104:107], v[232:235], v[128:131]
    v_mfma_f32_16x16x32_bf16 v[160:163], v[104:107], v[236:239], v[160:163]
    ds_read_b64_tr_b16 v[104:105], v197 offset:16384
    ds_read_b64_tr_b16 v[106:107], v197 offset:17408
    v_mfma_f32_16x16x32_bf16 v[132:135], v[108:111], v[232:235], v[132:135]
    v_mfma_f32_16x16x32_bf16 v[164:167], v[108:111], v[236:239], v[164:167]
    ds_read_b64_tr_b16 v[108:109], v198 offset:16384
    ds_read_b64_tr_b16 v[110:111], v198 offset:17408
    s_waitcnt lgkmcnt(6)
    v_mfma_f32_16x16x32_bf16 v[136:139], v[112:115], v[232:235], v[136:139]
    v_mfma_f32_16x16x32_bf16 v[168:171], v[112:115], v[236:239], v[168:171]
    ds_read_b64_tr_b16 v[112:113], v199 offset:16384
    ds_read_b64_tr_b16 v[114:115], v199 offset:17408
    s_add_u32 s93, s87, 12288
    buffer_load_dwordx4 v[224:227], v254, s[52:55], s93 offen offset:3072 sc1
    s_add_u32 s93, s65, 24576
    buffer_store_dwordx4 v[60:63], v254, s[52:55], s93 offen offset:1024 sc1
    v_mfma_f32_16x16x32_bf16 v[140:143], v[116:119], v[232:235], v[140:143]
    v_mfma_f32_16x16x32_bf16 v[172:175], v[116:119], v[236:239], v[172:175]
    ds_read_b64_tr_b16 v[116:117], v240 offset:8192
    ds_read_b64_tr_b16 v[118:119], v240 offset:8704
    s_waitcnt lgkmcnt(6)
    v_mfma_f32_16x16x32_bf16 v[144:147], v[120:123], v[232:235], v[144:147]
    v_mfma_f32_16x16x32_bf16 v[176:179], v[120:123], v[236:239], v[176:179]
    ds_read_b64_tr_b16 v[120:121], v241 offset:8192
    ds_read_b64_tr_b16 v[122:123], v241 offset:8704
    v_mfma_f32_16x16x32_bf16 v[148:151], v[104:107], v[232:235], v[148:151]
    v_mfma_f32_16x16x32_bf16 v[180:183], v[104:107], v[236:239], v[180:183]
    ds_read_b64_tr_b16 v[104:105], v242 offset:8192
    ds_read_b64_tr_b16 v[106:107], v242 offset:8704
    s_waitcnt lgkmcnt(6)
    v_mfma_f32_16x16x32_bf16 v[152:155], v[108:111], v[232:235], v[152:155]
    v_mfma_f32_16x16x32_bf16 v[184:187], v[108:111], v[236:239], v[184:187]
    ds_read_b64_tr_b16 v[108:109], v243 offset:8192
    ds_read_b64_tr_b16 v[110:111], v243 offset:8704
    v_mfma_f32_16x16x32_bf16 v[156:159], v[112:115], v[232:235], v[156:159]
    v_mfma_f32_16x16x32_bf16 v[188:191], v[112:115], v[236:239], v[188:191]
    ds_read_b64_tr_b16 v[112:113], v192 offset:24576
    ds_read_b64_tr_b16 v[114:115], v192 offset:25600
    s_waitcnt lgkmcnt(6)
    v_mfma_f32_16x16x32_bf16 v[72:75], v[116:119], v[232:235], v[72:75]
    s_cmp_eq_u32 s3, 4
    s_cbranch_scc1 L_cs43
    L_cb43:
    v_mfma_f32_16x16x32_bf16 v[88:91], v[116:119], v[236:239], v[88:91]
    ds_read_b64_tr_b16 v[116:117], v193 offset:24576
    ds_read_b64_tr_b16 v[118:119], v193 offset:25600
    s_add_u32 s93, s87, 28672
    buffer_load_dwordx4 v[228:231], v254, s[52:55], s93 offen offset:3072 sc1
    v_mfma_f32_16x16x32_bf16 v[76:79], v[120:123], v[232:235], v[76:79]
    s_cmp_eq_u32 s3, 5
    s_cbranch_scc1 L_cs44
    L_cb44:
    v_mfma_f32_16x16x32_bf16 v[92:95], v[120:123], v[236:239], v[92:95]
    ds_read_b64_tr_b16 v[120:121], v194 offset:24576
    ds_read_b64_tr_b16 v[122:123], v194 offset:25600
    s_waitcnt lgkmcnt(6)
    v_mfma_f32_16x16x32_bf16 v[80:83], v[104:107], v[232:235], v[80:83]
    s_cmp_eq_u32 s3, 6
    s_cbranch_scc1 L_cs45
    L_cb45:
    v_mfma_f32_16x16x32_bf16 v[96:99], v[104:107], v[236:239], v[96:99]
    ds_read_b64_tr_b16 v[104:105], v195 offset:24576
    ds_read_b64_tr_b16 v[106:107], v195 offset:25600
    v_mfma_f32_16x16x32_bf16 v[84:87], v[108:111], v[232:235], v[84:87]
    s_cmp_eq_u32 s3, 7
    s_cbranch_scc1 L_cs46
    L_cb46:
    v_mfma_f32_16x16x32_bf16 v[100:103], v[108:111], v[236:239], v[100:103]
    ds_read_b64_tr_b16 v[108:109], v196 offset:24576
    ds_read_b64_tr_b16 v[110:111], v196 offset:25600
    s_waitcnt vmcnt(24)
    s_waitcnt lgkmcnt(6)
    v_mfma_f32_16x16x32_bf16 v[128:131], v[112:115], v[64:67], v[128:131]
    v_mfma_f32_16x16x32_bf16 v[160:163], v[112:115], v[68:71], v[160:163]
    ds_read_b64_tr_b16 v[112:113], v197 offset:24576
    ds_read_b64_tr_b16 v[114:115], v197 offset:25600
    v_mfma_f32_16x16x32_bf16 v[132:135], v[116:119], v[64:67], v[132:135]
    v_mfma_f32_16x16x32_bf16 v[164:167], v[116:119], v[68:71], v[164:167]
    ds_read_b64_tr_b16 v[116:117], v198 offset:24576
    ds_read_b64_tr_b16 v[118:119], v198 offset:25600
    s_waitcnt lgkmcnt(6)
    v_mfma_f32_16x16x32_bf16 v[136:139], v[120:123], v[64:67], v[136:139]
    v_mfma_f32_16x16x32_bf16 v[168:171], v[120:123], v[68:71], v[168:171]
    ds_read_b64_tr_b16 v[120:121], v199 offset:24576
    ds_read_b64_tr_b16 v[122:123], v199 offset:25600
    v_mfma_f32_16x16x32_bf16 v[140:143], v[104:107], v[64:67], v[140:143]
    v_mfma_f32_16x16x32_bf16 v[172:175], v[104:107], v[68:71], v[172:175]
    ds_read_b64_tr_b16 v[104:105], v240 offset:12288
    ds_read_b64_tr_b16 v[106:107], v240 offset:12800
    s_waitcnt lgkmcnt(6)
    v_mfma_f32_16x16x32_bf16 v[144:147], v[108:111], v[64:67], v[144:147]
    v_mfma_f32_16x16x32_bf16 v[176:179], v[108:111], v[68:71], v[176:179]
    ds_read_b64_tr_b16 v[108:109], v241 offset:12288
    ds_read_b64_tr_b16 v[110:111], v241 offset:12800
    v_mfma_f32_16x16x32_bf16 v[148:151], v[112:115], v[64:67], v[148:151]
    v_mfma_f32_16x16x32_bf16 v[180:183], v[112:115], v[68:71], v[180:183]
    ds_read_b64_tr_b16 v[112:113], v242 offset:12288
    ds_read_b64_tr_b16 v[114:115], v242 offset:12800
    s_waitcnt lgkmcnt(6)
    v_mfma_f32_16x16x32_bf16 v[152:155], v[116:119], v[64:67], v[152:155]
    v_mfma_f32_16x16x32_bf16 v[184:187], v[116:119], v[68:71], v[184:187]
    ds_read_b64_tr_b16 v[116:117], v243 offset:12288
    ds_read_b64_tr_b16 v[118:119], v243 offset:12800
    v_mfma_f32_16x16x32_bf16 v[156:159], v[120:123], v[64:67], v[156:159]
    v_mfma_f32_16x16x32_bf16 v[188:191], v[120:123], v[68:71], v[188:191]
    s_waitcnt vmcnt(1)
    s_barrier
    s_cmp_lg_u32 s3, 0
    s_cbranch_scc1 L_pub51
    v_mov_b32 v0, 2
    s_lshl_b32 s93, s6, 7
    s_add_u32 s93, s93, 3145728
    v_mov_b32 v3, s93
    s_mov_b64 s[72:73], exec
    s_mov_b64 exec, 1
    buffer_store_dword v0, v3, s[52:55], 0 offen sc1
    s_mov_b64 exec, s[72:73]
    L_pub51:
    v_add_u32 v192, 4294852608, v192
    v_add_u32 v193, 4294852608, v193
    v_add_u32 v194, 4294852608, v194
    v_add_u32 v195, 4294852608, v195
    v_add_u32 v196, 4294852608, v196
    v_add_u32 v197, 4294852608, v197
    v_add_u32 v198, 4294852608, v198
    v_add_u32 v199, 4294852608, v199
    v_add_u32 v240, 4294852608, v240
    v_add_u32 v241, 4294852608, v241
    v_add_u32 v242, 4294852608, v242
    v_add_u32 v243, 4294852608, v243
    ds_read_b64_tr_b16 v[120:121], v192 offset:0
    s_waitcnt lgkmcnt(5)
    v_mfma_f32_16x16x32_bf16 v[72:75], v[104:107], v[64:67], v[72:75]
    ds_read_b64_tr_b16 v[122:123], v192 offset:1024
    s_cmp_eq_u32 s3, 4
    s_cbranch_scc1 L_cs47
    L_cb47:
    v_mfma_f32_16x16x32_bf16 v[88:91], v[104:107], v[68:71], v[88:91]
    ds_read_b64_tr_b16 v[104:105], v193 offset:0
    ds_read_b64_tr_b16 v[106:107], v193 offset:1024
    v_mfma_f32_16x16x32_bf16 v[76:79], v[108:111], v[64:67], v[76:79]
    s_cmp_eq_u32 s3, 5
    s_cbranch_scc1 L_cs48
    L_cb48:
    v_mfma_f32_16x16x32_bf16 v[92:95], v[108:111], v[68:71], v[92:95]
    ds_read_b64_tr_b16 v[108:109], v194 offset:0
    ds_read_b64_tr_b16 v[110:111], v194 offset:1024
    s_waitcnt lgkmcnt(6)
    v_mfma_f32_16x16x32_bf16 v[80:83], v[112:115], v[64:67], v[80:83]
    s_cmp_eq_u32 s3, 6
    s_cbranch_scc1 L_cs49
    L_cb49:
    v_mfma_f32_16x16x32_bf16 v[96:99], v[112:115], v[68:71], v[96:99]
    ds_read_b64_tr_b16 v[112:113], v195 offset:0
    ds_read_b64_tr_b16 v[114:115], v195 offset:1024
    v_mfma_f32_16x16x32_bf16 v[84:87], v[116:119], v[64:67], v[84:87]
    s_cmp_eq_u32 s3, 7
    s_cbranch_scc1 L_cs50
    L_cb50:
    v_mfma_f32_16x16x32_bf16 v[100:103], v[116:119], v[68:71], v[100:103]
    ds_read_b64_tr_b16 v[116:117], v196 offset:0
    ds_read_b64_tr_b16 v[118:119], v196 offset:1024
    s_waitcnt vmcnt(16)
    s_waitcnt lgkmcnt(6)
    v_mfma_f32_16x16x32_bf16 v[128:131], v[120:123], v[200:203], v[128:131]
    v_mfma_f32_16x16x32_bf16 v[160:163], v[120:123], v[204:207], v[160:163]
    ds_read_b64_tr_b16 v[120:121], v197 offset:0
    ds_read_b64_tr_b16 v[122:123], v197 offset:1024
    v_mfma_f32_16x16x32_bf16 v[132:135], v[104:107], v[200:203], v[132:135]
    v_mfma_f32_16x16x32_bf16 v[164:167], v[104:107], v[204:207], v[164:167]
    ds_read_b64_tr_b16 v[104:105], v198 offset:0
    ds_read_b64_tr_b16 v[106:107], v198 offset:1024
    s_waitcnt lgkmcnt(6)
    v_mfma_f32_16x16x32_bf16 v[136:139], v[108:111], v[200:203], v[136:139]
    v_mfma_f32_16x16x32_bf16 v[168:171], v[108:111], v[204:207], v[168:171]
    ds_read_b64_tr_b16 v[108:109], v199 offset:0
    ds_read_b64_tr_b16 v[110:111], v199 offset:1024
    v_mfma_f32_16x16x32_bf16 v[140:143], v[112:115], v[200:203], v[140:143]
    v_mfma_f32_16x16x32_bf16 v[172:175], v[112:115], v[204:207], v[172:175]
    ds_read_b64_tr_b16 v[112:113], v240 offset:0
    ds_read_b64_tr_b16 v[114:115], v240 offset:512
    s_waitcnt lgkmcnt(6)
    v_mfma_f32_16x16x32_bf16 v[144:147], v[116:119], v[200:203], v[144:147]
    v_mfma_f32_16x16x32_bf16 v[176:179], v[116:119], v[204:207], v[176:179]
    ds_read_b64_tr_b16 v[116:117], v241 offset:0
    ds_read_b64_tr_b16 v[118:119], v241 offset:512
    v_mfma_f32_16x16x32_bf16 v[148:151], v[120:123], v[200:203], v[148:151]
    v_mfma_f32_16x16x32_bf16 v[180:183], v[120:123], v[204:207], v[180:183]
    ds_read_b64_tr_b16 v[120:121], v242 offset:0
    ds_read_b64_tr_b16 v[122:123], v242 offset:512
    s_waitcnt lgkmcnt(6)
    v_mfma_f32_16x16x32_bf16 v[152:155], v[104:107], v[200:203], v[152:155]
    v_mfma_f32_16x16x32_bf16 v[184:187], v[104:107], v[204:207], v[184:187]
    ds_read_b64_tr_b16 v[104:105], v243 offset:0
    ds_read_b64_tr_b16 v[106:107], v243 offset:512
    v_mfma_f32_16x16x32_bf16 v[156:159], v[108:111], v[200:203], v[156:159]
    v_mfma_f32_16x16x32_bf16 v[188:191], v[108:111], v[204:207], v[188:191]
    ds_read_b64_tr_b16 v[108:109], v192 offset:8192
    ds_read_b64_tr_b16 v[110:111], v192 offset:9216
    s_waitcnt lgkmcnt(6)
    v_mfma_f32_16x16x32_bf16 v[72:75], v[112:115], v[200:203], v[72:75]
    s_cmp_eq_u32 s3, 4
    s_cbranch_scc1 L_cs52
    L_cb52:
    v_mfma_f32_16x16x32_bf16 v[88:91], v[112:115], v[204:207], v[88:91]
    ds_read_b64_tr_b16 v[112:113], v193 offset:8192
    ds_read_b64_tr_b16 v[114:115], v193 offset:9216
    v_mfma_f32_16x16x32_bf16 v[76:79], v[116:119], v[200:203], v[76:79]
    s_cmp_eq_u32 s3, 5
    s_cbranch_scc1 L_cs53
    L_cb53:
    v_mfma_f32_16x16x32_bf16 v[92:95], v[116:119], v[204:207], v[92:95]
    ds_read_b64_tr_b16 v[116:117], v194 offset:8192
    ds_read_b64_tr_b16 v[118:119], v194 offset:9216
    s_waitcnt lgkmcnt(6)
    v_mfma_f32_16x16x32_bf16 v[80:83], v[120:123], v[200:203], v[80:83]
    s_cmp_eq_u32 s3, 6
    s_cbranch_scc1 L_cs54
    L_cb54:
    v_mfma_f32_16x16x32_bf16 v[96:99], v[120:123], v[204:207], v[96:99]
    ds_read_b64_tr_b16 v[120:121], v195 offset:8192
    ds_read_b64_tr_b16 v[122:123], v195 offset:9216
    v_mfma_f32_16x16x32_bf16 v[84:87], v[104:107], v[200:203], v[84:87]
    s_cmp_eq_u32 s3, 7
    s_cbranch_scc1 L_cs55
    L_cb55:
    v_mfma_f32_16x16x32_bf16 v[100:103], v[104:107], v[204:207], v[100:103]
    ds_read_b64_tr_b16 v[104:105], v196 offset:8192
    ds_read_b64_tr_b16 v[106:107], v196 offset:9216
    s_waitcnt vmcnt(7)
    s_waitcnt lgkmcnt(6)
    v_mfma_f32_16x16x32_bf16 v[128:131], v[108:111], v[208:211], v[128:131]
    v_mfma_f32_16x16x32_bf16 v[160:163], v[108:111], v[212:215], v[160:163]
    ds_read_b64_tr_b16 v[108:109], v197 offset:8192
    ds_read_b64_tr_b16 v[110:111], v197 offset:9216
    v_and_b32 v2, 7, v255
    v_max_u32 v2, 1, v2
    v_add_u32 v2, s5, v2
    v_and_b32 v2, 7, v2
    s_lshl_b32 s93, s4, 3
    v_add_u32 v2, s93, v2
    v_lshlrev_b32 v2, 7, v2
    v_add_u32 v2, 3145728, v2
    v_mfma_f32_16x16x32_bf16 v[132:135], v[112:115], v[208:211], v[132:135]
    v_mfma_f32_16x16x32_bf16 v[164:167], v[112:115], v[212:215], v[164:167]
    ds_read_b64_tr_b16 v[112:113], v198 offset:8192
    ds_read_b64_tr_b16 v[114:115], v198 offset:9216
    s_waitcnt lgkmcnt(6)
    v_mfma_f32_16x16x32_bf16 v[136:139], v[116:119], v[208:211], v[136:139]
    v_mfma_f32_16x16x32_bf16 v[168:171], v[116:119], v[212:215], v[168:171]
    ds_read_b64_tr_b16 v[116:117], v199 offset:8192
    ds_read_b64_tr_b16 v[118:119], v199 offset:9216
    v_mfma_f32_16x16x32_bf16 v[140:143], v[120:123], v[208:211], v[140:143]
    v_mfma_f32_16x16x32_bf16 v[172:175], v[120:123], v[212:215], v[172:175]
    ds_read_b64_tr_b16 v[120:121], v240 offset:4096
    ds_read_b64_tr_b16 v[122:123], v240 offset:4608
    s_waitcnt lgkmcnt(6)
    v_mfma_f32_16x16x32_bf16 v[144:147], v[104:107], v[208:211], v[144:147]
    v_mfma_f32_16x16x32_bf16 v[176:179], v[104:107], v[212:215], v[176:179]
    ds_read_b64_tr_b16 v[104:105], v241 offset:4096
    ds_read_b64_tr_b16 v[106:107], v241 offset:4608
    v_mfma_f32_16x16x32_bf16 v[148:151], v[108:111], v[208:211], v[148:151]
    v_mfma_f32_16x16x32_bf16 v[180:183], v[108:111], v[212:215], v[180:183]
    ds_read_b64_tr_b16 v[108:109], v242 offset:4096
    ds_read_b64_tr_b16 v[110:111], v242 offset:4608
    s_waitcnt lgkmcnt(6)
    v_mfma_f32_16x16x32_bf16 v[152:155], v[112:115], v[208:211], v[152:155]
    v_mfma_f32_16x16x32_bf16 v[184:187], v[112:115], v[212:215], v[184:187]
    ds_read_b64_tr_b16 v[112:113], v243 offset:4096
    ds_read_b64_tr_b16 v[114:115], v243 offset:4608
    v_mfma_f32_16x16x32_bf16 v[156:159], v[116:119], v[208:211], v[156:159]
    v_mfma_f32_16x16x32_bf16 v[188:191], v[116:119], v[212:215], v[188:191]
    ds_read_b64_tr_b16 v[116:117], v192 offset:16384
    ds_read_b64_tr_b16 v[118:119], v192 offset:17408
    s_waitcnt lgkmcnt(6)
    v_mfma_f32_16x16x32_bf16 v[72:75], v[120:123], v[208:211], v[72:75]
    s_cmp_eq_u32 s3, 4
    s_cbranch_scc1 L_cs56
    L_cb56:
    v_mfma_f32_16x16x32_bf16 v[88:91], v[120:123], v[212:215], v[88:91]
    ds_read_b64_tr_b16 v[120:121], v193 offset:16384
    ds_read_b64_tr_b16 v[122:123], v193 offset:17408
    v_mfma_f32_16x16x32_bf16 v[76:79], v[104:107], v[208:211], v[76:79]
    s_cmp_eq_u32 s3, 5
    s_cbranch_scc1 L_cs57
    L_cb57:
    v_mfma_f32_16x16x32_bf16 v[92:95], v[104:107], v[212:215], v[92:95]
    ds_read_b64_tr_b16 v[104:105], v194 offset:16384
    ds_read_b64_tr_b16 v[106:107], v194 offset:17408
    s_waitcnt lgkmcnt(6)
    v_mfma_f32_16x16x32_bf16 v[80:83], v[108:111], v[208:211], v[80:83]
    s_cmp_eq_u32 s3, 6
    s_cbranch_scc1 L_cs58
    L_cb58:
    v_mfma_f32_16x16x32_bf16 v[96:99], v[108:111], v[212:215], v[96:99]
    ds_read_b64_tr_b16 v[108:109], v195 offset:16384
    ds_read_b64_tr_b16 v[110:111], v195 offset:17408
    v_mfma_f32_16x16x32_bf16 v[84:87], v[112:115], v[208:211], v[84:87]
    s_cmp_eq_u32 s3, 7
    s_cbranch_scc1 L_cs59
    L_cb59:
    v_mfma_f32_16x16x32_bf16 v[100:103], v[112:115], v[212:215], v[100:103]
    ds_read_b64_tr_b16 v[112:113], v196 offset:16384
    ds_read_b64_tr_b16 v[114:115], v196 offset:17408
    s_waitcnt vmcnt(3)
    s_waitcnt lgkmcnt(6)
    v_mfma_f32_16x16x32_bf16 v[128:131], v[116:119], v[216:219], v[128:131]
    v_mfma_f32_16x16x32_bf16 v[160:163], v[116:119], v[220:223], v[160:163]
    ds_read_b64_tr_b16 v[116:117], v197 offset:16384
    ds_read_b64_tr_b16 v[118:119], v197 offset:17408
    v_mfma_f32_16x16x32_bf16 v[132:135], v[120:123], v[216:219], v[132:135]
    v_lshlrev_b32 v32, 16, v12
    v_and_b32 v33, 0xffff0000, v12
    v_lshlrev_b32 v34, 16, v13
    v_and_b32 v35, 0xffff0000, v13
    v_mfma_f32_16x16x32_bf16 v[164:167], v[120:123], v[220:223], v[164:167]
    ds_read_b64_tr_b16 v[120:121], v198 offset:16384
    ds_read_b64_tr_b16 v[122:123], v198 offset:17408
    s_waitcnt lgkmcnt(6)
    v_mfma_f32_16x16x32_bf16 v[136:139], v[104:107], v[216:219], v[136:139]
    v_mfma_f32_16x16x32_bf16 v[168:171], v[104:107], v[220:223], v[168:171]
    ds_read_b64_tr_b16 v[104:105], v199 offset:16384
    ds_read_b64_tr_b16 v[106:107], v199 offset:17408
    v_mfma_f32_16x16x32_bf16 v[140:143], v[108:111], v[216:219], v[140:143]
    v_lshlrev_b32 v36, 16, v14
    v_and_b32 v37, 0xffff0000, v14
    v_lshlrev_b32 v38, 16, v15
    v_and_b32 v39, 0xffff0000, v15
    v_mfma_f32_16x16x32_bf16 v[172:175], v[108:111], v[220:223], v[172:175]
    ds_read_b64_tr_b16 v[108:109], v240 offset:8192
    ds_read_b64_tr_b16 v[110:111], v240 offset:8704
    s_waitcnt lgkmcnt(6)
    v_mfma_f32_16x16x32_bf16 v[144:147], v[112:115], v[216:219], v[144:147]
    v_mfma_f32_16x16x32_bf16 v[176:179], v[112:115], v[220:223], v[176:179]
    ds_read_b64_tr_b16 v[112:113], v241 offset:8192
    ds_read_b64_tr_b16 v[114:115], v241 offset:8704
    v_mfma_f32_16x16x32_bf16 v[148:151], v[116:119], v[216:219], v[148:151]
    v_lshlrev_b32 v40, 16, v16
    v_and_b32 v41, 0xffff0000, v16
    v_lshlrev_b32 v42, 16, v17
    v_and_b32 v43, 0xffff0000, v17
    v_mfma_f32_16x16x32_bf16 v[180:183], v[116:119], v[220:223], v[180:183]
    ds_read_b64_tr_b16 v[116:117], v242 offset:8192
    ds_read_b64_tr_b16 v[118:119], v242 offset:8704
    s_waitcnt lgkmcnt(6)
    v_mfma_f32_16x16x32_bf16 v[152:155], v[120:123], v[216:219], v[152:155]
    v_mfma_f32_16x16x32_bf16 v[184:187], v[120:123], v[220:223], v[184:187]
    ds_read_b64_tr_b16 v[120:121], v243 offset:8192
    ds_read_b64_tr_b16 v[122:123], v243 offset:8704
    v_mfma_f32_16x16x32_bf16 v[156:159], v[104:107], v[216:219], v[156:159]
    v_lshlrev_b32 v44, 16, v18
    v_and_b32 v45, 0xffff0000, v18
    v_lshlrev_b32 v46, 16, v19
    v_and_b32 v47, 0xffff0000, v19
    v_mfma_f32_16x16x32_bf16 v[188:191], v[104:107], v[220:223], v[188:191]
    ds_read_b64_tr_b16 v[104:105], v240 offset:12288
    ds_read_b64_tr_b16 v[106:107], v240 offset:12800
    s_waitcnt lgkmcnt(6)
    v_mfma_f32_16x16x32_bf16 v[72:75], v[108:111], v[216:219], v[72:75]
    s_cmp_eq_u32 s3, 4
    s_cbranch_scc1 L_cs60
    L_cb60:
    v_mfma_f32_16x16x32_bf16 v[88:91], v[108:111], v[220:223], v[88:91]
    ds_read_b64_tr_b16 v[108:109], v241 offset:12288
    ds_read_b64_tr_b16 v[110:111], v241 offset:12800
    v_mfma_f32_16x16x32_bf16 v[76:79], v[112:115], v[216:219], v[76:79]
    s_cmp_eq_u32 s3, 5
    s_cbranch_scc1 L_cs61
    L_cb61:
    v_mfma_f32_16x16x32_bf16 v[92:95], v[112:115], v[220:223], v[92:95]
    ds_read_b64_tr_b16 v[112:113], v242 offset:12288
    ds_read_b64_tr_b16 v[114:115], v242 offset:12800
    s_waitcnt lgkmcnt(6)
    v_mfma_f32_16x16x32_bf16 v[80:83], v[116:119], v[216:219], v[80:83]
    v_lshrrev_b32 v20, 4, v255
    v_lshlrev_b32 v20, 4, v20
    s_lshl_b32 s93, s3, 6
    s_add_u32 s93, s93, 131072
    v_add_u32 v21, s93, v20
    v_add_u32 v20, 131072, v20
    s_cmp_eq_u32 s3, 6
    s_cbranch_scc1 L_cs62
    L_cb62:
    v_mfma_f32_16x16x32_bf16 v[96:99], v[116:119], v[220:223], v[96:99]
    ds_read_b64_tr_b16 v[116:117], v243 offset:12288
    ds_read_b64_tr_b16 v[118:119], v243 offset:12800
    v_mfma_f32_16x16x32_bf16 v[84:87], v[120:123], v[216:219], v[84:87]
    s_cmp_eq_u32 s3, 7
    s_cbranch_scc1 L_cs63
    L_cb63:
    v_mfma_f32_16x16x32_bf16 v[100:103], v[120:123], v[220:223], v[100:103]
    ds_read_b64_tr_b16 v[120:121], v192 offset:24576
    ds_read_b64_tr_b16 v[122:123], v192 offset:25600
    s_waitcnt vmcnt(0)
    s_waitcnt lgkmcnt(6)
    v_mfma_f32_16x16x32_bf16 v[72:75], v[104:107], v[224:227], v[72:75]
    s_cmp_eq_u32 s3, 4
    s_cbranch_scc1 L_cs64
    L_cb64:
    v_mfma_f32_16x16x32_bf16 v[88:91], v[104:107], v[228:231], v[88:91]
    ds_read_b64_tr_b16 v[104:105], v193 offset:24576
    ds_read_b64_tr_b16 v[106:107], v193 offset:25600
    s_cmp_lg_u32 s3, 0
    s_cbranch_scc1 L_p2_ni
    buffer_load_dword v1, v2, s[52:55], 0 offen sc1
    L_p2_ni:
    v_mfma_f32_16x16x32_bf16 v[76:79], v[108:111], v[224:227], v[76:79]
    s_cmp_eq_u32 s3, 5
    s_cbranch_scc1 L_cs65
    L_cb65:
    v_mfma_f32_16x16x32_bf16 v[92:95], v[108:111], v[228:231], v[92:95]
    ds_read_b64_tr_b16 v[108:109], v194 offset:24576
    ds_read_b64_tr_b16 v[110:111], v194 offset:25600
    s_waitcnt lgkmcnt(6)
    v_mfma_f32_16x16x32_bf16 v[80:83], v[112:115], v[224:227], v[80:83]
    s_cmp_eq_u32 s3, 6
    s_cbranch_scc1 L_cs66
    L_cb66:
    v_mfma_f32_16x16x32_bf16 v[96:99], v[112:115], v[228:231], v[96:99]
    ds_read_b64_tr_b16 v[112:113], v195 offset:24576
    ds_read_b64_tr_b16 v[114:115], v195 offset:25600
    v_mfma_f32_16x16x32_bf16 v[84:87], v[116:119], v[224:227], v[84:87]
    s_cmp_eq_u32 s3, 7
    s_cbranch_scc1 L_cs67
    L_cb67:
    v_mfma_f32_16x16x32_bf16 v[100:103], v[116:119], v[228:231], v[100:103]
    ds_read_b64_tr_b16 v[116:117], v196 offset:24576
    ds_read_b64_tr_b16 v[118:119], v196 offset:25600
    s_waitcnt lgkmcnt(6)
    v_mfma_f32_16x16x32_bf16 v[128:131], v[120:123], v[224:227], v[128:131]
    v_mfma_f32_16x16x32_bf16 v[160:163], v[120:123], v[228:231], v[160:163]
    ds_read_b64_tr_b16 v[120:121], v197 offset:24576
    ds_read_b64_tr_b16 v[122:123], v197 offset:25600
    v_mfma_f32_16x16x32_bf16 v[132:135], v[104:107], v[224:227], v[132:135]
    v_mfma_f32_16x16x32_bf16 v[164:167], v[104:107], v[228:231], v[164:167]
    ds_read_b64_tr_b16 v[104:105], v198 offset:24576
    ds_read_b64_tr_b16 v[106:107], v198 offset:25600
    s_waitcnt lgkmcnt(6)
    v_mfma_f32_16x16x32_bf16 v[136:139], v[108:111], v[224:227], v[136:139]
    v_mfma_f32_16x16x32_bf16 v[168:171], v[108:111], v[228:231], v[168:171]
    ds_read_b64_tr_b16 v[108:109], v199 offset:24576
    ds_read_b64_tr_b16 v[110:111], v199 offset:25600
    v_mfma_f32_16x16x32_bf16 v[140:143], v[112:115], v[224:227], v[140:143]
    v_mfma_f32_16x16x32_bf16 v[172:175], v[112:115], v[228:231], v[172:175]
    s_waitcnt lgkmcnt(4)
    v_mfma_f32_16x16x32_bf16 v[144:147], v[116:119], v[224:227], v[144:147]
    v_mfma_f32_16x16x32_bf16 v[176:179], v[116:119], v[228:231], v[176:179]
    v_mfma_f32_16x16x32_bf16 v[148:151], v[120:123], v[224:227], v[148:151]
    v_mfma_f32_16x16x32_bf16 v[180:183], v[120:123], v[228:231], v[180:183]
    s_waitcnt lgkmcnt(0)
    v_mfma_f32_16x16x32_bf16 v[152:155], v[104:107], v[224:227], v[152:155]
    v_mfma_f32_16x16x32_bf16 v[184:187], v[104:107], v[228:231], v[184:187]
    v_mfma_f32_16x16x32_bf16 v[156:159], v[108:111], v[224:227], v[156:159]
    v_mfma_f32_16x16x32_bf16 v[188:191], v[108:111], v[228:231], v[188:191]
    ds_write_b128 v21, v[124:127]
    s_waitcnt vmcnt(0) lgkmcnt(0)
    s_cmp_lg_u32 s3, 0
    s_cbranch_scc1 L_p2_np
    s_mov_b32 s90, 0
    L_pl68:
    v_cmp_gt_u32 vcc, 2, v1
    s_cbranch_vccz L_pd68
    s_add_u32 s90, s90, 1
    s_cmp_gt_u32 s90, 0x40000
    s_cbranch_scc1 L_pd68
    s_sleep 4
    buffer_load_dword v1, v2, s[52:55], 0 offen sc1
    s_waitcnt vmcnt(0)
    s_branch L_pl68
    L_pd68:
    L_p2_np:
    s_barrier
    s_cmp_eq_u32 s56, 0
    s_cbranch_scc1 L_g69
    s_add_u32 m0, s92, 0
    s_add_u32 s93, s62, 0
    buffer_load_dwordx4 v254, s[52:55], s93 offen offset:0 sc1 lds
    buffer_load_dwordx4 v254, s[52:55], s93 offen offset:1024 sc1 lds
    buffer_load_dwordx4 v254, s[52:55], s93 offen offset:2048 sc1 lds
    buffer_load_dwordx4 v254, s[52:55], s93 offen offset:3072 sc1 lds
    L_g69:
    ds_read_b128 v[200:203], v20 offset:0
    ds_read_b128 v[204:207], v20 offset:64
    ds_read_b128 v[208:211], v20 offset:128
    ds_read_b128 v[212:215], v20 offset:192
    ds_read_b128 v[216:219], v20 offset:256
    ds_read_b128 v[220:223], v20 offset:320
    ds_read_b128 v[224:227], v20 offset:384
    ds_read_b128 v[228:231], v20 offset:448
    v_mov_b32 v22, 0x3e0293ee
    v_pk_mul_f32 v[128:129], v[128:129], v[22:23] op_sel_hi:[1,0]
    v_pk_mul_f32 v[130:131], v[130:131], v[22:23] op_sel_hi:[1,0]
    v_pk_mul_f32 v[132:133], v[132:133], v[22:23] op_sel_hi:[1,0]
    v_pk_mul_f32 v[134:135], v[134:135], v[22:23] op_sel_hi:[1,0]
    v_cvt_pk_bf16_f32 v128, v128, v129
    v_cvt_pk_bf16_f32 v129, v130, v131
    v_cvt_pk_bf16_f32 v130, v132, v133
    v_cvt_pk_bf16_f32 v131, v134, v135
    v_pk_mul_f32 v[136:137], v[136:137], v[22:23] op_sel_hi:[1,0]
    v_pk_mul_f32 v[138:139], v[138:139], v[22:23] op_sel_hi:[1,0]
    v_pk_mul_f32 v[140:141], v[140:141], v[22:23] op_sel_hi:[1,0]
    v_pk_mul_f32 v[142:143], v[142:143], v[22:23] op_sel_hi:[1,0]
    v_cvt_pk_bf16_f32 v132, v136, v137
    v_cvt_pk_bf16_f32 v133, v138, v139
    v_cvt_pk_bf16_f32 v134, v140, v141
    v_cvt_pk_bf16_f32 v135, v142, v143
    v_pk_mul_f32 v[144:145], v[144:145], v[22:23] op_sel_hi:[1,0]
    v_pk_mul_f32 v[146:147], v[146:147], v[22:23] op_sel_hi:[1,0]
    v_pk_mul_f32 v[148:149], v[148:149], v[22:23] op_sel_hi:[1,0]
    v_pk_mul_f32 v[150:151], v[150:151], v[22:23] op_sel_hi:[1,0]
    v_cvt_pk_bf16_f32 v136, v144, v145
    v_cvt_pk_bf16_f32 v137, v146, v147
    v_cvt_pk_bf16_f32 v138, v148, v149
    v_cvt_pk_bf16_f32 v139, v150, v151
    v_pk_mul_f32 v[152:153], v[152:153], v[22:23] op_sel_hi:[1,0]
    v_pk_mul_f32 v[154:155], v[154:155], v[22:23] op_sel_hi:[1,0]
    v_pk_mul_f32 v[156:157], v[156:157], v[22:23] op_sel_hi:[1,0]
    v_pk_mul_f32 v[158:159], v[158:159], v[22:23] op_sel_hi:[1,0]
    v_cvt_pk_bf16_f32 v140, v152, v153
    v_cvt_pk_bf16_f32 v141, v154, v155
    v_cvt_pk_bf16_f32 v142, v156, v157
    v_cvt_pk_bf16_f32 v143, v158, v159
    v_pk_mul_f32 v[160:161], v[160:161], v[22:23] op_sel_hi:[1,0]
    v_pk_mul_f32 v[162:163], v[162:163], v[22:23] op_sel_hi:[1,0]
    v_pk_mul_f32 v[164:165], v[164:165], v[22:23] op_sel_hi:[1,0]
    v_pk_mul_f32 v[166:167], v[166:167], v[22:23] op_sel_hi:[1,0]
    v_cvt_pk_bf16_f32 v144, v160, v161
    v_cvt_pk_bf16_f32 v145, v162, v163
    v_cvt_pk_bf16_f32 v146, v164, v165
    v_cvt_pk_bf16_f32 v147, v166, v167
    v_pk_mul_f32 v[168:169], v[168:169], v[22:23] op_sel_hi:[1,0]
    v_pk_mul_f32 v[170:171], v[170:171], v[22:23] op_sel_hi:[1,0]
    v_pk_mul_f32 v[172:173], v[172:173], v[22:23] op_sel_hi:[1,0]
    v_pk_mul_f32 v[174:175], v[174:175], v[22:23] op_sel_hi:[1,0]
    v_cvt_pk_bf16_f32 v148, v168, v169
    v_cvt_pk_bf16_f32 v149, v170, v171
    v_cvt_pk_bf16_f32 v150, v172, v173
    v_cvt_pk_bf16_f32 v151, v174, v175
    v_pk_mul_f32 v[176:177], v[176:177], v[22:23] op_sel_hi:[1,0]
    v_pk_mul_f32 v[178:179], v[178:179], v[22:23] op_sel_hi:[1,0]
    v_pk_mul_f32 v[180:181], v[180:181], v[22:23] op_sel_hi:[1,0]
    v_pk_mul_f32 v[182:183], v[182:183], v[22:23] op_sel_hi:[1,0]
    v_cvt_pk_bf16_f32 v152, v176, v177
    v_cvt_pk_bf16_f32 v153, v178, v179
    v_cvt_pk_bf16_f32 v154, v180, v181
    v_cvt_pk_bf16_f32 v155, v182, v183
    v_pk_mul_f32 v[184:185], v[184:185], v[22:23] op_sel_hi:[1,0]
    v_pk_mul_f32 v[186:187], v[186:187], v[22:23] op_sel_hi:[1,0]
    v_pk_mul_f32 v[188:189], v[188:189], v[22:23] op_sel_hi:[1,0]
    v_pk_mul_f32 v[190:191], v[190:191], v[22:23] op_sel_hi:[1,0]
    v_cvt_pk_bf16_f32 v156, v184, v185
    v_cvt_pk_bf16_f32 v157, v186, v187
    v_cvt_pk_bf16_f32 v158, v188, v189
    v_cvt_pk_bf16_f32 v159, v190, v191
    s_cmp_eq_u32 s56, 0
    s_cbranch_scc1 L_g70
    s_add_u32 m0, s92, 16384
    s_add_u32 s93, s62, 16384
    buffer_load_dwordx4 v254, s[52:55], s93 offen offset:0 sc1 lds
    buffer_load_dwordx4 v254, s[52:55], s93 offen offset:1024 sc1 lds
    buffer_load_dwordx4 v254, s[52:55], s93 offen offset:2048 sc1 lds
    buffer_load_dwordx4 v254, s[52:55], s93 offen offset:3072 sc1 lds
    L_g70:
    s_cmp_eq_u32 s71, 0
    s_cbranch_scc1 L_p2_nm
    v_mov_b32 v22, 0xbdd2d3e8
    v_mov_b32 v23, 0xc0135761
    v_mov_b32 v48, 1.0
    s_waitcnt lgkmcnt(0)
    v_pk_add_f32 v[200:201], v[200:201], v[216:217]
    v_pk_add_f32 v[202:203], v[202:203], v[218:219]
    v_pk_add_f32 v[204:205], v[204:205], v[220:221]
    v_pk_add_f32 v[206:207], v[206:207], v[222:223]
    v_pk_add_f32 v[208:209], v[208:209], v[224:225]
    v_pk_add_f32 v[210:211], v[210:211], v[226:227]
    v_pk_add_f32 v[212:213], v[212:213], v[228:229]
    v_pk_add_f32 v[214:215], v[214:215], v[230:231]
    v_pk_fma_f32 v[72:73], v[8:9], v[200:201], v[72:73] op_sel_hi:[0,1,1] neg_lo:[1,0,0] neg_hi:[1,0,0]
    v_pk_fma_f32 v[74:75], v[8:9], v[202:203], v[74:75] op_sel_hi:[0,1,1] neg_lo:[1,0,0] neg_hi:[1,0,0]
    v_pk_fma_f32 v[72:73], v[72:73], v[8:9], v[32:33] op_sel:[0,1,0] op_sel_hi:[1,1,1]
    v_pk_fma_f32 v[74:75], v[74:75], v[8:9], v[34:35] op_sel:[0,1,0] op_sel_hi:[1,1,1]
    v_pk_mul_f32 v[24:25], v[72:73], v[72:73]
    v_pk_mul_f32 v[26:27], v[74:75], v[74:75]
    v_pk_fma_f32 v[24:25], v[24:25], v[22:23], v[22:23] op_sel:[0,0,1] op_sel_hi:[1,0,1]
    v_pk_fma_f32 v[26:27], v[26:27], v[22:23], v[22:23] op_sel:[0,0,1] op_sel_hi:[1,0,1]
    v_pk_mul_f32 v[24:25], v[24:25], v[72:73]
    v_pk_mul_f32 v[26:27], v[26:27], v[74:75]
    v_exp_f32 v24, v24
    v_exp_f32 v25, v25
    v_exp_f32 v26, v26
    v_exp_f32 v27, v27
    v_pk_add_f32 v[24:25], v[24:25], v[48:49] op_sel_hi:[1,0]
    v_pk_add_f32 v[26:27], v[26:27], v[48:49] op_sel_hi:[1,0]
    v_rcp_f32 v24, v24
    v_rcp_f32 v25, v25
    v_rcp_f32 v26, v26
    v_rcp_f32 v27, v27
    v_pk_mul_f32 v[72:73], v[72:73], v[24:25]
    v_pk_mul_f32 v[74:75], v[74:75], v[26:27]
    v_pk_fma_f32 v[76:77], v[8:9], v[204:205], v[76:77] op_sel_hi:[0,1,1] neg_lo:[1,0,0] neg_hi:[1,0,0]
    v_pk_fma_f32 v[78:79], v[8:9], v[206:207], v[78:79] op_sel_hi:[0,1,1] neg_lo:[1,0,0] neg_hi:[1,0,0]
    v_pk_fma_f32 v[76:77], v[76:77], v[8:9], v[36:37] op_sel:[0,1,0] op_sel_hi:[1,1,1]
    v_pk_fma_f32 v[78:79], v[78:79], v[8:9], v[38:39] op_sel:[0,1,0] op_sel_hi:[1,1,1]
    v_pk_mul_f32 v[28:29], v[76:77], v[76:77]
    v_pk_mul_f32 v[30:31], v[78:79], v[78:79]
    v_pk_fma_f32 v[28:29], v[28:29], v[22:23], v[22:23] op_sel:[0,0,1] op_sel_hi:[1,0,1]
    v_pk_fma_f32 v[30:31], v[30:31], v[22:23], v[22:23] op_sel:[0,0,1] op_sel_hi:[1,0,1]
    v_pk_mul_f32 v[28:29], v[28:29], v[76:77]
    v_pk_mul_f32 v[30:31], v[30:31], v[78:79]
    v_exp_f32 v28, v28
    v_exp_f32 v29, v29
    v_exp_f32 v30, v30
    v_exp_f32 v31, v31
    v_pk_add_f32 v[28:29], v[28:29], v[48:49] op_sel_hi:[1,0]
    v_pk_add_f32 v[30:31], v[30:31], v[48:49] op_sel_hi:[1,0]
    v_rcp_f32 v28, v28
    v_rcp_f32 v29, v29
    v_rcp_f32 v30, v30
    v_rcp_f32 v31, v31
    v_pk_mul_f32 v[76:77], v[76:77], v[28:29]
    v_pk_mul_f32 v[78:79], v[78:79], v[30:31]
    v_pk_fma_f32 v[80:81], v[8:9], v[208:209], v[80:81] op_sel_hi:[0,1,1] neg_lo:[1,0,0] neg_hi:[1,0,0]
    v_pk_fma_f32 v[82:83], v[8:9], v[210:211], v[82:83] op_sel_hi:[0,1,1] neg_lo:[1,0,0] neg_hi:[1,0,0]
    v_pk_fma_f32 v[80:81], v[80:81], v[8:9], v[40:41] op_sel:[0,1,0] op_sel_hi:[1,1,1]
    v_pk_fma_f32 v[82:83], v[82:83], v[8:9], v[42:43] op_sel:[0,1,0] op_sel_hi:[1,1,1]
    v_pk_mul_f32 v[24:25], v[80:81], v[80:81]
    v_pk_mul_f32 v[26:27], v[82:83], v[82:83]
    v_pk_fma_f32 v[24:25], v[24:25], v[22:23], v[22:23] op_sel:[0,0,1] op_sel_hi:[1,0,1]
    v_pk_fma_f32 v[26:27], v[26:27], v[22:23], v[22:23] op_sel:[0,0,1] op_sel_hi:[1,0,1]
    v_pk_mul_f32 v[24:25], v[24:25], v[80:81]
    v_pk_mul_f32 v[26:27], v[26:27], v[82:83]
    v_exp_f32 v24, v24
    v_exp_f32 v25, v25
    v_exp_f32 v26, v26
    v_exp_f32 v27, v27
    v_pk_add_f32 v[24:25], v[24:25], v[48:49] op_sel_hi:[1,0]
    v_pk_add_f32 v[26:27], v[26:27], v[48:49] op_sel_hi:[1,0]
    v_rcp_f32 v24, v24
    v_rcp_f32 v25, v25
    v_rcp_f32 v26, v26
    v_rcp_f32 v27, v27
    v_pk_mul_f32 v[80:81], v[80:81], v[24:25]
    v_pk_mul_f32 v[82:83], v[82:83], v[26:27]
    v_pk_fma_f32 v[84:85], v[8:9], v[212:213], v[84:85] op_sel_hi:[0,1,1] neg_lo:[1,0,0] neg_hi:[1,0,0]
    v_pk_fma_f32 v[86:87], v[8:9], v[214:215], v[86:87] op_sel_hi:[0,1,1] neg_lo:[1,0,0] neg_hi:[1,0,0]
    v_pk_fma_f32 v[84:85], v[84:85], v[8:9], v[44:45] op_sel:[0,1,0] op_sel_hi:[1,1,1]
    v_pk_fma_f32 v[86:87], v[86:87], v[8:9], v[46:47] op_sel:[0,1,0] op_sel_hi:[1,1,1]
    v_pk_mul_f32 v[28:29], v[84:85], v[84:85]
    v_pk_mul_f32 v[30:31], v[86:87], v[86:87]
    v_pk_fma_f32 v[28:29], v[28:29], v[22:23], v[22:23] op_sel:[0,0,1] op_sel_hi:[1,0,1]
    v_pk_fma_f32 v[30:31], v[30:31], v[22:23], v[22:23] op_sel:[0,0,1] op_sel_hi:[1,0,1]
    v_pk_mul_f32 v[28:29], v[28:29], v[84:85]
    v_pk_mul_f32 v[30:31], v[30:31], v[86:87]
    v_exp_f32 v28, v28
    v_exp_f32 v29, v29
    v_exp_f32 v30, v30
    v_exp_f32 v31, v31
    v_pk_add_f32 v[28:29], v[28:29], v[48:49] op_sel_hi:[1,0]
    v_pk_add_f32 v[30:31], v[30:31], v[48:49] op_sel_hi:[1,0]
    v_rcp_f32 v28, v28
    v_rcp_f32 v29, v29
    v_rcp_f32 v30, v30
    v_rcp_f32 v31, v31
    v_pk_mul_f32 v[84:85], v[84:85], v[28:29]
    v_pk_mul_f32 v[86:87], v[86:87], v[30:31]
    v_pk_fma_f32 v[88:89], v[10:11], v[200:201], v[88:89] op_sel_hi:[0,1,1] neg_lo:[1,0,0] neg_hi:[1,0,0]
    v_pk_fma_f32 v[90:91], v[10:11], v[202:203], v[90:91] op_sel_hi:[0,1,1] neg_lo:[1,0,0] neg_hi:[1,0,0]
    v_pk_fma_f32 v[88:89], v[88:89], v[10:11], v[32:33] op_sel:[0,1,0] op_sel_hi:[1,1,1]
    v_pk_fma_f32 v[90:91], v[90:91], v[10:11], v[34:35] op_sel:[0,1,0] op_sel_hi:[1,1,1]
    v_pk_mul_f32 v[24:25], v[88:89], v[88:89]
    v_pk_mul_f32 v[26:27], v[90:91], v[90:91]
    v_pk_fma_f32 v[24:25], v[24:25], v[22:23], v[22:23] op_sel:[0,0,1] op_sel_hi:[1,0,1]
    v_pk_fma_f32 v[26:27], v[26:27], v[22:23], v[22:23] op_sel:[0,0,1] op_sel_hi:[1,0,1]
    v_pk_mul_f32 v[24:25], v[24:25], v[88:89]
    v_pk_mul_f32 v[26:27], v[26:27], v[90:91]
    v_exp_f32 v24, v24
    v_exp_f32 v25, v25
    v_exp_f32 v26, v26
    v_exp_f32 v27, v27
    v_pk_add_f32 v[24:25], v[24:25], v[48:49] op_sel_hi:[1,0]
    v_pk_add_f32 v[26:27], v[26:27], v[48:49] op_sel_hi:[1,0]
    v_rcp_f32 v24, v24
    v_rcp_f32 v25, v25
    v_rcp_f32 v26, v26
    v_rcp_f32 v27, v27
    v_pk_mul_f32 v[88:89], v[88:89], v[24:25]
    v_pk_mul_f32 v[90:91], v[90:91], v[26:27]
    v_pk_fma_f32 v[92:93], v[10:11], v[204:205], v[92:93] op_sel_hi:[0,1,1] neg_lo:[1,0,0] neg_hi:[1,0,0]
    v_pk_fma_f32 v[94:95], v[10:11], v[206:207], v[94:95] op_sel_hi:[0,1,1] neg_lo:[1,0,0] neg_hi:[1,0,0]
    v_pk_fma_f32 v[92:93], v[92:93], v[10:11], v[36:37] op_sel:[0,1,0] op_sel_hi:[1,1,1]
    v_pk_fma_f32 v[94:95], v[94:95], v[10:11], v[38:39] op_sel:[0,1,0] op_sel_hi:[1,1,1]
    v_pk_mul_f32 v[28:29], v[92:93], v[92:93]
    v_pk_mul_f32 v[30:31], v[94:95], v[94:95]
    v_pk_fma_f32 v[28:29], v[28:29], v[22:23], v[22:23] op_sel:[0,0,1] op_sel_hi:[1,0,1]
    v_pk_fma_f32 v[30:31], v[30:31], v[22:23], v[22:23] op_sel:[0,0,1] op_sel_hi:[1,0,1]
    v_pk_mul_f32 v[28:29], v[28:29], v[92:93]
    v_pk_mul_f32 v[30:31], v[30:31], v[94:95]
    v_exp_f32 v28, v28
    v_exp_f32 v29, v29
    v_exp_f32 v30, v30
    v_exp_f32 v31, v31
    v_pk_add_f32 v[28:29], v[28:29], v[48:49] op_sel_hi:[1,0]
    v_pk_add_f32 v[30:31], v[30:31], v[48:49] op_sel_hi:[1,0]
    v_rcp_f32 v28, v28
    v_rcp_f32 v29, v29
    v_rcp_f32 v30, v30
    v_rcp_f32 v31, v31
    v_pk_mul_f32 v[92:93], v[92:93], v[28:29]
    v_pk_mul_f32 v[94:95], v[94:95], v[30:31]
    v_pk_fma_f32 v[96:97], v[10:11], v[208:209], v[96:97] op_sel_hi:[0,1,1] neg_lo:[1,0,0] neg_hi:[1,0,0]
    v_pk_fma_f32 v[98:99], v[10:11], v[210:211], v[98:99] op_sel_hi:[0,1,1] neg_lo:[1,0,0] neg_hi:[1,0,0]
    v_pk_fma_f32 v[96:97], v[96:97], v[10:11], v[40:41] op_sel:[0,1,0] op_sel_hi:[1,1,1]
    v_pk_fma_f32 v[98:99], v[98:99], v[10:11], v[42:43] op_sel:[0,1,0] op_sel_hi:[1,1,1]
    v_pk_mul_f32 v[24:25], v[96:97], v[96:97]
    v_pk_mul_f32 v[26:27], v[98:99], v[98:99]
    v_pk_fma_f32 v[24:25], v[24:25], v[22:23], v[22:23] op_sel:[0,0,1] op_sel_hi:[1,0,1]
    v_pk_fma_f32 v[26:27], v[26:27], v[22:23], v[22:23] op_sel:[0,0,1] op_sel_hi:[1,0,1]
    v_pk_mul_f32 v[24:25], v[24:25], v[96:97]
    v_pk_mul_f32 v[26:27], v[26:27], v[98:99]
    v_exp_f32 v24, v24
    v_exp_f32 v25, v25
    v_exp_f32 v26, v26
    v_exp_f32 v27, v27
    v_pk_add_f32 v[24:25], v[24:25], v[48:49] op_sel_hi:[1,0]
    v_pk_add_f32 v[26:27], v[26:27], v[48:49] op_sel_hi:[1,0]
    v_rcp_f32 v24, v24
    v_rcp_f32 v25, v25
    v_rcp_f32 v26, v26
    v_rcp_f32 v27, v27
    v_pk_mul_f32 v[96:97], v[96:97], v[24:25]
    v_pk_mul_f32 v[98:99], v[98:99], v[26:27]
    v_pk_fma_f32 v[100:101], v[10:11], v[212:213], v[100:101] op_sel_hi:[0,1,1] neg_lo:[1,0,0] neg_hi:[1,0,0]
    v_pk_fma_f32 v[102:103], v[10:11], v[214:215], v[102:103] op_sel_hi:[0,1,1] neg_lo:[1,0,0] neg_hi:[1,0,0]
    v_pk_fma_f32 v[100:101], v[100:101], v[10:11], v[44:45] op_sel:[0,1,0] op_sel_hi:[1,1,1]
    v_pk_fma_f32 v[102:103], v[102:103], v[10:11], v[46:47] op_sel:[0,1,0] op_sel_hi:[1,1,1]
    v_pk_mul_f32 v[28:29], v[100:101], v[100:101]
    v_pk_mul_f32 v[30:31], v[102:103], v[102:103]
    v_pk_fma_f32 v[28:29], v[28:29], v[22:23], v[22:23] op_sel:[0,0,1] op_sel_hi:[1,0,1]
    v_pk_fma_f32 v[30:31], v[30:31], v[22:23], v[22:23] op_sel:[0,0,1] op_sel_hi:[1,0,1]
    v_pk_mul_f32 v[28:29], v[28:29], v[100:101]
    v_pk_mul_f32 v[30:31], v[30:31], v[102:103]
    v_exp_f32 v28, v28
    v_exp_f32 v29, v29
    v_exp_f32 v30, v30
    v_exp_f32 v31, v31
    v_pk_add_f32 v[28:29], v[28:29], v[48:49] op_sel_hi:[1,0]
    v_pk_add_f32 v[30:31], v[30:31], v[48:49] op_sel_hi:[1,0]
    v_rcp_f32 v28, v28
    v_rcp_f32 v29, v29
    v_rcp_f32 v30, v30
    v_rcp_f32 v31, v31
    v_pk_mul_f32 v[100:101], v[100:101], v[28:29]
    v_pk_mul_f32 v[102:103], v[102:103], v[30:31]
    v_cvt_pk_bf16_f32 v176, v72, v73
    v_cvt_pk_bf16_f32 v177, v74, v75
    v_cvt_pk_bf16_f32 v178, v76, v77
    v_cvt_pk_bf16_f32 v179, v78, v79
    v_cvt_pk_bf16_f32 v180, v88, v89
    v_cvt_pk_bf16_f32 v181, v90, v91
    v_cvt_pk_bf16_f32 v182, v92, v93
    v_cvt_pk_bf16_f32 v183, v94, v95
    v_cvt_pk_bf16_f32 v184, v80, v81
    v_cvt_pk_bf16_f32 v185, v82, v83
    v_cvt_pk_bf16_f32 v186, v84, v85
    v_cvt_pk_bf16_f32 v187, v86, v87
    v_cvt_pk_bf16_f32 v188, v96, v97
    v_cvt_pk_bf16_f32 v189, v98, v99
    v_cvt_pk_bf16_f32 v190, v100, v101
    v_cvt_pk_bf16_f32 v191, v102, v103
L_p2_nm:
    s_cmp_eq_u32 s56, 0
    s_cbranch_scc1 L_g71
    s_add_u32 m0, s92, 65536
    s_add_u32 s93, s63, 0
    buffer_load_dwordx4 v254, s[52:55], s93 offen offset:0 sc1 lds
    buffer_load_dwordx4 v254, s[52:55], s93 offen offset:1024 sc1 lds
    buffer_load_dwordx4 v254, s[52:55], s93 offen offset:2048 sc1 lds
    buffer_load_dwordx4 v254, s[52:55], s93 offen offset:3072 sc1 lds
    s_add_u32 m0, s92, 32768
    s_add_u32 s93, s62, 32768
    buffer_load_dwordx4 v254, s[52:55], s93 offen offset:0 sc1 lds
    buffer_load_dwordx4 v254, s[52:55], s93 offen offset:1024 sc1 lds
    buffer_load_dwordx4 v254, s[52:55], s93 offen offset:2048 sc1 lds
    buffer_load_dwordx4 v254, s[52:55], s93 offen offset:3072 sc1 lds
    L_g71:
    s_mul_i32 s66, s99, 175104
    s_lshl_b32 s93, s86, 11
    s_add_u32 s66, s66, s93
    s_add_u32 s66, s66, 37879808
    s_add_u32 s67, s66, 175104
    s_cmp_lt_u32 s86, 21
    s_cselect_b32 s68, s66, s82
    s_cselect_b32 s69, s67, s82
    s_cmp_lt_u32 s86, 22
    s_cselect_b32 s66, s66, s82
    s_cselect_b32 s67, s67, s82
    v_xor_b32 v244, 0x8000, v254
    s_mov_b32 s88, 49152
    s_mov_b32 s89, 65536
    s_mov_b32 s96, 0x53800000
    s_mov_b32 s97, 0xff7fffff
    s_mov_b32 s98, 0
    s_mov_b32 s61, -1
    s_mov_b32 s79, 0
    s_sub_u32 s77, s59, 2
    s_min_u32 s78, s77, 10
    s_cmp_eq_u32 s56, 0
    s_cselect_b32 s78, 4, s78
    v_lshlrev_b32 v251, 7, v255
    s_bfe_u32 s64, s2, 0x40003
    s_lshl_b32 s64, s64, 3
    s_and_b32 s65, s2, 7
    s_add_u32 s64, s64, s65
    s_lshl_b32 s76, s64, 2
    s_add_u32 s76, s76, s57
    s_lshl_b32 s76, s76, 13
    s_lshl_b32 s7, s64, 1
    s_add_u32 s7, s7, s57
    s_lshl_b32 s7, s7, 13
    s_cmp_lt_u32 s57, 2
    s_cselect_b32 s7, s7, 1073741824
    s_cmp_ge_u32 s5, 4
    s_cselect_b32 s7, s7, 1073741824
    s_cselect_b32 s76, s76, 1073741824
    s_waitcnt vmcnt(12) lgkmcnt(0)
    s_barrier
    v_xor_b32 v244, 0x8000, v244
    ds_read_b128 v[192:195], v244 offset:0
    ds_read_b128 v[196:199], v244 offset:1024
    ds_read_b128 v[200:203], v244 offset:2048
    ds_read_b128 v[204:207], v244 offset:3072
    ds_read_b128 v[208:211], v244 offset:4096
    ds_read_b128 v[212:215], v244 offset:5120
    ds_read_b128 v[216:219], v244 offset:6144
    ds_read_b128 v[220:223], v244 offset:7168
    s_waitcnt lgkmcnt(6)
    v_mfma_f32_16x16x32_bf16 v[64:67], v[192:195], v[128:131], 0
    v_mov_b32 v247, 0xf149f2ca
    s_and_b32 s93, s57, 1
    s_lshl_b32 s93, s93, 5
    v_mfma_f32_16x16x32_bf16 v[68:71], v[192:195], v[144:147], 0
    ds_read_b128 v[192:195], v244 offset:8192
    v_and_b32 v233, 15, v255
    v_lshrrev_b32 v232, 4, v255
    v_mfma_f32_16x16x32_bf16 v[64:67], v[196:199], v[132:135], v[64:67]
    v_lshlrev_b32 v232, 2, v232
    v_sub_u32 v233, v233, v232
    v_add_u32 v246, s93, v233
    v_mfma_f32_16x16x32_bf16 v[68:71], v[196:199], v[148:151], v[68:71]
    ds_read_b128 v[196:199], v244 offset:9216
    v_cmp_ge_i32 s[80:81], v233, 0
    v_cmp_ge_i32 s[82:83], v233, 1
    s_waitcnt lgkmcnt(6)
    v_mfma_f32_16x16x32_bf16 v[64:67], v[200:203], v[136:139], v[64:67]
    v_cmp_ge_i32 s[84:85], v233, 2
    v_cmp_ge_i32 s[86:87], v233, 3
    v_mov_b32 v0, 0
    v_mfma_f32_16x16x32_bf16 v[68:71], v[200:203], v[152:155], v[68:71]
    ds_read_b128 v[200:203], v244 offset:10240
    v_mov_b32 v1, 0
    v_mov_b32 v2, 0
    v_mfma_f32_16x16x32_bf16 v[64:67], v[204:207], v[140:143], v[64:67]
    v_mov_b32 v3, 0
    v_mov_b32 v4, 0
    v_mov_b32 v5, 0
    v_mfma_f32_16x16x32_bf16 v[68:71], v[204:207], v[156:159], v[68:71]
    ds_read_b128 v[204:207], v244 offset:11264
    v_mov_b32 v6, 0
    v_mov_b32 v7, 0
    s_waitcnt lgkmcnt(6)
    v_mfma_f32_16x16x32_bf16 v[72:75], v[208:211], v[128:131], 0
    v_mov_b32 v8, 0
    v_mov_b32 v9, 0
    v_mfma_f32_16x16x32_bf16 v[76:79], v[208:211], v[144:147], 0
    ds_read_b128 v[208:211], v244 offset:12288
    v_mov_b32 v10, 0
    v_mov_b32 v11, 0
    v_mov_b32 v12, 0
    v_mfma_f32_16x16x32_bf16 v[72:75], v[212:215], v[132:135], v[72:75]
    v_mov_b32 v13, 0
    v_mov_b32 v14, 0
    v_mfma_f32_16x16x32_bf16 v[76:79], v[212:215], v[148:151], v[76:79]
    ds_read_b128 v[212:215], v244 offset:13312
    v_mov_b32 v15, 0
    v_mov_b32 v16, 0
    v_mov_b32 v17, 0
    s_waitcnt lgkmcnt(6)
    v_mfma_f32_16x16x32_bf16 v[72:75], v[216:219], v[136:139], v[72:75]
    v_mov_b32 v18, 0
    v_mov_b32 v19, 0
    v_mfma_f32_16x16x32_bf16 v[76:79], v[216:219], v[152:155], v[76:79]
    ds_read_b128 v[216:219], v244 offset:14336
    v_mov_b32 v20, 0
    v_mov_b32 v21, 0
    v_mov_b32 v22, 0
    v_mfma_f32_16x16x32_bf16 v[72:75], v[220:223], v[140:143], v[72:75]
    v_mov_b32 v23, 0
    v_mov_b32 v24, 0
    v_mfma_f32_16x16x32_bf16 v[76:79], v[220:223], v[156:159], v[76:79]
    ds_read_b128 v[220:223], v244 offset:15360
    v_mov_b32 v25, 0
    v_mov_b32 v26, 0
    s_waitcnt lgkmcnt(6)
    v_mfma_f32_16x16x32_bf16 v[80:83], v[192:195], v[128:131], 0
    v_mov_b32 v27, 0
    v_mov_b32 v28, 0
    v_mov_b32 v29, 0
    v_mfma_f32_16x16x32_bf16 v[84:87], v[192:195], v[144:147], 0
    v_mov_b32 v30, 0
    v_mov_b32 v31, 0
    v_mfma_f32_16x16x32_bf16 v[80:83], v[196:199], v[132:135], v[80:83]
    v_mov_b32 v32, 0
    v_mov_b32 v33, 0
    v_mov_b32 v34, 0
    v_mfma_f32_16x16x32_bf16 v[84:87], v[196:199], v[148:151], v[84:87]
    v_mov_b32 v35, 0
    v_mov_b32 v36, 0
    s_waitcnt lgkmcnt(4)
    v_mfma_f32_16x16x32_bf16 v[80:83], v[200:203], v[136:139], v[80:83]
    v_mov_b32 v37, 0
    v_mov_b32 v38, 0
    v_mov_b32 v39, 0
    v_mfma_f32_16x16x32_bf16 v[84:87], v[200:203], v[152:155], v[84:87]
    v_mov_b32 v40, 0
    v_mov_b32 v41, 0
    v_mfma_f32_16x16x32_bf16 v[80:83], v[204:207], v[140:143], v[80:83]
    v_mov_b32 v42, 0
    v_mov_b32 v43, 0
    v_mov_b32 v44, 0
    v_mfma_f32_16x16x32_bf16 v[84:87], v[204:207], v[156:159], v[84:87]
    v_mov_b32 v45, 0
    v_mov_b32 v46, 0
    s_waitcnt lgkmcnt(2)
    v_mfma_f32_16x16x32_bf16 v[88:91], v[208:211], v[128:131], 0
    v_mov_b32 v47, 0
    v_mov_b32 v48, 0
    v_mfma_f32_16x16x32_bf16 v[92:95], v[208:211], v[144:147], 0
    v_mov_b32 v49, 0
    v_mov_b32 v50, 0
    v_mov_b32 v51, 0
    v_mfma_f32_16x16x32_bf16 v[88:91], v[212:215], v[132:135], v[88:91]
    v_mov_b32 v52, 0
    v_mov_b32 v53, 0
    v_mfma_f32_16x16x32_bf16 v[92:95], v[212:215], v[148:151], v[92:95]
    v_mov_b32 v54, 0
    v_mov_b32 v55, 0
    v_mov_b32 v56, 0
    s_waitcnt lgkmcnt(0)
    v_mfma_f32_16x16x32_bf16 v[88:91], v[216:219], v[136:139], v[88:91]
    v_mov_b32 v57, 0
    v_mov_b32 v58, 0
    v_mfma_f32_16x16x32_bf16 v[92:95], v[216:219], v[152:155], v[92:95]
    v_mov_b32 v59, 0
    v_mov_b32 v60, 0
    v_mov_b32 v61, 0
    v_mfma_f32_16x16x32_bf16 v[88:91], v[220:223], v[140:143], v[88:91]
    v_mov_b32 v62, 0
    v_mov_b32 v63, 0
    v_mfma_f32_16x16x32_bf16 v[92:95], v[220:223], v[156:159], v[92:95]
    v_mov_b32 v240, 0
    v_mov_b32 v241, 0
    s_cmp_eq_u32 s56, 0
    s_cbranch_scc1 L_sa76
    s_waitcnt vmcnt(0)
    s_barrier
    s_add_u32 s93, s61, 2
    s_cmp_ge_i32 s93, s60
    s_cbranch_scc1 L_sb76
    s_add_u32 s93, s61, 4
    s_and_b32 s100, s93, 3
    s_lshl_b32 s100, s100, 14
    s_add_u32 m0, s100, s92
    s_lshl_b32 s101, s93, 14
    s_add_u32 s101, s101, s62
    s_cmp_lt_i32 s93, s60
    s_cselect_b32 s101, s101, 1073741824
    buffer_load_dwordx4 v254, s[52:55], s101 offen offset:0 sc1 lds
    buffer_load_dwordx4 v254, s[52:55], s101 offen offset:1024 sc1 lds
    buffer_load_dwordx4 v254, s[52:55], s101 offen offset:2048 sc1 lds
    buffer_load_dwordx4 v254, s[52:55], s101 offen offset:3072 sc1 lds
    s_add_u32 s93, s61, 5
    s_and_b32 s100, s93, 3
    s_lshl_b32 s100, s100, 14
    s_add_u32 m0, s100, s92
    s_lshl_b32 s101, s93, 14
    s_add_u32 s101, s101, s62
    s_cmp_lt_i32 s93, s60
    s_cselect_b32 s101, s101, 1073741824
    buffer_load_dwordx4 v254, s[52:55], s101 offen offset:0 sc1 lds
    buffer_load_dwordx4 v254, s[52:55], s101 offen offset:1024 sc1 lds
    buffer_load_dwordx4 v254, s[52:55], s101 offen offset:2048 sc1 lds
    buffer_load_dwordx4 v254, s[52:55], s101 offen offset:3072 sc1 lds
    s_add_u32 s89, s89, 16384
    s_cmp_eq_u32 s89, 147456
    s_cselect_b32 s89, 65536, s89
    s_add_u32 s93, s61, 2
    s_add_u32 m0, s92, s89
    s_lshl_b32 s101, s93, 14
    s_add_u32 s101, s101, s63
    s_cmp_lt_i32 s93, s60
    s_cselect_b32 s101, s101, 1073741824
    buffer_load_dwordx4 v254, s[52:55], s101 offen offset:0 sc1 lds
    buffer_load_dwordx4 v254, s[52:55], s101 offen offset:1024 sc1 lds
    buffer_load_dwordx4 v254, s[52:55], s101 offen offset:2048 sc1 lds
    buffer_load_dwordx4 v254, s[52:55], s101 offen offset:3072 sc1 lds
    s_add_u32 s89, s89, 16384
    s_cmp_eq_u32 s89, 147456
    s_cselect_b32 s89, 65536, s89
    s_add_u32 s93, s61, 3
    s_add_u32 m0, s92, s89
    s_lshl_b32 s101, s93, 14
    s_add_u32 s101, s101, s63
    s_cmp_lt_i32 s93, s60
    s_cselect_b32 s101, s101, 1073741824
    buffer_load_dwordx4 v254, s[52:55], s101 offen offset:0 sc1 lds
    buffer_load_dwordx4 v254, s[52:55], s101 offen offset:1024 sc1 lds
    buffer_load_dwordx4 v254, s[52:55], s101 offen offset:2048 sc1 lds
    buffer_load_dwordx4 v254, s[52:55], s101 offen offset:3072 sc1 lds
    buffer_load_dword v249, v251, s[32:35], s7 offen
    s_branch L_sb76
    L_sa76:
    s_barrier
    L_sb76:
    s_mov_b32 s61, 0
    s_cmp_eq_u32 s59, 1
    s_cbranch_scc1 L_att_n1
    s_nop 3
    v_max3_f32 v236, v64, v65, v66
    v_max3_f32 v236, v236, v67, v72
    v_max3_f32 v236, v236, v73, v74
    v_max3_f32 v236, v236, v75, v80
    v_max3_f32 v236, v236, v81, v82
    v_max3_f32 v236, v236, v83, v88
    v_max3_f32 v236, v236, v89, v90
    v_max_f32 v236, v236, v91
    v_max3_f32 v237, v68, v69, v70
    v_max3_f32 v237, v237, v71, v76
    v_max3_f32 v237, v237, v77, v78
    v_max3_f32 v237, v237, v79, v84
    v_max3_f32 v237, v237, v85, v86
    v_max3_f32 v237, v237, v87, v92
    v_max3_f32 v237, v237, v93, v94
    v_max_f32 v237, v237, v95
    v_mov_b32 v232, v236
    v_mov_b32 v233, v237
    s_nop 1
    v_permlane16_swap_b32 v236, v232
    v_permlane16_swap_b32 v237, v233
    v_max_f32 v236, v236, v232
    v_max_f32 v237, v237, v233
    v_mov_b32 v232, v236
    v_mov_b32 v233, v237
    s_nop 1
    v_permlane32_swap_b32 v236, v232
    v_permlane32_swap_b32 v237, v233
    v_max_f32 v236, v236, v232
    v_max_f32 v237, v237, v233
    v_sub_f32 v224, 0, v236
    v_sub_f32 v225, 0, v236
    v_sub_f32 v226, 0, v236
    v_sub_f32 v227, 0, v236
    v_sub_f32 v228, 0, v237
    v_sub_f32 v229, 0, v237
    v_sub_f32 v230, 0, v237
    v_sub_f32 v231, 0, v237
    s_mov_b32 s97, 0
    ds_read_b128 v[192:195], v244 offset:16384
    ds_read_b128 v[196:199], v244 offset:17408
    ds_read_b128 v[200:203], v244 offset:18432
    ds_read_b128 v[204:207], v244 offset:19456
    ds_read_b128 v[208:211], v244 offset:20480
    ds_read_b128 v[212:215], v244 offset:21504
    ds_read_b128 v[216:219], v244 offset:22528
    ds_read_b128 v[220:223], v244 offset:23552
    s_waitcnt lgkmcnt(6)
    v_mfma_f32_16x16x32_bf16 v[96:99], v[192:195], v[128:131], v[224:227]
    v_sub_f32 v232, v64, v236
    v_sub_f32 v233, v65, v236
    v_exp_f32 v232, v232
    v_exp_f32 v233, v233
    v_mfma_f32_16x16x32_bf16 v[100:103], v[192:195], v[144:147], v[228:231]
    ds_read_b128 v[192:195], v244 offset:24576
    v_add_f32 v238, v232, v233
    v_cvt_pk_bf16_f32 v160, v232, v233
    v_mfma_f32_16x16x32_bf16 v[96:99], v[196:199], v[132:135], v[96:99]
    v_sub_f32 v234, v66, v236
    v_sub_f32 v235, v67, v236
    v_exp_f32 v234, v234
    v_exp_f32 v235, v235
    v_mfma_f32_16x16x32_bf16 v[100:103], v[196:199], v[148:151], v[100:103]
    ds_read_b128 v[196:199], v244 offset:25600
    v_add_f32 v238, v238, v234
    v_add_f32 v238, v238, v235
    v_cvt_pk_bf16_f32 v161, v234, v235
    s_waitcnt lgkmcnt(6)
    v_mfma_f32_16x16x32_bf16 v[96:99], v[200:203], v[136:139], v[96:99]
    v_sub_f32 v232, v72, v236
    v_sub_f32 v233, v73, v236
    v_exp_f32 v232, v232
    v_exp_f32 v233, v233
    v_mfma_f32_16x16x32_bf16 v[100:103], v[200:203], v[152:155], v[100:103]
    ds_read_b128 v[200:203], v244 offset:26624
    v_add_f32 v238, v238, v232
    v_add_f32 v238, v238, v233
    v_cvt_pk_bf16_f32 v162, v232, v233
    buffer_store_dwordx4 v[176:179], v254, s[52:55], s66 offen offset:0 sc1
    v_mfma_f32_16x16x32_bf16 v[96:99], v[204:207], v[140:143], v[96:99]
    v_sub_f32 v234, v74, v236
    v_sub_f32 v235, v75, v236
    v_exp_f32 v234, v234
    v_exp_f32 v235, v235
    v_mfma_f32_16x16x32_bf16 v[100:103], v[204:207], v[156:159], v[100:103]
    ds_read_b128 v[204:207], v244 offset:27648
    v_add_f32 v238, v238, v234
    v_add_f32 v238, v238, v235
    v_cvt_pk_bf16_f32 v163, v234, v235
    s_waitcnt lgkmcnt(6)
    v_mfma_f32_16x16x32_bf16 v[104:107], v[208:211], v[128:131], v[224:227]
    v_sub_f32 v232, v80, v236
    v_sub_f32 v233, v81, v236
    v_exp_f32 v232, v232
    v_exp_f32 v233, v233
    v_mfma_f32_16x16x32_bf16 v[108:111], v[208:211], v[144:147], v[228:231]
    ds_read_b128 v[208:211], v244 offset:28672
    v_add_f32 v238, v238, v232
    v_add_f32 v238, v238, v233
    v_cvt_pk_bf16_f32 v168, v232, v233
    v_mfma_f32_16x16x32_bf16 v[104:107], v[212:215], v[132:135], v[104:107]
    v_sub_f32 v234, v82, v236
    v_sub_f32 v235, v83, v236
    v_exp_f32 v234, v234
    v_exp_f32 v235, v235
    v_mfma_f32_16x16x32_bf16 v[108:111], v[212:215], v[148:151], v[108:111]
    ds_read_b128 v[212:215], v244 offset:29696
    v_add_f32 v238, v238, v234
    v_add_f32 v238, v238, v235
    v_cvt_pk_bf16_f32 v169, v234, v235
    s_waitcnt lgkmcnt(6)
    v_mfma_f32_16x16x32_bf16 v[104:107], v[216:219], v[136:139], v[104:107]
    v_sub_f32 v232, v88, v236
    v_sub_f32 v233, v89, v236
    v_exp_f32 v232, v232
    v_exp_f32 v233, v233
    buffer_store_dwordx4 v[180:183], v254, s[52:55], s67 offen offset:0 sc1
    v_mfma_f32_16x16x32_bf16 v[108:111], v[216:219], v[152:155], v[108:111]
    ds_read_b128 v[216:219], v244 offset:30720
    v_add_f32 v238, v238, v232
    v_add_f32 v238, v238, v233
    v_cvt_pk_bf16_f32 v170, v232, v233
    v_mfma_f32_16x16x32_bf16 v[104:107], v[220:223], v[140:143], v[104:107]
    v_sub_f32 v234, v90, v236
    v_sub_f32 v235, v91, v236
    v_exp_f32 v234, v234
    v_exp_f32 v235, v235
    v_mfma_f32_16x16x32_bf16 v[108:111], v[220:223], v[156:159], v[108:111]
    ds_read_b128 v[220:223], v244 offset:31744
    v_add_f32 v238, v238, v234
    v_add_f32 v238, v238, v235
    v_cvt_pk_bf16_f32 v171, v234, v235
    s_waitcnt lgkmcnt(6)
    v_mfma_f32_16x16x32_bf16 v[112:115], v[192:195], v[128:131], v[224:227]
    v_sub_f32 v232, v68, v237
    v_sub_f32 v233, v69, v237
    v_exp_f32 v232, v232
    v_exp_f32 v233, v233
    v_mfma_f32_16x16x32_bf16 v[116:119], v[192:195], v[144:147], v[228:231]
    v_add_f32 v239, v232, v233
    v_cvt_pk_bf16_f32 v164, v232, v233
    v_mfma_f32_16x16x32_bf16 v[112:115], v[196:199], v[132:135], v[112:115]
    v_sub_f32 v234, v70, v237
    v_sub_f32 v235, v71, v237
    v_exp_f32 v234, v234
    v_exp_f32 v235, v235
    v_mfma_f32_16x16x32_bf16 v[116:119], v[196:199], v[148:151], v[116:119]
    v_add_f32 v239, v239, v234
    v_add_f32 v239, v239, v235
    v_cvt_pk_bf16_f32 v165, v234, v235
    buffer_store_dwordx4 v[184:187], v254, s[52:55], s68 offen offset:1024 sc1
    s_waitcnt lgkmcnt(4)
    v_mfma_f32_16x16x32_bf16 v[112:115], v[200:203], v[136:139], v[112:115]
    v_sub_f32 v232, v76, v237
    v_sub_f32 v233, v77, v237
    v_exp_f32 v232, v232
    v_exp_f32 v233, v233
    v_mfma_f32_16x16x32_bf16 v[116:119], v[200:203], v[152:155], v[116:119]
    v_add_f32 v239, v239, v232
    v_add_f32 v239, v239, v233
    v_cvt_pk_bf16_f32 v166, v232, v233
    v_mfma_f32_16x16x32_bf16 v[112:115], v[204:207], v[140:143], v[112:115]
    v_sub_f32 v234, v78, v237
    v_sub_f32 v235, v79, v237
    v_exp_f32 v234, v234
    v_exp_f32 v235, v235
    v_mfma_f32_16x16x32_bf16 v[116:119], v[204:207], v[156:159], v[116:119]
    v_add_f32 v239, v239, v234
    v_add_f32 v239, v239, v235
    v_cvt_pk_bf16_f32 v167, v234, v235
    s_waitcnt lgkmcnt(2)
    v_mfma_f32_16x16x32_bf16 v[120:123], v[208:211], v[128:131], v[224:227]
    v_sub_f32 v232, v84, v237
    v_sub_f32 v233, v85, v237
    v_exp_f32 v232, v232
    v_exp_f32 v233, v233
    v_mfma_f32_16x16x32_bf16 v[124:127], v[208:211], v[144:147], v[228:231]
    v_add_f32 v239, v239, v232
    v_add_f32 v239, v239, v233
    v_cvt_pk_bf16_f32 v172, v232, v233
    v_mfma_f32_16x16x32_bf16 v[120:123], v[212:215], v[132:135], v[120:123]
    v_sub_f32 v234, v86, v237
    v_sub_f32 v235, v87, v237
    v_exp_f32 v234, v234
    v_exp_f32 v235, v235
    buffer_store_dwordx4 v[188:191], v254, s[52:55], s69 offen offset:1024 sc1
    v_mfma_f32_16x16x32_bf16 v[124:127], v[212:215], v[148:151], v[124:127]
    v_add_f32 v239, v239, v234
    v_add_f32 v239, v239, v235
    v_cvt_pk_bf16_f32 v173, v234, v235
    s_waitcnt lgkmcnt(0)
    v_mfma_f32_16x16x32_bf16 v[120:123], v[216:219], v[136:139], v[120:123]
    v_sub_f32 v232, v92, v237
    v_sub_f32 v233, v93, v237
    v_exp_f32 v232, v232
    v_exp_f32 v233, v233
    v_mfma_f32_16x16x32_bf16 v[124:127], v[216:219], v[152:155], v[124:127]
    v_add_f32 v239, v239, v232
    v_add_f32 v239, v239, v233
    v_cvt_pk_bf16_f32 v174, v232, v233
    v_mfma_f32_16x16x32_bf16 v[120:123], v[220:223], v[140:143], v[120:123]
    v_sub_f32 v234, v94, v237
    v_sub_f32 v235, v95, v237
    v_exp_f32 v234, v234
    v_exp_f32 v235, v235
    v_mfma_f32_16x16x32_bf16 v[124:127], v[220:223], v[156:159], v[124:127]
    v_add_f32 v239, v239, v234
    v_add_f32 v239, v239, v235
    v_cvt_pk_bf16_f32 v175, v234, v235
    s_branch L_att_i0
L_att_n1:
    buffer_store_dwordx4 v[176:179], v254, s[52:55], s66 offen offset:0 sc1
    buffer_store_dwordx4 v[180:183], v254, s[52:55], s67 offen offset:0 sc1
    buffer_store_dwordx4 v[184:187], v254, s[52:55], s68 offen offset:1024 sc1
    buffer_store_dwordx4 v[188:191], v254, s[52:55], s69 offen offset:1024 sc1
    s_mov_b32 s98, 1
    s_call_b64 s[94:95], L_exact0
L_att_i0:
    s_mov_b32 s61, 1
    s_cmp_eq_u32 s59, 1
    s_cbranch_scc1 L_att_last0
    s_cmp_eq_u32 s59, 2
    s_cbranch_scc1 L_att_tail1
    s_cmp_lg_u32 s56, 0
    s_cbranch_scc1 L_att_g1
    v_xor_b32 v244, 0x8000, v244
    ds_read_b128 v[192:195], v244 offset:0
    ds_read_b128 v[196:199], v244 offset:1024
    ds_read_b128 v[200:203], v244 offset:2048
    ds_read_b128 v[204:207], v244 offset:3072
    ds_read_b128 v[208:211], v244 offset:4096
    ds_read_b128 v[212:215], v244 offset:5120
    ds_read_b128 v[216:219], v244 offset:6144
    ds_read_b128 v[220:223], v244 offset:7168
.p2align 6
L_att_loop0:
    s_waitcnt lgkmcnt(4)
    v_mfma_f32_16x16x32_bf16 v[64:67], v[192:195], v[128:131], v[224:227]
    v_exp_f32 v232, v96
    v_mfma_f32_16x16x32_bf16 v[68:71], v[192:195], v[144:147], v[228:231]
    ds_read_b128 v[192:195], v244 offset:8192
    v_exp_f32 v233, v97
    v_mfma_f32_16x16x32_bf16 v[64:67], v[196:199], v[132:135], v[64:67]
    v_add_f32 v242, v232, v233
    v_mfma_f32_16x16x32_bf16 v[68:71], v[196:199], v[148:151], v[68:71]
    ds_read_b128 v[196:199], v244 offset:9216
    v_cvt_pk_bf16_f32 v176, v232, v233
    v_mfma_f32_16x16x32_bf16 v[64:67], v[200:203], v[136:139], v[64:67]
    v_exp_f32 v234, v98
    v_mfma_f32_16x16x32_bf16 v[68:71], v[200:203], v[152:155], v[68:71]
    ds_read_b128 v[200:203], v244 offset:10240
    v_exp_f32 v235, v99
    v_mfma_f32_16x16x32_bf16 v[64:67], v[204:207], v[140:143], v[64:67]
    v_add_f32 v242, v242, v234
    v_add_f32 v242, v242, v235
    v_mfma_f32_16x16x32_bf16 v[68:71], v[204:207], v[156:159], v[68:71]
    ds_read_b128 v[204:207], v244 offset:11264
    v_cvt_pk_bf16_f32 v177, v234, v235
    s_waitcnt lgkmcnt(4)
    v_mfma_f32_16x16x32_bf16 v[72:75], v[208:211], v[128:131], v[224:227]
    v_exp_f32 v232, v104
    v_mfma_f32_16x16x32_bf16 v[76:79], v[208:211], v[144:147], v[228:231]
    ds_read_b128 v[208:211], v244 offset:12288
    v_exp_f32 v233, v105
    v_mfma_f32_16x16x32_bf16 v[72:75], v[212:215], v[132:135], v[72:75]
    v_add_f32 v242, v242, v232
    v_add_f32 v242, v242, v233
    v_cvt_pk_bf16_f32 v178, v232, v233
    v_mfma_f32_16x16x32_bf16 v[76:79], v[212:215], v[148:151], v[76:79]
    ds_read_b128 v[212:215], v244 offset:13312
    v_exp_f32 v234, v106
    v_mfma_f32_16x16x32_bf16 v[72:75], v[216:219], v[136:139], v[72:75]
    v_exp_f32 v235, v107
    v_mfma_f32_16x16x32_bf16 v[76:79], v[216:219], v[152:155], v[76:79]
    ds_read_b128 v[216:219], v244 offset:14336
    v_add_f32 v242, v242, v234
    v_add_f32 v242, v242, v235
    v_mfma_f32_16x16x32_bf16 v[72:75], v[220:223], v[140:143], v[72:75]
    v_cvt_pk_bf16_f32 v179, v234, v235
    v_mfma_f32_16x16x32_bf16 v[76:79], v[220:223], v[156:159], v[76:79]
    ds_read_b128 v[220:223], v244 offset:15360
    v_exp_f32 v232, v112
    s_waitcnt lgkmcnt(4)
    v_mfma_f32_16x16x32_bf16 v[80:83], v[192:195], v[128:131], v[224:227]
    v_exp_f32 v233, v113
    v_mfma_f32_16x16x32_bf16 v[84:87], v[192:195], v[144:147], v[228:231]
    s_add_u32 s88, s88, 16384
    s_cmp_eq_u32 s88, 147456
    s_cselect_b32 s88, 65536, s88
    v_add_u32 v245, s88, v254
    v_add_f32 v242, v242, v232
    v_add_f32 v242, v242, v233
    v_mfma_f32_16x16x32_bf16 v[80:83], v[196:199], v[132:135], v[80:83]
    ds_read_b128 v[192:195], v245 offset:0
    v_cvt_pk_bf16_f32 v184, v232, v233
    v_mfma_f32_16x16x32_bf16 v[84:87], v[196:199], v[148:151], v[84:87]
    ds_read_b128 v[196:199], v245 offset:1024
    v_exp_f32 v234, v114
    v_mfma_f32_16x16x32_bf16 v[80:83], v[200:203], v[136:139], v[80:83]
    v_exp_f32 v235, v115
    v_mfma_f32_16x16x32_bf16 v[84:87], v[200:203], v[152:155], v[84:87]
    ds_read_b128 v[200:203], v245 offset:2048
    v_add_f32 v242, v242, v234
    v_add_f32 v242, v242, v235
    v_cvt_pk_bf16_f32 v185, v234, v235
    v_mfma_f32_16x16x32_bf16 v[80:83], v[204:207], v[140:143], v[80:83]
    v_exp_f32 v232, v120
    v_mfma_f32_16x16x32_bf16 v[84:87], v[204:207], v[156:159], v[84:87]
    ds_read_b128 v[204:207], v245 offset:3072
    v_exp_f32 v233, v121
    s_waitcnt lgkmcnt(4)
    v_mfma_f32_16x16x32_bf16 v[88:91], v[208:211], v[128:131], v[224:227]
    v_add_f32 v242, v242, v232
    v_add_f32 v242, v242, v233
    v_mfma_f32_16x16x32_bf16 v[92:95], v[208:211], v[144:147], v[228:231]
    ds_read_b128 v[208:211], v245 offset:4096
    v_cvt_pk_bf16_f32 v186, v232, v233
    v_mfma_f32_16x16x32_bf16 v[88:91], v[212:215], v[132:135], v[88:91]
    v_exp_f32 v234, v122
    v_mfma_f32_16x16x32_bf16 v[92:95], v[212:215], v[148:151], v[92:95]
    ds_read_b128 v[212:215], v245 offset:5120
    v_exp_f32 v235, v123
    v_mfma_f32_16x16x32_bf16 v[88:91], v[216:219], v[136:139], v[88:91]
    v_add_f32 v242, v242, v234
    v_add_f32 v242, v242, v235
    v_mfma_f32_16x16x32_bf16 v[92:95], v[216:219], v[152:155], v[92:95]
    ds_read_b128 v[216:219], v245 offset:6144
    v_cvt_pk_bf16_f32 v187, v234, v235
    v_mfma_f32_16x16x32_bf16 v[88:91], v[220:223], v[140:143], v[88:91]
    v_exp_f32 v232, v100
    v_mfma_f32_16x16x32_bf16 v[92:95], v[220:223], v[156:159], v[92:95]
    ds_read_b128 v[220:223], v245 offset:7168
    v_exp_f32 v233, v101
    s_barrier
    s_waitcnt lgkmcnt(4)
    v_mfma_f32_16x16x32_bf16 v[0:3], v[192:195], v[160:163], v[0:3]
    v_add_f32 v243, v232, v233
    v_mfma_f32_16x16x32_bf16 v[4:7], v[192:195], v[164:167], v[4:7]
    ds_read_b128 v[192:195], v245 offset:8192
    v_cvt_pk_bf16_f32 v180, v232, v233
    v_mfma_f32_16x16x32_bf16 v[8:11], v[196:199], v[160:163], v[8:11]
    v_exp_f32 v234, v102
    v_mfma_f32_16x16x32_bf16 v[12:15], v[196:199], v[164:167], v[12:15]
    ds_read_b128 v[196:199], v245 offset:9216
    v_exp_f32 v235, v103
    v_mfma_f32_16x16x32_bf16 v[16:19], v[200:203], v[160:163], v[16:19]
    v_add_f32 v243, v243, v234
    v_add_f32 v243, v243, v235
    v_mfma_f32_16x16x32_bf16 v[20:23], v[200:203], v[164:167], v[20:23]
    ds_read_b128 v[200:203], v245 offset:10240
    v_cvt_pk_bf16_f32 v181, v234, v235
    v_mfma_f32_16x16x32_bf16 v[24:27], v[204:207], v[160:163], v[24:27]
    v_exp_f32 v232, v108
    v_mfma_f32_16x16x32_bf16 v[28:31], v[204:207], v[164:167], v[28:31]
    ds_read_b128 v[204:207], v245 offset:11264
    v_exp_f32 v233, v109
    s_waitcnt lgkmcnt(4)
    v_mfma_f32_16x16x32_bf16 v[32:35], v[208:211], v[160:163], v[32:35]
    v_add_f32 v243, v243, v232
    v_add_f32 v243, v243, v233
    v_cvt_pk_bf16_f32 v182, v232, v233
    v_mfma_f32_16x16x32_bf16 v[36:39], v[208:211], v[164:167], v[36:39]
    ds_read_b128 v[208:211], v245 offset:12288
    v_exp_f32 v234, v110
    v_mfma_f32_16x16x32_bf16 v[40:43], v[212:215], v[160:163], v[40:43]
    v_exp_f32 v235, v111
    v_mfma_f32_16x16x32_bf16 v[44:47], v[212:215], v[164:167], v[44:47]
    ds_read_b128 v[212:215], v245 offset:13312
    v_add_f32 v243, v243, v234
    v_add_f32 v243, v243, v235
    v_mfma_f32_16x16x32_bf16 v[48:51], v[216:219], v[160:163], v[48:51]
    v_cvt_pk_bf16_f32 v183, v234, v235
    v_mfma_f32_16x16x32_bf16 v[52:55], v[216:219], v[164:167], v[52:55]
    ds_read_b128 v[216:219], v245 offset:14336
    v_exp_f32 v232, v116
    v_mfma_f32_16x16x32_bf16 v[56:59], v[220:223], v[160:163], v[56:59]
    v_exp_f32 v233, v117
    v_mfma_f32_16x16x32_bf16 v[60:63], v[220:223], v[164:167], v[60:63]
    ds_read_b128 v[220:223], v245 offset:15360
    v_add_f32 v243, v243, v232
    v_add_f32 v243, v243, v233
    s_waitcnt lgkmcnt(4)
    v_mfma_f32_16x16x32_bf16 v[0:3], v[192:195], v[168:171], v[0:3]
    v_cvt_pk_bf16_f32 v188, v232, v233
    v_mfma_f32_16x16x32_bf16 v[4:7], v[192:195], v[172:175], v[4:7]
    ds_read_b128 v[192:195], v244 offset:16384
    v_exp_f32 v234, v118
    v_mfma_f32_16x16x32_bf16 v[8:11], v[196:199], v[168:171], v[8:11]
    v_exp_f32 v235, v119
    v_mfma_f32_16x16x32_bf16 v[12:15], v[196:199], v[172:175], v[12:15]
    ds_read_b128 v[196:199], v244 offset:17408
    v_add_f32 v243, v243, v234
    v_add_f32 v243, v243, v235
    v_cvt_pk_bf16_f32 v189, v234, v235
    v_mfma_f32_16x16x32_bf16 v[16:19], v[200:203], v[168:171], v[16:19]
    v_exp_f32 v232, v124
    v_mfma_f32_16x16x32_bf16 v[20:23], v[200:203], v[172:175], v[20:23]
    ds_read_b128 v[200:203], v244 offset:18432
    v_exp_f32 v233, v125
    v_mfma_f32_16x16x32_bf16 v[24:27], v[204:207], v[168:171], v[24:27]
    v_add_f32 v243, v243, v232
    v_add_f32 v243, v243, v233
    v_mfma_f32_16x16x32_bf16 v[28:31], v[204:207], v[172:175], v[28:31]
    ds_read_b128 v[204:207], v244 offset:19456
    v_cvt_pk_bf16_f32 v190, v232, v233
    s_waitcnt lgkmcnt(4)
    v_mfma_f32_16x16x32_bf16 v[32:35], v[208:211], v[168:171], v[32:35]
    v_exp_f32 v234, v126
    v_mfma_f32_16x16x32_bf16 v[36:39], v[208:211], v[172:175], v[36:39]
    ds_read_b128 v[208:211], v244 offset:20480
    v_exp_f32 v235, v127
    v_mfma_f32_16x16x32_bf16 v[40:43], v[212:215], v[168:171], v[40:43]
    v_add_f32 v243, v243, v234
    v_add_f32 v243, v243, v235
    v_mfma_f32_16x16x32_bf16 v[44:47], v[212:215], v[172:175], v[44:47]
    ds_read_b128 v[212:215], v244 offset:21504
    v_cvt_pk_bf16_f32 v191, v234, v235
    v_mfma_f32_16x16x32_bf16 v[48:51], v[216:219], v[168:171], v[48:51]
    v_add_f32 v236, v242, v243
    v_add_f32 v240, v238, v242
    v_mfma_f32_16x16x32_bf16 v[52:55], v[216:219], v[172:175], v[52:55]
    ds_read_b128 v[216:219], v244 offset:22528
    v_cmp_nge_f32 vcc, s96, v236
    v_add_f32 v241, v239, v243
    v_mfma_f32_16x16x32_bf16 v[56:59], v[220:223], v[168:171], v[56:59]
    s_add_u32 s61, s61, 1
    s_cmp_gt_u32 s61, s77
    v_mfma_f32_16x16x32_bf16 v[60:63], v[220:223], v[172:175], v[60:63]
    ds_read_b128 v[220:223], v244 offset:23552
    s_cbranch_vccnz L_att_sl01
L_att_bk01:
    s_cbranch_scc1 L_att_tail0
    s_waitcnt lgkmcnt(4)
    v_mfma_f32_16x16x32_bf16 v[96:99], v[192:195], v[128:131], v[224:227]
    v_exp_f32 v232, v64
    v_mfma_f32_16x16x32_bf16 v[100:103], v[192:195], v[144:147], v[228:231]
    ds_read_b128 v[192:195], v244 offset:24576
    v_exp_f32 v233, v65
    v_mfma_f32_16x16x32_bf16 v[96:99], v[196:199], v[132:135], v[96:99]
    v_add_f32 v242, v232, v233
    v_mfma_f32_16x16x32_bf16 v[100:103], v[196:199], v[148:151], v[100:103]
    ds_read_b128 v[196:199], v244 offset:25600
    v_cvt_pk_bf16_f32 v160, v232, v233
    v_mfma_f32_16x16x32_bf16 v[96:99], v[200:203], v[136:139], v[96:99]
    v_exp_f32 v234, v66
    v_mfma_f32_16x16x32_bf16 v[100:103], v[200:203], v[152:155], v[100:103]
    ds_read_b128 v[200:203], v244 offset:26624
    v_exp_f32 v235, v67
    v_mfma_f32_16x16x32_bf16 v[96:99], v[204:207], v[140:143], v[96:99]
    v_add_f32 v242, v242, v234
    v_add_f32 v242, v242, v235
    v_mfma_f32_16x16x32_bf16 v[100:103], v[204:207], v[156:159], v[100:103]
    ds_read_b128 v[204:207], v244 offset:27648
    v_cvt_pk_bf16_f32 v161, v234, v235
    s_waitcnt lgkmcnt(4)
    v_mfma_f32_16x16x32_bf16 v[104:107], v[208:211], v[128:131], v[224:227]
    v_exp_f32 v232, v72
    v_mfma_f32_16x16x32_bf16 v[108:111], v[208:211], v[144:147], v[228:231]
    ds_read_b128 v[208:211], v244 offset:28672
    v_exp_f32 v233, v73
    v_mfma_f32_16x16x32_bf16 v[104:107], v[212:215], v[132:135], v[104:107]
    v_add_f32 v242, v242, v232
    v_add_f32 v242, v242, v233
    v_cvt_pk_bf16_f32 v162, v232, v233
    v_mfma_f32_16x16x32_bf16 v[108:111], v[212:215], v[148:151], v[108:111]
    ds_read_b128 v[212:215], v244 offset:29696
    v_exp_f32 v234, v74
    v_mfma_f32_16x16x32_bf16 v[104:107], v[216:219], v[136:139], v[104:107]
    v_exp_f32 v235, v75
    v_mfma_f32_16x16x32_bf16 v[108:111], v[216:219], v[152:155], v[108:111]
    ds_read_b128 v[216:219], v244 offset:30720
    v_add_f32 v242, v242, v234
    v_add_f32 v242, v242, v235
    v_mfma_f32_16x16x32_bf16 v[104:107], v[220:223], v[140:143], v[104:107]
    v_cvt_pk_bf16_f32 v163, v234, v235
    v_mfma_f32_16x16x32_bf16 v[108:111], v[220:223], v[156:159], v[108:111]
    ds_read_b128 v[220:223], v244 offset:31744
    v_exp_f32 v232, v80
    s_waitcnt lgkmcnt(4)
    v_mfma_f32_16x16x32_bf16 v[112:115], v[192:195], v[128:131], v[224:227]
    v_exp_f32 v233, v81
    v_mfma_f32_16x16x32_bf16 v[116:119], v[192:195], v[144:147], v[228:231]
    s_add_u32 s88, s88, 16384
    s_cmp_eq_u32 s88, 147456
    s_cselect_b32 s88, 65536, s88
    v_add_u32 v245, s88, v254
    v_add_f32 v242, v242, v232
    v_add_f32 v242, v242, v233
    v_mfma_f32_16x16x32_bf16 v[112:115], v[196:199], v[132:135], v[112:115]
    ds_read_b128 v[192:195], v245 offset:0
    v_cvt_pk_bf16_f32 v168, v232, v233
    v_mfma_f32_16x16x32_bf16 v[116:119], v[196:199], v[148:151], v[116:119]
    ds_read_b128 v[196:199], v245 offset:1024
    v_exp_f32 v234, v82
    v_mfma_f32_16x16x32_bf16 v[112:115], v[200:203], v[136:139], v[112:115]
    v_exp_f32 v235, v83
    v_mfma_f32_16x16x32_bf16 v[116:119], v[200:203], v[152:155], v[116:119]
    ds_read_b128 v[200:203], v245 offset:2048
    v_add_f32 v242, v242, v234
    v_add_f32 v242, v242, v235
    v_cvt_pk_bf16_f32 v169, v234, v235
    v_mfma_f32_16x16x32_bf16 v[112:115], v[204:207], v[140:143], v[112:115]
    v_exp_f32 v232, v88
    v_mfma_f32_16x16x32_bf16 v[116:119], v[204:207], v[156:159], v[116:119]
    ds_read_b128 v[204:207], v245 offset:3072
    v_exp_f32 v233, v89
    s_waitcnt lgkmcnt(4)
    v_mfma_f32_16x16x32_bf16 v[120:123], v[208:211], v[128:131], v[224:227]
    v_add_f32 v242, v242, v232
    v_add_f32 v242, v242, v233
    v_mfma_f32_16x16x32_bf16 v[124:127], v[208:211], v[144:147], v[228:231]
    ds_read_b128 v[208:211], v245 offset:4096
    v_cvt_pk_bf16_f32 v170, v232, v233
    v_mfma_f32_16x16x32_bf16 v[120:123], v[212:215], v[132:135], v[120:123]
    v_exp_f32 v234, v90
    v_mfma_f32_16x16x32_bf16 v[124:127], v[212:215], v[148:151], v[124:127]
    ds_read_b128 v[212:215], v245 offset:5120
    v_exp_f32 v235, v91
    v_mfma_f32_16x16x32_bf16 v[120:123], v[216:219], v[136:139], v[120:123]
    v_add_f32 v242, v242, v234
    v_add_f32 v242, v242, v235
    v_mfma_f32_16x16x32_bf16 v[124:127], v[216:219], v[152:155], v[124:127]
    ds_read_b128 v[216:219], v245 offset:6144
    v_cvt_pk_bf16_f32 v171, v234, v235
    v_mfma_f32_16x16x32_bf16 v[120:123], v[220:223], v[140:143], v[120:123]
    v_exp_f32 v232, v68
    v_mfma_f32_16x16x32_bf16 v[124:127], v[220:223], v[156:159], v[124:127]
    ds_read_b128 v[220:223], v245 offset:7168
    v_exp_f32 v233, v69
    s_waitcnt lgkmcnt(4)
    v_mfma_f32_16x16x32_bf16 v[0:3], v[192:195], v[176:179], v[0:3]
    v_add_f32 v243, v232, v233
    v_mfma_f32_16x16x32_bf16 v[4:7], v[192:195], v[180:183], v[4:7]
    ds_read_b128 v[192:195], v245 offset:8192
    v_cvt_pk_bf16_f32 v164, v232, v233
    v_mfma_f32_16x16x32_bf16 v[8:11], v[196:199], v[176:179], v[8:11]
    v_exp_f32 v234, v70
    v_mfma_f32_16x16x32_bf16 v[12:15], v[196:199], v[180:183], v[12:15]
    ds_read_b128 v[196:199], v245 offset:9216
    v_exp_f32 v235, v71
    v_mfma_f32_16x16x32_bf16 v[16:19], v[200:203], v[176:179], v[16:19]
    v_add_f32 v243, v243, v234
    v_add_f32 v243, v243, v235
    v_mfma_f32_16x16x32_bf16 v[20:23], v[200:203], v[180:183], v[20:23]
    ds_read_b128 v[200:203], v245 offset:10240
    v_cvt_pk_bf16_f32 v165, v234, v235
    v_mfma_f32_16x16x32_bf16 v[24:27], v[204:207], v[176:179], v[24:27]
    v_exp_f32 v232, v76
    v_mfma_f32_16x16x32_bf16 v[28:31], v[204:207], v[180:183], v[28:31]
    ds_read_b128 v[204:207], v245 offset:11264
    v_exp_f32 v233, v77
    s_waitcnt lgkmcnt(4)
    v_mfma_f32_16x16x32_bf16 v[32:35], v[208:211], v[176:179], v[32:35]
    v_add_f32 v243, v243, v232
    v_add_f32 v243, v243, v233
    v_cvt_pk_bf16_f32 v166, v232, v233
    v_mfma_f32_16x16x32_bf16 v[36:39], v[208:211], v[180:183], v[36:39]
    ds_read_b128 v[208:211], v245 offset:12288
    v_exp_f32 v234, v78
    v_mfma_f32_16x16x32_bf16 v[40:43], v[212:215], v[176:179], v[40:43]
    v_exp_f32 v235, v79
    v_mfma_f32_16x16x32_bf16 v[44:47], v[212:215], v[180:183], v[44:47]
    ds_read_b128 v[212:215], v245 offset:13312
    v_add_f32 v243, v243, v234
    v_add_f32 v243, v243, v235
    v_mfma_f32_16x16x32_bf16 v[48:51], v[216:219], v[176:179], v[48:51]
    v_cvt_pk_bf16_f32 v167, v234, v235
    v_mfma_f32_16x16x32_bf16 v[52:55], v[216:219], v[180:183], v[52:55]
    ds_read_b128 v[216:219], v245 offset:14336
    v_exp_f32 v232, v84
    v_mfma_f32_16x16x32_bf16 v[56:59], v[220:223], v[176:179], v[56:59]
    v_exp_f32 v233, v85
    v_mfma_f32_16x16x32_bf16 v[60:63], v[220:223], v[180:183], v[60:63]
    ds_read_b128 v[220:223], v245 offset:15360
    v_add_f32 v243, v243, v232
    v_add_f32 v243, v243, v233
    s_waitcnt lgkmcnt(4)
    v_mfma_f32_16x16x32_bf16 v[0:3], v[192:195], v[184:187], v[0:3]
    v_cvt_pk_bf16_f32 v172, v232, v233
    v_mfma_f32_16x16x32_bf16 v[4:7], v[192:195], v[188:191], v[4:7]
    v_xor_b32 v244, 0x8000, v244
    v_exp_f32 v234, v86
    v_mfma_f32_16x16x32_bf16 v[8:11], v[196:199], v[184:187], v[8:11]
    ds_read_b128 v[192:195], v244 offset:0
    v_exp_f32 v235, v87
    v_mfma_f32_16x16x32_bf16 v[12:15], v[196:199], v[188:191], v[12:15]
    ds_read_b128 v[196:199], v244 offset:1024
    v_add_f32 v243, v243, v234
    v_add_f32 v243, v243, v235
    v_cvt_pk_bf16_f32 v173, v234, v235
    v_mfma_f32_16x16x32_bf16 v[16:19], v[200:203], v[184:187], v[16:19]
    v_exp_f32 v232, v92
    v_mfma_f32_16x16x32_bf16 v[20:23], v[200:203], v[188:191], v[20:23]
    ds_read_b128 v[200:203], v244 offset:2048
    v_exp_f32 v233, v93
    v_mfma_f32_16x16x32_bf16 v[24:27], v[204:207], v[184:187], v[24:27]
    v_add_f32 v243, v243, v232
    v_add_f32 v243, v243, v233
    v_mfma_f32_16x16x32_bf16 v[28:31], v[204:207], v[188:191], v[28:31]
    ds_read_b128 v[204:207], v244 offset:3072
    v_cvt_pk_bf16_f32 v174, v232, v233
    s_waitcnt lgkmcnt(4)
    v_mfma_f32_16x16x32_bf16 v[32:35], v[208:211], v[184:187], v[32:35]
    v_exp_f32 v234, v94
    v_mfma_f32_16x16x32_bf16 v[36:39], v[208:211], v[188:191], v[36:39]
    ds_read_b128 v[208:211], v244 offset:4096
    v_exp_f32 v235, v95
    v_mfma_f32_16x16x32_bf16 v[40:43], v[212:215], v[184:187], v[40:43]
    v_add_f32 v243, v243, v234
    v_add_f32 v243, v243, v235
    v_mfma_f32_16x16x32_bf16 v[44:47], v[212:215], v[188:191], v[44:47]
    ds_read_b128 v[212:215], v244 offset:5120
    v_cvt_pk_bf16_f32 v175, v234, v235
    v_mfma_f32_16x16x32_bf16 v[48:51], v[216:219], v[184:187], v[48:51]
    v_add_f32 v236, v242, v243
    v_add_f32 v238, v240, v242
    v_mfma_f32_16x16x32_bf16 v[52:55], v[216:219], v[188:191], v[52:55]
    ds_read_b128 v[216:219], v244 offset:6144
    v_cmp_nge_f32 vcc, s96, v236
    v_add_f32 v239, v241, v243
    v_mfma_f32_16x16x32_bf16 v[56:59], v[220:223], v[184:187], v[56:59]
    s_add_u32 s61, s61, 1
    s_cmp_gt_u32 s61, s78
    v_mfma_f32_16x16x32_bf16 v[60:63], v[220:223], v[188:191], v[60:63]
    ds_read_b128 v[220:223], v244 offset:7168
    s_cbranch_vccnz L_att_sl00
L_att_bk00:
    s_cbranch_scc0 L_att_loop0
    s_cmp_gt_u32 s61, s77
    s_cbranch_scc1 L_att_tail1
    s_cmp_lg_u32 s61, 9
    s_cbranch_scc1 L_ev0
    s_waitcnt vmcnt(0)
    s_mov_b32 s78, s77
    s_branch L_ev9
    L_ev0:
    s_mov_b32 s78, 8
    s_and_b32 s64, s2, 3
    s_bfe_u32 s65, s2, 0x10002
    s_lshl_b32 s65, s65, 3
    s_bfe_u32 s93, s2, 0x30003
    s_add_u32 s65, s65, s93
    s_lshr_b32 s66, s2, 6
    s_lshl_b32 s65, s65, 2
    s_add_u32 s65, s65, s66
    s_lshl_b32 s65, s65, 17
    s_add_u32 s65, s65, 67108864
    s_lshl_b32 s66, s64, 13
    s_add_u32 s65, s65, s66
    s_lshl_b32 s66, s3, 11
    s_add_u32 s65, s65, s66
    v_mov_b32 v248, -1
    v_mov_b32 v249, -1
    v_mov_b32 v250, -1
    v_mov_b32 v251, -1
    s_add_u32 s93, s64, 1
    s_and_b32 s93, s93, 3
    s_lshl_b32 s93, s93, 15
    s_add_u32 s93, s93, s65
    buffer_store_dwordx4 v[248:251], v254, s[52:55], s93 offen offset:0 sc1
    buffer_store_dwordx4 v[248:251], v254, s[52:55], s93 offen offset:1024 sc1
    s_add_u32 s93, s64, 2
    s_and_b32 s93, s93, 3
    s_lshl_b32 s93, s93, 15
    s_add_u32 s93, s93, s65
    buffer_store_dwordx4 v[248:251], v254, s[52:55], s93 offen offset:0 sc1
    buffer_store_dwordx4 v[248:251], v254, s[52:55], s93 offen offset:1024 sc1
    s_add_u32 s93, s64, 3
    s_and_b32 s93, s93, 3
    s_lshl_b32 s93, s93, 15
    s_add_u32 s93, s93, s65
    buffer_store_dwordx4 v[248:251], v254, s[52:55], s93 offen offset:0 sc1
    buffer_store_dwordx4 v[248:251], v254, s[52:55], s93 offen offset:1024 sc1
    L_ev9:
    s_branch L_att_loop0
L_att_g1:
    s_setprio 1
    v_xor_b32 v244, 0x8000, v244
    ds_read_b128 v[192:195], v244 offset:0
    ds_read_b128 v[196:199], v244 offset:1024
    ds_read_b128 v[200:203], v244 offset:2048
    ds_read_b128 v[204:207], v244 offset:3072
    ds_read_b128 v[208:211], v244 offset:4096
    ds_read_b128 v[212:215], v244 offset:5120
    ds_read_b128 v[216:219], v244 offset:6144
    ds_read_b128 v[220:223], v244 offset:7168
.p2align 6
L_att_loop1:
    s_waitcnt lgkmcnt(4)
    v_mfma_f32_16x16x32_bf16 v[64:67], v[192:195], v[128:131], v[224:227]
    v_exp_f32 v232, v96
    v_mfma_f32_16x16x32_bf16 v[68:71], v[192:195], v[144:147], v[228:231]
    ds_read_b128 v[192:195], v244 offset:8192
    v_exp_f32 v233, v97
    v_mfma_f32_16x16x32_bf16 v[64:67], v[196:199], v[132:135], v[64:67]
    v_add_f32 v242, v232, v233
    v_mfma_f32_16x16x32_bf16 v[68:71], v[196:199], v[148:151], v[68:71]
    ds_read_b128 v[196:199], v244 offset:9216
    v_cvt_pk_bf16_f32 v176, v232, v233
    v_mfma_f32_16x16x32_bf16 v[64:67], v[200:203], v[136:139], v[64:67]
    v_exp_f32 v234, v98
    v_mfma_f32_16x16x32_bf16 v[68:71], v[200:203], v[152:155], v[68:71]
    ds_read_b128 v[200:203], v244 offset:10240
    v_exp_f32 v235, v99
    v_mfma_f32_16x16x32_bf16 v[64:67], v[204:207], v[140:143], v[64:67]
    v_add_f32 v242, v242, v234
    v_add_f32 v242, v242, v235
    v_mfma_f32_16x16x32_bf16 v[68:71], v[204:207], v[156:159], v[68:71]
    ds_read_b128 v[204:207], v244 offset:11264
    v_cvt_pk_bf16_f32 v177, v234, v235
    s_waitcnt lgkmcnt(4)
    v_mfma_f32_16x16x32_bf16 v[72:75], v[208:211], v[128:131], v[224:227]
    v_exp_f32 v232, v104
    v_mfma_f32_16x16x32_bf16 v[76:79], v[208:211], v[144:147], v[228:231]
    ds_read_b128 v[208:211], v244 offset:12288
    v_exp_f32 v233, v105
    v_mfma_f32_16x16x32_bf16 v[72:75], v[212:215], v[132:135], v[72:75]
    v_add_f32 v242, v242, v232
    v_add_f32 v242, v242, v233
    v_cvt_pk_bf16_f32 v178, v232, v233
    v_mfma_f32_16x16x32_bf16 v[76:79], v[212:215], v[148:151], v[76:79]
    ds_read_b128 v[212:215], v244 offset:13312
    v_exp_f32 v234, v106
    v_mfma_f32_16x16x32_bf16 v[72:75], v[216:219], v[136:139], v[72:75]
    v_exp_f32 v235, v107
    v_mfma_f32_16x16x32_bf16 v[76:79], v[216:219], v[152:155], v[76:79]
    ds_read_b128 v[216:219], v244 offset:14336
    v_add_f32 v242, v242, v234
    v_add_f32 v242, v242, v235
    v_mfma_f32_16x16x32_bf16 v[72:75], v[220:223], v[140:143], v[72:75]
    v_cvt_pk_bf16_f32 v179, v234, v235
    v_mfma_f32_16x16x32_bf16 v[76:79], v[220:223], v[156:159], v[76:79]
    ds_read_b128 v[220:223], v244 offset:15360
    v_exp_f32 v232, v112
    s_waitcnt lgkmcnt(4)
    v_mfma_f32_16x16x32_bf16 v[80:83], v[192:195], v[128:131], v[224:227]
    v_exp_f32 v233, v113
    v_mfma_f32_16x16x32_bf16 v[84:87], v[192:195], v[144:147], v[228:231]
    s_add_u32 s88, s88, 16384
    s_cmp_eq_u32 s88, 147456
    s_cselect_b32 s88, 65536, s88
    v_add_u32 v245, s88, v254
    v_add_f32 v242, v242, v232
    v_add_f32 v242, v242, v233
    v_mfma_f32_16x16x32_bf16 v[80:83], v[196:199], v[132:135], v[80:83]
    ds_read_b128 v[192:195], v245 offset:0
    v_cvt_pk_bf16_f32 v184, v232, v233
    v_mfma_f32_16x16x32_bf16 v[84:87], v[196:199], v[148:151], v[84:87]
    ds_read_b128 v[196:199], v245 offset:1024
    v_exp_f32 v234, v114
    v_mfma_f32_16x16x32_bf16 v[80:83], v[200:203], v[136:139], v[80:83]
    v_exp_f32 v235, v115
    v_mfma_f32_16x16x32_bf16 v[84:87], v[200:203], v[152:155], v[84:87]
    ds_read_b128 v[200:203], v245 offset:2048
    v_add_f32 v242, v242, v234
    v_add_f32 v242, v242, v235
    v_cvt_pk_bf16_f32 v185, v234, v235
    v_mfma_f32_16x16x32_bf16 v[80:83], v[204:207], v[140:143], v[80:83]
    v_exp_f32 v232, v120
    v_mfma_f32_16x16x32_bf16 v[84:87], v[204:207], v[156:159], v[84:87]
    ds_read_b128 v[204:207], v245 offset:3072
    v_exp_f32 v233, v121
    s_waitcnt lgkmcnt(4)
    v_mfma_f32_16x16x32_bf16 v[88:91], v[208:211], v[128:131], v[224:227]
    v_add_f32 v242, v242, v232
    v_add_f32 v242, v242, v233
    v_mfma_f32_16x16x32_bf16 v[92:95], v[208:211], v[144:147], v[228:231]
    ds_read_b128 v[208:211], v245 offset:4096
    v_cvt_pk_bf16_f32 v186, v232, v233
    v_mfma_f32_16x16x32_bf16 v[88:91], v[212:215], v[132:135], v[88:91]
    v_exp_f32 v234, v122
    v_mfma_f32_16x16x32_bf16 v[92:95], v[212:215], v[148:151], v[92:95]
    ds_read_b128 v[212:215], v245 offset:5120
    v_exp_f32 v235, v123
    v_mfma_f32_16x16x32_bf16 v[88:91], v[216:219], v[136:139], v[88:91]
    v_add_f32 v242, v242, v234
    v_add_f32 v242, v242, v235
    v_mfma_f32_16x16x32_bf16 v[92:95], v[216:219], v[152:155], v[92:95]
    ds_read_b128 v[216:219], v245 offset:6144
    v_cvt_pk_bf16_f32 v187, v234, v235
    v_mfma_f32_16x16x32_bf16 v[88:91], v[220:223], v[140:143], v[88:91]
    v_exp_f32 v232, v100
    v_mfma_f32_16x16x32_bf16 v[92:95], v[220:223], v[156:159], v[92:95]
    ds_read_b128 v[220:223], v245 offset:7168
    v_exp_f32 v233, v101
    s_waitcnt vmcnt(0)
    s_barrier
    s_waitcnt lgkmcnt(4)
    v_mfma_f32_16x16x32_bf16 v[0:3], v[192:195], v[160:163], v[0:3]
    s_add_u32 s93, s61, 4
    s_and_b32 s100, s93, 3
    s_lshl_b32 s100, s100, 14
    s_add_u32 m0, s100, s92
    s_lshl_b32 s101, s93, 14
    s_add_u32 s101, s101, s62
    s_cmp_lt_i32 s93, s60
    s_cselect_b32 s101, s101, 1073741824
    buffer_load_dwordx4 v254, s[52:55], s101 offen offset:0 sc1 lds
    v_add_f32 v243, v232, v233
    v_mfma_f32_16x16x32_bf16 v[4:7], v[192:195], v[164:167], v[4:7]
    ds_read_b128 v[192:195], v245 offset:8192
    buffer_load_dwordx4 v254, s[52:55], s101 offen offset:1024 sc1 lds
    v_cvt_pk_bf16_f32 v180, v232, v233
    v_mfma_f32_16x16x32_bf16 v[8:11], v[196:199], v[160:163], v[8:11]
    buffer_load_dwordx4 v254, s[52:55], s101 offen offset:2048 sc1 lds
    v_exp_f32 v234, v102
    v_mfma_f32_16x16x32_bf16 v[12:15], v[196:199], v[164:167], v[12:15]
    ds_read_b128 v[196:199], v245 offset:9216
    buffer_load_dwordx4 v254, s[52:55], s101 offen offset:3072 sc1 lds
    v_exp_f32 v235, v103
    v_mfma_f32_16x16x32_bf16 v[16:19], v[200:203], v[160:163], v[16:19]
    s_add_u32 s93, s61, 5
    s_and_b32 s100, s93, 3
    s_lshl_b32 s100, s100, 14
    s_add_u32 m0, s100, s92
    s_lshl_b32 s101, s93, 14
    s_add_u32 s101, s101, s62
    s_cmp_lt_i32 s93, s60
    s_cselect_b32 s101, s101, 1073741824
    buffer_load_dwordx4 v254, s[52:55], s101 offen offset:0 sc1 lds
    v_add_f32 v243, v243, v234
    v_add_f32 v243, v243, v235
    v_mfma_f32_16x16x32_bf16 v[20:23], v[200:203], v[164:167], v[20:23]
    ds_read_b128 v[200:203], v245 offset:10240
    buffer_load_dwordx4 v254, s[52:55], s101 offen offset:1024 sc1 lds
    v_cvt_pk_bf16_f32 v181, v234, v235
    v_mfma_f32_16x16x32_bf16 v[24:27], v[204:207], v[160:163], v[24:27]
    buffer_load_dwordx4 v254, s[52:55], s101 offen offset:2048 sc1 lds
    v_exp_f32 v232, v108
    v_mfma_f32_16x16x32_bf16 v[28:31], v[204:207], v[164:167], v[28:31]
    ds_read_b128 v[204:207], v245 offset:11264
    buffer_load_dwordx4 v254, s[52:55], s101 offen offset:3072 sc1 lds
    v_exp_f32 v233, v109
    s_waitcnt lgkmcnt(4)
    v_mfma_f32_16x16x32_bf16 v[32:35], v[208:211], v[160:163], v[32:35]
    s_add_u32 s89, s89, 16384
    s_cmp_eq_u32 s89, 147456
    s_cselect_b32 s89, 65536, s89
    s_add_u32 s93, s61, 2
    s_add_u32 m0, s92, s89
    s_lshl_b32 s101, s93, 14
    s_add_u32 s101, s101, s63
    s_cmp_lt_i32 s93, s60
    s_cselect_b32 s101, s101, 1073741824
    buffer_load_dwordx4 v254, s[52:55], s101 offen offset:0 sc1 lds
    v_add_f32 v243, v243, v232
    v_add_f32 v243, v243, v233
    v_cvt_pk_bf16_f32 v182, v232, v233
    v_mfma_f32_16x16x32_bf16 v[36:39], v[208:211], v[164:167], v[36:39]
    ds_read_b128 v[208:211], v245 offset:12288
    buffer_load_dwordx4 v254, s[52:55], s101 offen offset:1024 sc1 lds
    v_exp_f32 v234, v110
    v_mfma_f32_16x16x32_bf16 v[40:43], v[212:215], v[160:163], v[40:43]
    buffer_load_dwordx4 v254, s[52:55], s101 offen offset:2048 sc1 lds
    v_exp_f32 v235, v111
    v_mfma_f32_16x16x32_bf16 v[44:47], v[212:215], v[164:167], v[44:47]
    ds_read_b128 v[212:215], v245 offset:13312
    buffer_load_dwordx4 v254, s[52:55], s101 offen offset:3072 sc1 lds
    v_add_f32 v243, v243, v234
    v_add_f32 v243, v243, v235
    v_mfma_f32_16x16x32_bf16 v[48:51], v[216:219], v[160:163], v[48:51]
    s_add_u32 s89, s89, 16384
    s_cmp_eq_u32 s89, 147456
    s_cselect_b32 s89, 65536, s89
    s_add_u32 s93, s61, 3
    s_add_u32 m0, s92, s89
    s_lshl_b32 s101, s93, 14
    s_add_u32 s101, s101, s63
    s_cmp_lt_i32 s93, s60
    s_cselect_b32 s101, s101, 1073741824
    buffer_load_dwordx4 v254, s[52:55], s101 offen offset:0 sc1 lds
    v_cvt_pk_bf16_f32 v183, v234, v235
    v_mfma_f32_16x16x32_bf16 v[52:55], v[216:219], v[164:167], v[52:55]
    ds_read_b128 v[216:219], v245 offset:14336
    buffer_load_dwordx4 v254, s[52:55], s101 offen offset:1024 sc1 lds
    v_exp_f32 v232, v116
    v_mfma_f32_16x16x32_bf16 v[56:59], v[220:223], v[160:163], v[56:59]
    buffer_load_dwordx4 v254, s[52:55], s101 offen offset:2048 sc1 lds
    v_exp_f32 v233, v117
    v_mfma_f32_16x16x32_bf16 v[60:63], v[220:223], v[164:167], v[60:63]
    ds_read_b128 v[220:223], v245 offset:15360
    buffer_load_dwordx4 v254, s[52:55], s101 offen offset:3072 sc1 lds
    v_add_f32 v243, v243, v232
    v_add_f32 v243, v243, v233
    s_waitcnt lgkmcnt(4)
    v_mfma_f32_16x16x32_bf16 v[0:3], v[192:195], v[168:171], v[0:3]
    s_cmp_eq_u32 s61, 3
    s_cselect_b32 s100, s76, 1073741824
    buffer_load_dword v249, v251, s[24:27], s100 offen
    v_cvt_pk_bf16_f32 v188, v232, v233
    v_mfma_f32_16x16x32_bf16 v[4:7], v[192:195], v[172:175], v[4:7]
    ds_read_b128 v[192:195], v244 offset:16384
    v_exp_f32 v234, v118
    v_mfma_f32_16x16x32_bf16 v[8:11], v[196:199], v[168:171], v[8:11]
    v_exp_f32 v235, v119
    v_mfma_f32_16x16x32_bf16 v[12:15], v[196:199], v[172:175], v[12:15]
    ds_read_b128 v[196:199], v244 offset:17408
    v_add_f32 v243, v243, v234
    v_add_f32 v243, v243, v235
    v_cvt_pk_bf16_f32 v189, v234, v235
    v_mfma_f32_16x16x32_bf16 v[16:19], v[200:203], v[168:171], v[16:19]
    v_exp_f32 v232, v124
    v_mfma_f32_16x16x32_bf16 v[20:23], v[200:203], v[172:175], v[20:23]
    ds_read_b128 v[200:203], v244 offset:18432
    v_exp_f32 v233, v125
    v_mfma_f32_16x16x32_bf16 v[24:27], v[204:207], v[168:171], v[24:27]
    v_add_f32 v243, v243, v232
    v_add_f32 v243, v243, v233
    v_mfma_f32_16x16x32_bf16 v[28:31], v[204:207], v[172:175], v[28:31]
    ds_read_b128 v[204:207], v244 offset:19456
    v_cvt_pk_bf16_f32 v190, v232, v233
    s_waitcnt lgkmcnt(4)
    v_mfma_f32_16x16x32_bf16 v[32:35], v[208:211], v[168:171], v[32:35]
    v_exp_f32 v234, v126
    v_mfma_f32_16x16x32_bf16 v[36:39], v[208:211], v[172:175], v[36:39]
    ds_read_b128 v[208:211], v244 offset:20480
    v_exp_f32 v235, v127
    v_mfma_f32_16x16x32_bf16 v[40:43], v[212:215], v[168:171], v[40:43]
    v_add_f32 v243, v243, v234
    v_add_f32 v243, v243, v235
    v_mfma_f32_16x16x32_bf16 v[44:47], v[212:215], v[172:175], v[44:47]
    ds_read_b128 v[212:215], v244 offset:21504
    v_cvt_pk_bf16_f32 v191, v234, v235
    v_mfma_f32_16x16x32_bf16 v[48:51], v[216:219], v[168:171], v[48:51]
    v_add_f32 v236, v242, v243
    v_add_f32 v240, v238, v242
    v_mfma_f32_16x16x32_bf16 v[52:55], v[216:219], v[172:175], v[52:55]
    ds_read_b128 v[216:219], v244 offset:22528
    v_cmp_nge_f32 vcc, s96, v236
    v_add_f32 v241, v239, v243
    v_mfma_f32_16x16x32_bf16 v[56:59], v[220:223], v[168:171], v[56:59]
    s_add_u32 s61, s61, 1
    s_cmp_gt_u32 s61, s77
    v_mfma_f32_16x16x32_bf16 v[60:63], v[220:223], v[172:175], v[60:63]
    ds_read_b128 v[220:223], v244 offset:23552
    s_cbranch_vccnz L_att_sl11
L_att_bk11:
    s_cbranch_scc1 L_att_tail0
    s_waitcnt lgkmcnt(4)
    v_mfma_f32_16x16x32_bf16 v[96:99], v[192:195], v[128:131], v[224:227]
    v_exp_f32 v232, v64
    v_mfma_f32_16x16x32_bf16 v[100:103], v[192:195], v[144:147], v[228:231]
    ds_read_b128 v[192:195], v244 offset:24576
    v_exp_f32 v233, v65
    v_mfma_f32_16x16x32_bf16 v[96:99], v[196:199], v[132:135], v[96:99]
    v_add_f32 v242, v232, v233
    v_mfma_f32_16x16x32_bf16 v[100:103], v[196:199], v[148:151], v[100:103]
    ds_read_b128 v[196:199], v244 offset:25600
    v_cvt_pk_bf16_f32 v160, v232, v233
    v_mfma_f32_16x16x32_bf16 v[96:99], v[200:203], v[136:139], v[96:99]
    v_exp_f32 v234, v66
    v_mfma_f32_16x16x32_bf16 v[100:103], v[200:203], v[152:155], v[100:103]
    ds_read_b128 v[200:203], v244 offset:26624
    v_exp_f32 v235, v67
    v_mfma_f32_16x16x32_bf16 v[96:99], v[204:207], v[140:143], v[96:99]
    v_add_f32 v242, v242, v234
    v_add_f32 v242, v242, v235
    v_mfma_f32_16x16x32_bf16 v[100:103], v[204:207], v[156:159], v[100:103]
    ds_read_b128 v[204:207], v244 offset:27648
    v_cvt_pk_bf16_f32 v161, v234, v235
    s_waitcnt lgkmcnt(4)
    v_mfma_f32_16x16x32_bf16 v[104:107], v[208:211], v[128:131], v[224:227]
    v_exp_f32 v232, v72
    v_mfma_f32_16x16x32_bf16 v[108:111], v[208:211], v[144:147], v[228:231]
    ds_read_b128 v[208:211], v244 offset:28672
    v_exp_f32 v233, v73
    v_mfma_f32_16x16x32_bf16 v[104:107], v[212:215], v[132:135], v[104:107]
    v_add_f32 v242, v242, v232
    v_add_f32 v242, v242, v233
    v_cvt_pk_bf16_f32 v162, v232, v233
    v_mfma_f32_16x16x32_bf16 v[108:111], v[212:215], v[148:151], v[108:111]
    ds_read_b128 v[212:215], v244 offset:29696
    v_exp_f32 v234, v74
    v_mfma_f32_16x16x32_bf16 v[104:107], v[216:219], v[136:139], v[104:107]
    v_exp_f32 v235, v75
    v_mfma_f32_16x16x32_bf16 v[108:111], v[216:219], v[152:155], v[108:111]
    ds_read_b128 v[216:219], v244 offset:30720
    v_add_f32 v242, v242, v234
    v_add_f32 v242, v242, v235
    v_mfma_f32_16x16x32_bf16 v[104:107], v[220:223], v[140:143], v[104:107]
    v_cvt_pk_bf16_f32 v163, v234, v235
    v_mfma_f32_16x16x32_bf16 v[108:111], v[220:223], v[156:159], v[108:111]
    ds_read_b128 v[220:223], v244 offset:31744
    v_exp_f32 v232, v80
    s_waitcnt lgkmcnt(4)
    v_mfma_f32_16x16x32_bf16 v[112:115], v[192:195], v[128:131], v[224:227]
    v_exp_f32 v233, v81
    v_mfma_f32_16x16x32_bf16 v[116:119], v[192:195], v[144:147], v[228:231]
    s_add_u32 s88, s88, 16384
    s_cmp_eq_u32 s88, 147456
    s_cselect_b32 s88, 65536, s88
    v_add_u32 v245, s88, v254
    v_add_f32 v242, v242, v232
    v_add_f32 v242, v242, v233
    v_mfma_f32_16x16x32_bf16 v[112:115], v[196:199], v[132:135], v[112:115]
    ds_read_b128 v[192:195], v245 offset:0
    v_cvt_pk_bf16_f32 v168, v232, v233
    v_mfma_f32_16x16x32_bf16 v[116:119], v[196:199], v[148:151], v[116:119]
    ds_read_b128 v[196:199], v245 offset:1024
    v_exp_f32 v234, v82
    v_mfma_f32_16x16x32_bf16 v[112:115], v[200:203], v[136:139], v[112:115]
    v_exp_f32 v235, v83
    v_mfma_f32_16x16x32_bf16 v[116:119], v[200:203], v[152:155], v[116:119]
    ds_read_b128 v[200:203], v245 offset:2048
    v_add_f32 v242, v242, v234
    v_add_f32 v242, v242, v235
    v_cvt_pk_bf16_f32 v169, v234, v235
    v_mfma_f32_16x16x32_bf16 v[112:115], v[204:207], v[140:143], v[112:115]
    v_exp_f32 v232, v88
    v_mfma_f32_16x16x32_bf16 v[116:119], v[204:207], v[156:159], v[116:119]
    ds_read_b128 v[204:207], v245 offset:3072
    v_exp_f32 v233, v89
    s_waitcnt lgkmcnt(4)
    v_mfma_f32_16x16x32_bf16 v[120:123], v[208:211], v[128:131], v[224:227]
    v_add_f32 v242, v242, v232
    v_add_f32 v242, v242, v233
    v_mfma_f32_16x16x32_bf16 v[124:127], v[208:211], v[144:147], v[228:231]
    ds_read_b128 v[208:211], v245 offset:4096
    v_cvt_pk_bf16_f32 v170, v232, v233
    v_mfma_f32_16x16x32_bf16 v[120:123], v[212:215], v[132:135], v[120:123]
    v_exp_f32 v234, v90
    v_mfma_f32_16x16x32_bf16 v[124:127], v[212:215], v[148:151], v[124:127]
    ds_read_b128 v[212:215], v245 offset:5120
    v_exp_f32 v235, v91
    v_mfma_f32_16x16x32_bf16 v[120:123], v[216:219], v[136:139], v[120:123]
    v_add_f32 v242, v242, v234
    v_add_f32 v242, v242, v235
    v_mfma_f32_16x16x32_bf16 v[124:127], v[216:219], v[152:155], v[124:127]
    ds_read_b128 v[216:219], v245 offset:6144
    v_cvt_pk_bf16_f32 v171, v234, v235
    v_mfma_f32_16x16x32_bf16 v[120:123], v[220:223], v[140:143], v[120:123]
    v_exp_f32 v232, v68
    v_mfma_f32_16x16x32_bf16 v[124:127], v[220:223], v[156:159], v[124:127]
    ds_read_b128 v[220:223], v245 offset:7168
    v_exp_f32 v233, v69
    s_waitcnt lgkmcnt(4)
    v_mfma_f32_16x16x32_bf16 v[0:3], v[192:195], v[176:179], v[0:3]
    v_add_f32 v243, v232, v233
    v_mfma_f32_16x16x32_bf16 v[4:7], v[192:195], v[180:183], v[4:7]
    ds_read_b128 v[192:195], v245 offset:8192
    v_cvt_pk_bf16_f32 v164, v232, v233
    v_mfma_f32_16x16x32_bf16 v[8:11], v[196:199], v[176:179], v[8:11]
    v_exp_f32 v234, v70
    v_mfma_f32_16x16x32_bf16 v[12:15], v[196:199], v[180:183], v[12:15]
    ds_read_b128 v[196:199], v245 offset:9216
    v_exp_f32 v235, v71
    v_mfma_f32_16x16x32_bf16 v[16:19], v[200:203], v[176:179], v[16:19]
    v_add_f32 v243, v243, v234
    v_add_f32 v243, v243, v235
    v_mfma_f32_16x16x32_bf16 v[20:23], v[200:203], v[180:183], v[20:23]
    ds_read_b128 v[200:203], v245 offset:10240
    v_cvt_pk_bf16_f32 v165, v234, v235
    v_mfma_f32_16x16x32_bf16 v[24:27], v[204:207], v[176:179], v[24:27]
    v_exp_f32 v232, v76
    v_mfma_f32_16x16x32_bf16 v[28:31], v[204:207], v[180:183], v[28:31]
    ds_read_b128 v[204:207], v245 offset:11264
    v_exp_f32 v233, v77
    s_waitcnt lgkmcnt(4)
    v_mfma_f32_16x16x32_bf16 v[32:35], v[208:211], v[176:179], v[32:35]
    v_add_f32 v243, v243, v232
    v_add_f32 v243, v243, v233
    v_cvt_pk_bf16_f32 v166, v232, v233
    v_mfma_f32_16x16x32_bf16 v[36:39], v[208:211], v[180:183], v[36:39]
    ds_read_b128 v[208:211], v245 offset:12288
    v_exp_f32 v234, v78
    v_mfma_f32_16x16x32_bf16 v[40:43], v[212:215], v[176:179], v[40:43]
    v_exp_f32 v235, v79
    v_mfma_f32_16x16x32_bf16 v[44:47], v[212:215], v[180:183], v[44:47]
    ds_read_b128 v[212:215], v245 offset:13312
    v_add_f32 v243, v243, v234
    v_add_f32 v243, v243, v235
    v_mfma_f32_16x16x32_bf16 v[48:51], v[216:219], v[176:179], v[48:51]
    v_cvt_pk_bf16_f32 v167, v234, v235
    v_mfma_f32_16x16x32_bf16 v[52:55], v[216:219], v[180:183], v[52:55]
    ds_read_b128 v[216:219], v245 offset:14336
    v_exp_f32 v232, v84
    v_mfma_f32_16x16x32_bf16 v[56:59], v[220:223], v[176:179], v[56:59]
    v_exp_f32 v233, v85
    v_mfma_f32_16x16x32_bf16 v[60:63], v[220:223], v[180:183], v[60:63]
    ds_read_b128 v[220:223], v245 offset:15360
    v_add_f32 v243, v243, v232
    v_add_f32 v243, v243, v233
    s_waitcnt lgkmcnt(4)
    v_mfma_f32_16x16x32_bf16 v[0:3], v[192:195], v[184:187], v[0:3]
    v_cvt_pk_bf16_f32 v172, v232, v233
    v_mfma_f32_16x16x32_bf16 v[4:7], v[192:195], v[188:191], v[4:7]
    v_xor_b32 v244, 0x8000, v244
    v_exp_f32 v234, v86
    v_mfma_f32_16x16x32_bf16 v[8:11], v[196:199], v[184:187], v[8:11]
    ds_read_b128 v[192:195], v244 offset:0
    v_exp_f32 v235, v87
    v_mfma_f32_16x16x32_bf16 v[12:15], v[196:199], v[188:191], v[12:15]
    ds_read_b128 v[196:199], v244 offset:1024
    v_add_f32 v243, v243, v234
    v_add_f32 v243, v243, v235
    v_cvt_pk_bf16_f32 v173, v234, v235
    v_mfma_f32_16x16x32_bf16 v[16:19], v[200:203], v[184:187], v[16:19]
    v_exp_f32 v232, v92
    v_mfma_f32_16x16x32_bf16 v[20:23], v[200:203], v[188:191], v[20:23]
    ds_read_b128 v[200:203], v244 offset:2048
    v_exp_f32 v233, v93
    v_mfma_f32_16x16x32_bf16 v[24:27], v[204:207], v[184:187], v[24:27]
    v_add_f32 v243, v243, v232
    v_add_f32 v243, v243, v233
    v_mfma_f32_16x16x32_bf16 v[28:31], v[204:207], v[188:191], v[28:31]
    ds_read_b128 v[204:207], v244 offset:3072
    v_cvt_pk_bf16_f32 v174, v232, v233
    s_waitcnt lgkmcnt(4)
    v_mfma_f32_16x16x32_bf16 v[32:35], v[208:211], v[184:187], v[32:35]
    v_exp_f32 v234, v94
    v_mfma_f32_16x16x32_bf16 v[36:39], v[208:211], v[188:191], v[36:39]
    ds_read_b128 v[208:211], v244 offset:4096
    v_exp_f32 v235, v95
    v_mfma_f32_16x16x32_bf16 v[40:43], v[212:215], v[184:187], v[40:43]
    v_add_f32 v243, v243, v234
    v_add_f32 v243, v243, v235
    v_mfma_f32_16x16x32_bf16 v[44:47], v[212:215], v[188:191], v[44:47]
    ds_read_b128 v[212:215], v244 offset:5120
    v_cvt_pk_bf16_f32 v175, v234, v235
    v_mfma_f32_16x16x32_bf16 v[48:51], v[216:219], v[184:187], v[48:51]
    v_add_f32 v236, v242, v243
    v_add_f32 v238, v240, v242
    v_mfma_f32_16x16x32_bf16 v[52:55], v[216:219], v[188:191], v[52:55]
    ds_read_b128 v[216:219], v244 offset:6144
    v_cmp_nge_f32 vcc, s96, v236
    v_add_f32 v239, v241, v243
    v_mfma_f32_16x16x32_bf16 v[56:59], v[220:223], v[184:187], v[56:59]
    s_add_u32 s61, s61, 1
    s_cmp_gt_u32 s61, s78
    v_mfma_f32_16x16x32_bf16 v[60:63], v[220:223], v[188:191], v[60:63]
    ds_read_b128 v[220:223], v244 offset:7168
    s_cbranch_vccnz L_att_sl10
L_att_bk10:
    s_cbranch_scc0 L_att_loop1
    s_cmp_gt_u32 s61, s77
    s_cbranch_scc1 L_att_tail1
    s_mov_b32 s78, s77
    s_mov_b32 s79, 1
    s_cmp_lg_u32 s3, 4
    s_cbranch_scc1 L_pub77
    v_mov_b32 v232, 3
    s_lshl_b32 s93, s6, 7
    s_add_u32 s93, s93, 3145728
    v_mov_b32 v233, s93
    s_mov_b64 s[72:73], exec
    s_mov_b64 exec, 1
    buffer_store_dword v232, v233, s[52:55], 0 offen sc1
    s_mov_b64 exec, s[72:73]
    L_pub77:
    s_branch L_att_loop1
    L_att_sl01:
    s_call_b64 s[94:95], L_exact1
    s_cmp_gt_u32 s61, s77
    s_branch L_att_bk01
    L_att_sl00:
    s_call_b64 s[94:95], L_exact0
    s_cmp_gt_u32 s61, s78
    s_branch L_att_bk00
    L_att_sl11:
    s_call_b64 s[94:95], L_exact1
    s_cmp_gt_u32 s61, s77
    s_branch L_att_bk11
    L_att_sl10:
    s_call_b64 s[94:95], L_exact0
    s_cmp_gt_u32 s61, s78
    s_branch L_att_bk10
L_att_tail1:
    s_waitcnt lgkmcnt(0)
    s_cmp_eq_u32 s56, 0
    s_cbranch_scc1 L_sa78
    s_waitcnt vmcnt(0)
    s_barrier
    s_add_u32 s93, s61, 2
    s_cmp_ge_i32 s93, s60
    s_cbranch_scc1 L_sb78
    s_add_u32 s93, s61, 4
    s_and_b32 s100, s93, 3
    s_lshl_b32 s100, s100, 14
    s_add_u32 m0, s100, s92
    s_lshl_b32 s101, s93, 14
    s_add_u32 s101, s101, s62
    s_cmp_lt_i32 s93, s60
    s_cselect_b32 s101, s101, 1073741824
    buffer_load_dwordx4 v254, s[52:55], s101 offen offset:0 sc1 lds
    buffer_load_dwordx4 v254, s[52:55], s101 offen offset:1024 sc1 lds
    buffer_load_dwordx4 v254, s[52:55], s101 offen offset:2048 sc1 lds
    buffer_load_dwordx4 v254, s[52:55], s101 offen offset:3072 sc1 lds
    s_add_u32 s93, s61, 5
    s_and_b32 s100, s93, 3
    s_lshl_b32 s100, s100, 14
    s_add_u32 m0, s100, s92
    s_lshl_b32 s101, s93, 14
    s_add_u32 s101, s101, s62
    s_cmp_lt_i32 s93, s60
    s_cselect_b32 s101, s101, 1073741824
    buffer_load_dwordx4 v254, s[52:55], s101 offen offset:0 sc1 lds
    buffer_load_dwordx4 v254, s[52:55], s101 offen offset:1024 sc1 lds
    buffer_load_dwordx4 v254, s[52:55], s101 offen offset:2048 sc1 lds
    buffer_load_dwordx4 v254, s[52:55], s101 offen offset:3072 sc1 lds
    s_add_u32 s89, s89, 16384
    s_cmp_eq_u32 s89, 147456
    s_cselect_b32 s89, 65536, s89
    s_add_u32 s93, s61, 2
    s_add_u32 m0, s92, s89
    s_lshl_b32 s101, s93, 14
    s_add_u32 s101, s101, s63
    s_cmp_lt_i32 s93, s60
    s_cselect_b32 s101, s101, 1073741824
    buffer_load_dwordx4 v254, s[52:55], s101 offen offset:0 sc1 lds
    buffer_load_dwordx4 v254, s[52:55], s101 offen offset:1024 sc1 lds
    buffer_load_dwordx4 v254, s[52:55], s101 offen offset:2048 sc1 lds
    buffer_load_dwordx4 v254, s[52:55], s101 offen offset:3072 sc1 lds
    s_add_u32 s89, s89, 16384
    s_cmp_eq_u32 s89, 147456
    s_cselect_b32 s89, 65536, s89
    s_add_u32 s93, s61, 3
    s_add_u32 m0, s92, s89
    s_lshl_b32 s101, s93, 14
    s_add_u32 s101, s101, s63
    s_cmp_lt_i32 s93, s60
    s_cselect_b32 s101, s101, 1073741824
    buffer_load_dwordx4 v254, s[52:55], s101 offen offset:0 sc1 lds
    buffer_load_dwordx4 v254, s[52:55], s101 offen offset:1024 sc1 lds
    buffer_load_dwordx4 v254, s[52:55], s101 offen offset:2048 sc1 lds
    buffer_load_dwordx4 v254, s[52:55], s101 offen offset:3072 sc1 lds
    s_branch L_sb78
    L_sa78:
    s_barrier
    L_sb78:
    s_mov_b32 s98, 1
    s_bitcmp1_b32 s57, 0
    s_cbranch_scc1 L_att_to1
    s_add_u32 s88, s88, 16384
    s_cmp_eq_u32 s88, 147456
    s_cselect_b32 s88, 65536, s88
    v_add_u32 v245, s88, v254
    ds_read_b128 v[192:195], v245 offset:0
    ds_read_b128 v[196:199], v245 offset:1024
    ds_read_b128 v[200:203], v245 offset:2048
    ds_read_b128 v[204:207], v245 offset:3072
    ds_read_b128 v[208:211], v245 offset:4096
    ds_read_b128 v[212:215], v245 offset:5120
    ds_read_b128 v[216:219], v245 offset:6144
    ds_read_b128 v[220:223], v245 offset:7168
    s_waitcnt lgkmcnt(6)
    v_mfma_f32_16x16x32_bf16 v[0:3], v[192:195], v[160:163], v[0:3]
    v_cndmask_b32 v96, v247, v96, s[80:81]
    v_mfma_f32_16x16x32_bf16 v[4:7], v[192:195], v[164:167], v[4:7]
    ds_read_b128 v[192:195], v245 offset:8192
    v_cndmask_b32 v97, v247, v97, s[82:83]
    v_mfma_f32_16x16x32_bf16 v[8:11], v[196:199], v[160:163], v[8:11]
    v_cndmask_b32 v98, v247, v98, s[84:85]
    v_mfma_f32_16x16x32_bf16 v[12:15], v[196:199], v[164:167], v[12:15]
    ds_read_b128 v[196:199], v245 offset:9216
    v_cndmask_b32 v99, v247, v99, s[86:87]
    s_waitcnt lgkmcnt(6)
    v_mfma_f32_16x16x32_bf16 v[16:19], v[200:203], v[160:163], v[16:19]
    v_cndmask_b32 v108, v247, v108, s[80:81]
    v_mfma_f32_16x16x32_bf16 v[20:23], v[200:203], v[164:167], v[20:23]
    ds_read_b128 v[200:203], v245 offset:10240
    v_cndmask_b32 v109, v247, v109, s[82:83]
    v_mfma_f32_16x16x32_bf16 v[24:27], v[204:207], v[160:163], v[24:27]
    v_cndmask_b32 v110, v247, v110, s[84:85]
    v_mfma_f32_16x16x32_bf16 v[28:31], v[204:207], v[164:167], v[28:31]
    ds_read_b128 v[204:207], v245 offset:11264
    v_cndmask_b32 v111, v247, v111, s[86:87]
    s_waitcnt lgkmcnt(6)
    v_mfma_f32_16x16x32_bf16 v[32:35], v[208:211], v[160:163], v[32:35]
    v_exp_f32 v232, v96
    v_exp_f32 v233, v97
    v_mfma_f32_16x16x32_bf16 v[36:39], v[208:211], v[164:167], v[36:39]
    ds_read_b128 v[208:211], v245 offset:12288
    v_add_f32 v242, v232, v233
    v_cvt_pk_bf16_f32 v176, v232, v233
    v_mfma_f32_16x16x32_bf16 v[40:43], v[212:215], v[160:163], v[40:43]
    v_exp_f32 v234, v98
    v_exp_f32 v235, v99
    v_mfma_f32_16x16x32_bf16 v[44:47], v[212:215], v[164:167], v[44:47]
    ds_read_b128 v[212:215], v245 offset:13312
    v_add_f32 v242, v242, v234
    v_add_f32 v242, v242, v235
    v_cvt_pk_bf16_f32 v177, v234, v235
    s_waitcnt lgkmcnt(6)
    v_mfma_f32_16x16x32_bf16 v[48:51], v[216:219], v[160:163], v[48:51]
    v_mov_b32 v178, 0
    v_mfma_f32_16x16x32_bf16 v[52:55], v[216:219], v[164:167], v[52:55]
    ds_read_b128 v[216:219], v245 offset:14336
    v_mov_b32 v179, 0
    v_mfma_f32_16x16x32_bf16 v[56:59], v[220:223], v[160:163], v[56:59]
    v_exp_f32 v232, v100
    v_exp_f32 v233, v101
    v_mfma_f32_16x16x32_bf16 v[60:63], v[220:223], v[164:167], v[60:63]
    ds_read_b128 v[220:223], v245 offset:15360
    v_add_f32 v243, v232, v233
    v_cvt_pk_bf16_f32 v180, v232, v233
    s_waitcnt lgkmcnt(6)
    v_mfma_f32_16x16x32_bf16 v[0:3], v[192:195], v[168:171], v[0:3]
    v_exp_f32 v234, v102
    v_exp_f32 v235, v103
    v_mfma_f32_16x16x32_bf16 v[4:7], v[192:195], v[172:175], v[4:7]
    v_add_f32 v243, v243, v234
    v_add_f32 v243, v243, v235
    v_cvt_pk_bf16_f32 v181, v234, v235
    v_mfma_f32_16x16x32_bf16 v[8:11], v[196:199], v[168:171], v[8:11]
    v_exp_f32 v232, v108
    v_exp_f32 v233, v109
    v_mfma_f32_16x16x32_bf16 v[12:15], v[196:199], v[172:175], v[12:15]
    v_add_f32 v243, v243, v232
    v_add_f32 v243, v243, v233
    v_cvt_pk_bf16_f32 v182, v232, v233
    s_waitcnt lgkmcnt(4)
    v_mfma_f32_16x16x32_bf16 v[16:19], v[200:203], v[168:171], v[16:19]
    v_exp_f32 v234, v110
    v_exp_f32 v235, v111
    v_mfma_f32_16x16x32_bf16 v[20:23], v[200:203], v[172:175], v[20:23]
    v_add_f32 v243, v243, v234
    v_add_f32 v243, v243, v235
    v_cvt_pk_bf16_f32 v183, v234, v235
    v_mfma_f32_16x16x32_bf16 v[24:27], v[204:207], v[168:171], v[24:27]
    v_add_f32 v236, v242, v243
    v_add_f32 v240, v238, v242
    v_mfma_f32_16x16x32_bf16 v[28:31], v[204:207], v[172:175], v[28:31]
    v_cmp_nge_f32 vcc, s96, v236
    v_add_f32 v241, v239, v243
    s_waitcnt lgkmcnt(2)
    v_mfma_f32_16x16x32_bf16 v[32:35], v[208:211], v[168:171], v[32:35]
    v_mfma_f32_16x16x32_bf16 v[36:39], v[208:211], v[172:175], v[36:39]
    v_mfma_f32_16x16x32_bf16 v[40:43], v[212:215], v[168:171], v[40:43]
    v_mfma_f32_16x16x32_bf16 v[44:47], v[212:215], v[172:175], v[44:47]
    s_waitcnt lgkmcnt(0)
    v_mfma_f32_16x16x32_bf16 v[48:51], v[216:219], v[168:171], v[48:51]
    v_mfma_f32_16x16x32_bf16 v[52:55], v[216:219], v[172:175], v[52:55]
    v_mfma_f32_16x16x32_bf16 v[56:59], v[220:223], v[168:171], v[56:59]
    v_mfma_f32_16x16x32_bf16 v[60:63], v[220:223], v[172:175], v[60:63]
    s_branch L_att_tc1
L_att_to1:
    s_add_u32 s88, s88, 16384
    s_cmp_eq_u32 s88, 147456
    s_cselect_b32 s88, 65536, s88
    v_add_u32 v245, s88, v254
    ds_read_b128 v[192:195], v245 offset:0
    ds_read_b128 v[196:199], v245 offset:1024
    ds_read_b128 v[200:203], v245 offset:2048
    ds_read_b128 v[204:207], v245 offset:3072
    ds_read_b128 v[208:211], v245 offset:4096
    ds_read_b128 v[212:215], v245 offset:5120
    ds_read_b128 v[216:219], v245 offset:6144
    ds_read_b128 v[220:223], v245 offset:7168
    s_waitcnt lgkmcnt(6)
    v_mfma_f32_16x16x32_bf16 v[0:3], v[192:195], v[160:163], v[0:3]
    v_cndmask_b32 v112, v247, v112, s[80:81]
    v_cndmask_b32 v113, v247, v113, s[82:83]
    v_mfma_f32_16x16x32_bf16 v[4:7], v[192:195], v[164:167], v[4:7]
    ds_read_b128 v[192:195], v245 offset:8192
    v_cndmask_b32 v114, v247, v114, s[84:85]
    v_mfma_f32_16x16x32_bf16 v[8:11], v[196:199], v[160:163], v[8:11]
    v_cndmask_b32 v115, v247, v115, s[86:87]
    v_mfma_f32_16x16x32_bf16 v[12:15], v[196:199], v[164:167], v[12:15]
    ds_read_b128 v[196:199], v245 offset:9216
    v_cndmask_b32 v124, v247, v124, s[80:81]
    v_cndmask_b32 v125, v247, v125, s[82:83]
    s_waitcnt lgkmcnt(6)
    v_mfma_f32_16x16x32_bf16 v[16:19], v[200:203], v[160:163], v[16:19]
    v_cndmask_b32 v126, v247, v126, s[84:85]
    v_mfma_f32_16x16x32_bf16 v[20:23], v[200:203], v[164:167], v[20:23]
    ds_read_b128 v[200:203], v245 offset:10240
    v_cndmask_b32 v127, v247, v127, s[86:87]
    v_mfma_f32_16x16x32_bf16 v[24:27], v[204:207], v[160:163], v[24:27]
    v_exp_f32 v232, v96
    v_exp_f32 v233, v97
    s_nop 0
    v_add_f32 v242, v232, v233
    v_cvt_pk_bf16_f32 v176, v232, v233
    v_mfma_f32_16x16x32_bf16 v[28:31], v[204:207], v[164:167], v[28:31]
    ds_read_b128 v[204:207], v245 offset:11264
    v_exp_f32 v234, v98
    v_exp_f32 v235, v99
    s_waitcnt lgkmcnt(6)
    v_mfma_f32_16x16x32_bf16 v[32:35], v[208:211], v[160:163], v[32:35]
    s_nop 0
    v_add_f32 v242, v242, v234
    v_add_f32 v242, v242, v235
    v_cvt_pk_bf16_f32 v177, v234, v235
    v_mfma_f32_16x16x32_bf16 v[36:39], v[208:211], v[164:167], v[36:39]
    ds_read_b128 v[208:211], v245 offset:12288
    v_exp_f32 v232, v104
    v_exp_f32 v233, v105
    v_mfma_f32_16x16x32_bf16 v[40:43], v[212:215], v[160:163], v[40:43]
    s_nop 0
    v_add_f32 v242, v242, v232
    v_add_f32 v242, v242, v233
    v_cvt_pk_bf16_f32 v178, v232, v233
    v_exp_f32 v234, v106
    v_exp_f32 v235, v107
    v_mfma_f32_16x16x32_bf16 v[44:47], v[212:215], v[164:167], v[44:47]
    ds_read_b128 v[212:215], v245 offset:13312
    s_nop 0
    v_add_f32 v242, v242, v234
    v_add_f32 v242, v242, v235
    v_cvt_pk_bf16_f32 v179, v234, v235
    s_waitcnt lgkmcnt(6)
    v_mfma_f32_16x16x32_bf16 v[48:51], v[216:219], v[160:163], v[48:51]
    v_exp_f32 v232, v112
    v_exp_f32 v233, v113
    v_mfma_f32_16x16x32_bf16 v[52:55], v[216:219], v[164:167], v[52:55]
    ds_read_b128 v[216:219], v245 offset:14336
    s_nop 0
    v_add_f32 v242, v242, v232
    v_add_f32 v242, v242, v233
    v_cvt_pk_bf16_f32 v184, v232, v233
    v_exp_f32 v234, v114
    v_exp_f32 v235, v115
    v_mfma_f32_16x16x32_bf16 v[56:59], v[220:223], v[160:163], v[56:59]
    s_nop 0
    v_add_f32 v242, v242, v234
    v_add_f32 v242, v242, v235
    v_cvt_pk_bf16_f32 v185, v234, v235
    v_mfma_f32_16x16x32_bf16 v[60:63], v[220:223], v[164:167], v[60:63]
    ds_read_b128 v[220:223], v245 offset:15360
    v_mov_b32 v186, 0
    s_waitcnt lgkmcnt(6)
    v_mfma_f32_16x16x32_bf16 v[0:3], v[192:195], v[168:171], v[0:3]
    v_mov_b32 v187, 0
    v_mfma_f32_16x16x32_bf16 v[4:7], v[192:195], v[172:175], v[4:7]
    v_exp_f32 v232, v100
    v_exp_f32 v233, v101
    s_nop 0
    v_add_f32 v243, v232, v233
    v_cvt_pk_bf16_f32 v180, v232, v233
    v_mfma_f32_16x16x32_bf16 v[8:11], v[196:199], v[168:171], v[8:11]
    v_exp_f32 v234, v102
    v_exp_f32 v235, v103
    v_mfma_f32_16x16x32_bf16 v[12:15], v[196:199], v[172:175], v[12:15]
    s_nop 0
    v_add_f32 v243, v243, v234
    v_add_f32 v243, v243, v235
    v_cvt_pk_bf16_f32 v181, v234, v235
    s_waitcnt lgkmcnt(4)
    v_mfma_f32_16x16x32_bf16 v[16:19], v[200:203], v[168:171], v[16:19]
    v_exp_f32 v232, v108
    v_exp_f32 v233, v109
    s_nop 0
    v_add_f32 v243, v243, v232
    v_add_f32 v243, v243, v233
    v_cvt_pk_bf16_f32 v182, v232, v233
    v_mfma_f32_16x16x32_bf16 v[20:23], v[200:203], v[172:175], v[20:23]
    v_exp_f32 v234, v110
    v_exp_f32 v235, v111
    v_mfma_f32_16x16x32_bf16 v[24:27], v[204:207], v[168:171], v[24:27]
    s_nop 0
    v_add_f32 v243, v243, v234
    v_add_f32 v243, v243, v235
    v_cvt_pk_bf16_f32 v183, v234, v235
    v_mfma_f32_16x16x32_bf16 v[28:31], v[204:207], v[172:175], v[28:31]
    v_exp_f32 v232, v116
    v_exp_f32 v233, v117
    s_waitcnt lgkmcnt(2)
    v_mfma_f32_16x16x32_bf16 v[32:35], v[208:211], v[168:171], v[32:35]
    s_nop 0
    v_add_f32 v243, v243, v232
    v_add_f32 v243, v243, v233
    v_cvt_pk_bf16_f32 v188, v232, v233
    v_exp_f32 v234, v118
    v_exp_f32 v235, v119
    v_mfma_f32_16x16x32_bf16 v[36:39], v[208:211], v[172:175], v[36:39]
    s_nop 0
    v_add_f32 v243, v243, v234
    v_add_f32 v243, v243, v235
    v_cvt_pk_bf16_f32 v189, v234, v235
    v_mfma_f32_16x16x32_bf16 v[40:43], v[212:215], v[168:171], v[40:43]
    v_exp_f32 v232, v124
    v_exp_f32 v233, v125
    v_mfma_f32_16x16x32_bf16 v[44:47], v[212:215], v[172:175], v[44:47]
    s_nop 0
    v_add_f32 v243, v243, v232
    v_add_f32 v243, v243, v233
    v_cvt_pk_bf16_f32 v190, v232, v233
    v_exp_f32 v234, v126
    v_exp_f32 v235, v127
    s_waitcnt lgkmcnt(0)
    v_mfma_f32_16x16x32_bf16 v[48:51], v[216:219], v[168:171], v[48:51]
    s_nop 0
    v_add_f32 v243, v243, v234
    v_add_f32 v243, v243, v235
    v_cvt_pk_bf16_f32 v191, v234, v235
    v_mfma_f32_16x16x32_bf16 v[52:55], v[216:219], v[172:175], v[52:55]
    s_nop 0
    v_add_f32 v236, v242, v243
    v_add_f32 v240, v238, v242
    v_mfma_f32_16x16x32_bf16 v[56:59], v[220:223], v[168:171], v[56:59]
    v_cmp_nge_f32 vcc, s96, v236
    v_add_f32 v241, v239, v243
    v_mfma_f32_16x16x32_bf16 v[60:63], v[220:223], v[172:175], v[60:63]
L_att_tc1:
    s_cbranch_vccz L_att_tk1
    s_call_b64 s[94:95], L_exact1
L_att_tk1:
    s_add_u32 s61, s61, 1
L_att_last1:
    s_bitcmp1_b32 s57, 0
    s_cbranch_scc1 L_att_lo1
    s_add_u32 s88, s88, 16384
    s_cmp_eq_u32 s88, 147456
    s_cselect_b32 s88, 65536, s88
    v_add_u32 v245, s88, v254
    ds_read_b128 v[192:195], v245 offset:0
    ds_read_b128 v[196:199], v245 offset:1024
    ds_read_b128 v[200:203], v245 offset:2048
    ds_read_b128 v[204:207], v245 offset:3072
    ds_read_b128 v[208:211], v245 offset:4096
    ds_read_b128 v[212:215], v245 offset:5120
    ds_read_b128 v[216:219], v245 offset:6144
    ds_read_b128 v[220:223], v245 offset:7168
    s_waitcnt lgkmcnt(6)
    v_mfma_f32_16x16x32_bf16 v[0:3], v[192:195], v[176:179], v[0:3]
    v_mfma_f32_16x16x32_bf16 v[4:7], v[192:195], v[180:183], v[4:7]
    v_mfma_f32_16x16x32_bf16 v[8:11], v[196:199], v[176:179], v[8:11]
    v_mfma_f32_16x16x32_bf16 v[12:15], v[196:199], v[180:183], v[12:15]
    s_waitcnt lgkmcnt(4)
    v_mfma_f32_16x16x32_bf16 v[16:19], v[200:203], v[176:179], v[16:19]
    v_mfma_f32_16x16x32_bf16 v[20:23], v[200:203], v[180:183], v[20:23]
    v_mfma_f32_16x16x32_bf16 v[24:27], v[204:207], v[176:179], v[24:27]
    v_mfma_f32_16x16x32_bf16 v[28:31], v[204:207], v[180:183], v[28:31]
    s_waitcnt lgkmcnt(2)
    v_mfma_f32_16x16x32_bf16 v[32:35], v[208:211], v[176:179], v[32:35]
    v_mfma_f32_16x16x32_bf16 v[36:39], v[208:211], v[180:183], v[36:39]
    v_mfma_f32_16x16x32_bf16 v[40:43], v[212:215], v[176:179], v[40:43]
    v_mfma_f32_16x16x32_bf16 v[44:47], v[212:215], v[180:183], v[44:47]
    s_waitcnt lgkmcnt(0)
    v_mfma_f32_16x16x32_bf16 v[48:51], v[216:219], v[176:179], v[48:51]
    v_mfma_f32_16x16x32_bf16 v[52:55], v[216:219], v[180:183], v[52:55]
    v_mfma_f32_16x16x32_bf16 v[56:59], v[220:223], v[176:179], v[56:59]
    v_mfma_f32_16x16x32_bf16 v[60:63], v[220:223], v[180:183], v[60:63]
    s_branch L_att_le1
L_att_lo1:
    s_add_u32 s88, s88, 16384
    s_cmp_eq_u32 s88, 147456
    s_cselect_b32 s88, 65536, s88
    v_add_u32 v245, s88, v254
    ds_read_b128 v[192:195], v245 offset:0
    ds_read_b128 v[196:199], v245 offset:1024
    ds_read_b128 v[200:203], v245 offset:2048
    ds_read_b128 v[204:207], v245 offset:3072
    ds_read_b128 v[208:211], v245 offset:4096
    ds_read_b128 v[212:215], v245 offset:5120
    ds_read_b128 v[216:219], v245 offset:6144
    ds_read_b128 v[220:223], v245 offset:7168
    s_waitcnt lgkmcnt(6)
    v_mfma_f32_16x16x32_bf16 v[0:3], v[192:195], v[176:179], v[0:3]
    v_mfma_f32_16x16x32_bf16 v[4:7], v[192:195], v[180:183], v[4:7]
    ds_read_b128 v[192:195], v245 offset:8192
    v_mfma_f32_16x16x32_bf16 v[8:11], v[196:199], v[176:179], v[8:11]
    v_mfma_f32_16x16x32_bf16 v[12:15], v[196:199], v[180:183], v[12:15]
    ds_read_b128 v[196:199], v245 offset:9216
    s_waitcnt lgkmcnt(6)
    v_mfma_f32_16x16x32_bf16 v[16:19], v[200:203], v[176:179], v[16:19]
    v_mfma_f32_16x16x32_bf16 v[20:23], v[200:203], v[180:183], v[20:23]
    ds_read_b128 v[200:203], v245 offset:10240
    v_mfma_f32_16x16x32_bf16 v[24:27], v[204:207], v[176:179], v[24:27]
    v_mfma_f32_16x16x32_bf16 v[28:31], v[204:207], v[180:183], v[28:31]
    ds_read_b128 v[204:207], v245 offset:11264
    s_waitcnt lgkmcnt(6)
    v_mfma_f32_16x16x32_bf16 v[32:35], v[208:211], v[176:179], v[32:35]
    v_mfma_f32_16x16x32_bf16 v[36:39], v[208:211], v[180:183], v[36:39]
    ds_read_b128 v[208:211], v245 offset:12288
    v_mfma_f32_16x16x32_bf16 v[40:43], v[212:215], v[176:179], v[40:43]
    v_mfma_f32_16x16x32_bf16 v[44:47], v[212:215], v[180:183], v[44:47]
    ds_read_b128 v[212:215], v245 offset:13312
    s_waitcnt lgkmcnt(6)
    v_mfma_f32_16x16x32_bf16 v[48:51], v[216:219], v[176:179], v[48:51]
    v_mfma_f32_16x16x32_bf16 v[52:55], v[216:219], v[180:183], v[52:55]
    ds_read_b128 v[216:219], v245 offset:14336
    v_mfma_f32_16x16x32_bf16 v[56:59], v[220:223], v[176:179], v[56:59]
    v_mfma_f32_16x16x32_bf16 v[60:63], v[220:223], v[180:183], v[60:63]
    ds_read_b128 v[220:223], v245 offset:15360
    s_waitcnt lgkmcnt(6)
    v_mfma_f32_16x16x32_bf16 v[0:3], v[192:195], v[184:187], v[0:3]
    v_mfma_f32_16x16x32_bf16 v[4:7], v[192:195], v[188:191], v[4:7]
    v_mfma_f32_16x16x32_bf16 v[8:11], v[196:199], v[184:187], v[8:11]
    v_mfma_f32_16x16x32_bf16 v[12:15], v[196:199], v[188:191], v[12:15]
    s_waitcnt lgkmcnt(4)
    v_mfma_f32_16x16x32_bf16 v[16:19], v[200:203], v[184:187], v[16:19]
    v_mfma_f32_16x16x32_bf16 v[20:23], v[200:203], v[188:191], v[20:23]
    v_mfma_f32_16x16x32_bf16 v[24:27], v[204:207], v[184:187], v[24:27]
    v_mfma_f32_16x16x32_bf16 v[28:31], v[204:207], v[188:191], v[28:31]
    s_waitcnt lgkmcnt(2)
    v_mfma_f32_16x16x32_bf16 v[32:35], v[208:211], v[184:187], v[32:35]
    v_mfma_f32_16x16x32_bf16 v[36:39], v[208:211], v[188:191], v[36:39]
    v_mfma_f32_16x16x32_bf16 v[40:43], v[212:215], v[184:187], v[40:43]
    v_mfma_f32_16x16x32_bf16 v[44:47], v[212:215], v[188:191], v[44:47]
    s_waitcnt lgkmcnt(0)
    v_mfma_f32_16x16x32_bf16 v[48:51], v[216:219], v[184:187], v[48:51]
    v_mfma_f32_16x16x32_bf16 v[52:55], v[216:219], v[188:191], v[52:55]
    v_mfma_f32_16x16x32_bf16 v[56:59], v[220:223], v[184:187], v[56:59]
    v_mfma_f32_16x16x32_bf16 v[60:63], v[220:223], v[188:191], v[60:63]
L_att_le1:
    s_branch L_att_epi
L_att_tail0:
    s_waitcnt lgkmcnt(0)
    s_mov_b32 s98, 1
    s_bitcmp1_b32 s57, 0
    s_cbranch_scc1 L_att_to0
    s_add_u32 s88, s88, 16384
    s_cmp_eq_u32 s88, 147456
    s_cselect_b32 s88, 65536, s88
    v_add_u32 v245, s88, v254
    ds_read_b128 v[192:195], v245 offset:0
    ds_read_b128 v[196:199], v245 offset:1024
    ds_read_b128 v[200:203], v245 offset:2048
    ds_read_b128 v[204:207], v245 offset:3072
    ds_read_b128 v[208:211], v245 offset:4096
    ds_read_b128 v[212:215], v245 offset:5120
    ds_read_b128 v[216:219], v245 offset:6144
    ds_read_b128 v[220:223], v245 offset:7168
    s_waitcnt lgkmcnt(6)
    v_mfma_f32_16x16x32_bf16 v[0:3], v[192:195], v[176:179], v[0:3]
    v_cndmask_b32 v64, v247, v64, s[80:81]
    v_mfma_f32_16x16x32_bf16 v[4:7], v[192:195], v[180:183], v[4:7]
    ds_read_b128 v[192:195], v245 offset:8192
    v_cndmask_b32 v65, v247, v65, s[82:83]
    v_mfma_f32_16x16x32_bf16 v[8:11], v[196:199], v[176:179], v[8:11]
    v_cndmask_b32 v66, v247, v66, s[84:85]
    v_mfma_f32_16x16x32_bf16 v[12:15], v[196:199], v[180:183], v[12:15]
    ds_read_b128 v[196:199], v245 offset:9216
    v_cndmask_b32 v67, v247, v67, s[86:87]
    s_waitcnt lgkmcnt(6)
    v_mfma_f32_16x16x32_bf16 v[16:19], v[200:203], v[176:179], v[16:19]
    v_cndmask_b32 v76, v247, v76, s[80:81]
    v_mfma_f32_16x16x32_bf16 v[20:23], v[200:203], v[180:183], v[20:23]
    ds_read_b128 v[200:203], v245 offset:10240
    v_cndmask_b32 v77, v247, v77, s[82:83]
    v_mfma_f32_16x16x32_bf16 v[24:27], v[204:207], v[176:179], v[24:27]
    v_cndmask_b32 v78, v247, v78, s[84:85]
    v_mfma_f32_16x16x32_bf16 v[28:31], v[204:207], v[180:183], v[28:31]
    ds_read_b128 v[204:207], v245 offset:11264
    v_cndmask_b32 v79, v247, v79, s[86:87]
    s_waitcnt lgkmcnt(6)
    v_mfma_f32_16x16x32_bf16 v[32:35], v[208:211], v[176:179], v[32:35]
    v_exp_f32 v232, v64
    v_exp_f32 v233, v65
    v_mfma_f32_16x16x32_bf16 v[36:39], v[208:211], v[180:183], v[36:39]
    ds_read_b128 v[208:211], v245 offset:12288
    v_add_f32 v242, v232, v233
    v_cvt_pk_bf16_f32 v160, v232, v233
    v_mfma_f32_16x16x32_bf16 v[40:43], v[212:215], v[176:179], v[40:43]
    v_exp_f32 v234, v66
    v_exp_f32 v235, v67
    v_mfma_f32_16x16x32_bf16 v[44:47], v[212:215], v[180:183], v[44:47]
    ds_read_b128 v[212:215], v245 offset:13312
    v_add_f32 v242, v242, v234
    v_add_f32 v242, v242, v235
    v_cvt_pk_bf16_f32 v161, v234, v235
    s_waitcnt lgkmcnt(6)
    v_mfma_f32_16x16x32_bf16 v[48:51], v[216:219], v[176:179], v[48:51]
    v_mov_b32 v162, 0
    v_mfma_f32_16x16x32_bf16 v[52:55], v[216:219], v[180:183], v[52:55]
    ds_read_b128 v[216:219], v245 offset:14336
    v_mov_b32 v163, 0
    v_mfma_f32_16x16x32_bf16 v[56:59], v[220:223], v[176:179], v[56:59]
    v_exp_f32 v232, v68
    v_exp_f32 v233, v69
    v_mfma_f32_16x16x32_bf16 v[60:63], v[220:223], v[180:183], v[60:63]
    ds_read_b128 v[220:223], v245 offset:15360
    v_add_f32 v243, v232, v233
    v_cvt_pk_bf16_f32 v164, v232, v233
    s_waitcnt lgkmcnt(6)
    v_mfma_f32_16x16x32_bf16 v[0:3], v[192:195], v[184:187], v[0:3]
    v_exp_f32 v234, v70
    v_exp_f32 v235, v71
    v_mfma_f32_16x16x32_bf16 v[4:7], v[192:195], v[188:191], v[4:7]
    v_add_f32 v243, v243, v234
    v_add_f32 v243, v243, v235
    v_cvt_pk_bf16_f32 v165, v234, v235
    v_mfma_f32_16x16x32_bf16 v[8:11], v[196:199], v[184:187], v[8:11]
    v_exp_f32 v232, v76
    v_exp_f32 v233, v77
    v_mfma_f32_16x16x32_bf16 v[12:15], v[196:199], v[188:191], v[12:15]
    v_add_f32 v243, v243, v232
    v_add_f32 v243, v243, v233
    v_cvt_pk_bf16_f32 v166, v232, v233
    s_waitcnt lgkmcnt(4)
    v_mfma_f32_16x16x32_bf16 v[16:19], v[200:203], v[184:187], v[16:19]
    v_exp_f32 v234, v78
    v_exp_f32 v235, v79
    v_mfma_f32_16x16x32_bf16 v[20:23], v[200:203], v[188:191], v[20:23]
    v_add_f32 v243, v243, v234
    v_add_f32 v243, v243, v235
    v_cvt_pk_bf16_f32 v167, v234, v235
    v_mfma_f32_16x16x32_bf16 v[24:27], v[204:207], v[184:187], v[24:27]
    v_add_f32 v236, v242, v243
    v_add_f32 v238, v240, v242
    v_mfma_f32_16x16x32_bf16 v[28:31], v[204:207], v[188:191], v[28:31]
    v_cmp_nge_f32 vcc, s96, v236
    v_add_f32 v239, v241, v243
    s_waitcnt lgkmcnt(2)
    v_mfma_f32_16x16x32_bf16 v[32:35], v[208:211], v[184:187], v[32:35]
    v_mfma_f32_16x16x32_bf16 v[36:39], v[208:211], v[188:191], v[36:39]
    v_mfma_f32_16x16x32_bf16 v[40:43], v[212:215], v[184:187], v[40:43]
    v_mfma_f32_16x16x32_bf16 v[44:47], v[212:215], v[188:191], v[44:47]
    s_waitcnt lgkmcnt(0)
    v_mfma_f32_16x16x32_bf16 v[48:51], v[216:219], v[184:187], v[48:51]
    v_mfma_f32_16x16x32_bf16 v[52:55], v[216:219], v[188:191], v[52:55]
    v_mfma_f32_16x16x32_bf16 v[56:59], v[220:223], v[184:187], v[56:59]
    v_mfma_f32_16x16x32_bf16 v[60:63], v[220:223], v[188:191], v[60:63]
    s_branch L_att_tc0
L_att_to0:
    s_add_u32 s88, s88, 16384
    s_cmp_eq_u32 s88, 147456
    s_cselect_b32 s88, 65536, s88
    v_add_u32 v245, s88, v254
    ds_read_b128 v[192:195], v245 offset:0
    ds_read_b128 v[196:199], v245 offset:1024
    ds_read_b128 v[200:203], v245 offset:2048
    ds_read_b128 v[204:207], v245 offset:3072
    ds_read_b128 v[208:211], v245 offset:4096
    ds_read_b128 v[212:215], v245 offset:5120
    ds_read_b128 v[216:219], v245 offset:6144
    ds_read_b128 v[220:223], v245 offset:7168
    s_waitcnt lgkmcnt(6)
    v_mfma_f32_16x16x32_bf16 v[0:3], v[192:195], v[176:179], v[0:3]
    v_cndmask_b32 v80, v247, v80, s[80:81]
    v_cndmask_b32 v81, v247, v81, s[82:83]
    v_mfma_f32_16x16x32_bf16 v[4:7], v[192:195], v[180:183], v[4:7]
    ds_read_b128 v[192:195], v245 offset:8192
    v_cndmask_b32 v82, v247, v82, s[84:85]
    v_mfma_f32_16x16x32_bf16 v[8:11], v[196:199], v[176:179], v[8:11]
    v_cndmask_b32 v83, v247, v83, s[86:87]
    v_mfma_f32_16x16x32_bf16 v[12:15], v[196:199], v[180:183], v[12:15]
    ds_read_b128 v[196:199], v245 offset:9216
    v_cndmask_b32 v92, v247, v92, s[80:81]
    v_cndmask_b32 v93, v247, v93, s[82:83]
    s_waitcnt lgkmcnt(6)
    v_mfma_f32_16x16x32_bf16 v[16:19], v[200:203], v[176:179], v[16:19]
    v_cndmask_b32 v94, v247, v94, s[84:85]
    v_mfma_f32_16x16x32_bf16 v[20:23], v[200:203], v[180:183], v[20:23]
    ds_read_b128 v[200:203], v245 offset:10240
    v_cndmask_b32 v95, v247, v95, s[86:87]
    v_mfma_f32_16x16x32_bf16 v[24:27], v[204:207], v[176:179], v[24:27]
    v_exp_f32 v232, v64
    v_exp_f32 v233, v65
    s_nop 0
    v_add_f32 v242, v232, v233
    v_cvt_pk_bf16_f32 v160, v232, v233
    v_mfma_f32_16x16x32_bf16 v[28:31], v[204:207], v[180:183], v[28:31]
    ds_read_b128 v[204:207], v245 offset:11264
    v_exp_f32 v234, v66
    v_exp_f32 v235, v67
    s_waitcnt lgkmcnt(6)
    v_mfma_f32_16x16x32_bf16 v[32:35], v[208:211], v[176:179], v[32:35]
    s_nop 0
    v_add_f32 v242, v242, v234
    v_add_f32 v242, v242, v235
    v_cvt_pk_bf16_f32 v161, v234, v235
    v_mfma_f32_16x16x32_bf16 v[36:39], v[208:211], v[180:183], v[36:39]
    ds_read_b128 v[208:211], v245 offset:12288
    v_exp_f32 v232, v72
    v_exp_f32 v233, v73
    v_mfma_f32_16x16x32_bf16 v[40:43], v[212:215], v[176:179], v[40:43]
    s_nop 0
    v_add_f32 v242, v242, v232
    v_add_f32 v242, v242, v233
    v_cvt_pk_bf16_f32 v162, v232, v233
    v_exp_f32 v234, v74
    v_exp_f32 v235, v75
    v_mfma_f32_16x16x32_bf16 v[44:47], v[212:215], v[180:183], v[44:47]
    ds_read_b128 v[212:215], v245 offset:13312
    s_nop 0
    v_add_f32 v242, v242, v234
    v_add_f32 v242, v242, v235
    v_cvt_pk_bf16_f32 v163, v234, v235
    s_waitcnt lgkmcnt(6)
    v_mfma_f32_16x16x32_bf16 v[48:51], v[216:219], v[176:179], v[48:51]
    v_exp_f32 v232, v80
    v_exp_f32 v233, v81
    v_mfma_f32_16x16x32_bf16 v[52:55], v[216:219], v[180:183], v[52:55]
    ds_read_b128 v[216:219], v245 offset:14336
    s_nop 0
    v_add_f32 v242, v242, v232
    v_add_f32 v242, v242, v233
    v_cvt_pk_bf16_f32 v168, v232, v233
    v_exp_f32 v234, v82
    v_exp_f32 v235, v83
    v_mfma_f32_16x16x32_bf16 v[56:59], v[220:223], v[176:179], v[56:59]
    s_nop 0
    v_add_f32 v242, v242, v234
    v_add_f32 v242, v242, v235
    v_cvt_pk_bf16_f32 v169, v234, v235
    v_mfma_f32_16x16x32_bf16 v[60:63], v[220:223], v[180:183], v[60:63]
    ds_read_b128 v[220:223], v245 offset:15360
    v_mov_b32 v170, 0
    s_waitcnt lgkmcnt(6)
    v_mfma_f32_16x16x32_bf16 v[0:3], v[192:195], v[184:187], v[0:3]
    v_mov_b32 v171, 0
    v_mfma_f32_16x16x32_bf16 v[4:7], v[192:195], v[188:191], v[4:7]
    v_exp_f32 v232, v68
    v_exp_f32 v233, v69
    s_nop 0
    v_add_f32 v243, v232, v233
    v_cvt_pk_bf16_f32 v164, v232, v233
    v_mfma_f32_16x16x32_bf16 v[8:11], v[196:199], v[184:187], v[8:11]
    v_exp_f32 v234, v70
    v_exp_f32 v235, v71
    v_mfma_f32_16x16x32_bf16 v[12:15], v[196:199], v[188:191], v[12:15]
    s_nop 0
    v_add_f32 v243, v243, v234
    v_add_f32 v243, v243, v235
    v_cvt_pk_bf16_f32 v165, v234, v235
    s_waitcnt lgkmcnt(4)
    v_mfma_f32_16x16x32_bf16 v[16:19], v[200:203], v[184:187], v[16:19]
    v_exp_f32 v232, v76
    v_exp_f32 v233, v77
    s_nop 0
    v_add_f32 v243, v243, v232
    v_add_f32 v243, v243, v233
    v_cvt_pk_bf16_f32 v166, v232, v233
    v_mfma_f32_16x16x32_bf16 v[20:23], v[200:203], v[188:191], v[20:23]
    v_exp_f32 v234, v78
    v_exp_f32 v235, v79
    v_mfma_f32_16x16x32_bf16 v[24:27], v[204:207], v[184:187], v[24:27]
    s_nop 0
    v_add_f32 v243, v243, v234
    v_add_f32 v243, v243, v235
    v_cvt_pk_bf16_f32 v167, v234, v235
    v_mfma_f32_16x16x32_bf16 v[28:31], v[204:207], v[188:191], v[28:31]
    v_exp_f32 v232, v84
    v_exp_f32 v233, v85
    s_waitcnt lgkmcnt(2)
    v_mfma_f32_16x16x32_bf16 v[32:35], v[208:211], v[184:187], v[32:35]
    s_nop 0
    v_add_f32 v243, v243, v232
    v_add_f32 v243, v243, v233
    v_cvt_pk_bf16_f32 v172, v232, v233
    v_exp_f32 v234, v86
    v_exp_f32 v235, v87
    v_mfma_f32_16x16x32_bf16 v[36:39], v[208:211], v[188:191], v[36:39]
    s_nop 0
    v_add_f32 v243, v243, v234
    v_add_f32 v243, v243, v235
    v_cvt_pk_bf16_f32 v173, v234, v235
    v_mfma_f32_16x16x32_bf16 v[40:43], v[212:215], v[184:187], v[40:43]
    v_exp_f32 v232, v92
    v_exp_f32 v233, v93
    v_mfma_f32_16x16x32_bf16 v[44:47], v[212:215], v[188:191], v[44:47]
    s_nop 0
    v_add_f32 v243, v243, v232
    v_add_f32 v243, v243, v233
    v_cvt_pk_bf16_f32 v174, v232, v233
    v_exp_f32 v234, v94
    v_exp_f32 v235, v95
    s_waitcnt lgkmcnt(0)
    v_mfma_f32_16x16x32_bf16 v[48:51], v[216:219], v[184:187], v[48:51]
    s_nop 0
    v_add_f32 v243, v243, v234
    v_add_f32 v243, v243, v235
    v_cvt_pk_bf16_f32 v175, v234, v235
    v_mfma_f32_16x16x32_bf16 v[52:55], v[216:219], v[188:191], v[52:55]
    s_nop 0
    v_add_f32 v236, v242, v243
    v_add_f32 v238, v240, v242
    v_mfma_f32_16x16x32_bf16 v[56:59], v[220:223], v[184:187], v[56:59]
    v_cmp_nge_f32 vcc, s96, v236
    v_add_f32 v239, v241, v243
    v_mfma_f32_16x16x32_bf16 v[60:63], v[220:223], v[188:191], v[60:63]
L_att_tc0:
    s_cbranch_vccz L_att_tk0
    s_call_b64 s[94:95], L_exact0
L_att_tk0:
    s_add_u32 s61, s61, 1
L_att_last0:
    s_cmp_eq_u32 s56, 0
    s_cbranch_scc1 L_sa79
    s_waitcnt vmcnt(0)
    s_barrier
    s_add_u32 s93, s61, 2
    s_cmp_ge_i32 s93, s60
    s_cbranch_scc1 L_sb79
    s_add_u32 s93, s61, 4
    s_and_b32 s100, s93, 3
    s_lshl_b32 s100, s100, 14
    s_add_u32 m0, s100, s92
    s_lshl_b32 s101, s93, 14
    s_add_u32 s101, s101, s62
    s_cmp_lt_i32 s93, s60
    s_cselect_b32 s101, s101, 1073741824
    buffer_load_dwordx4 v254, s[52:55], s101 offen offset:0 sc1 lds
    buffer_load_dwordx4 v254, s[52:55], s101 offen offset:1024 sc1 lds
    buffer_load_dwordx4 v254, s[52:55], s101 offen offset:2048 sc1 lds
    buffer_load_dwordx4 v254, s[52:55], s101 offen offset:3072 sc1 lds
    s_add_u32 s93, s61, 5
    s_and_b32 s100, s93, 3
    s_lshl_b32 s100, s100, 14
    s_add_u32 m0, s100, s92
    s_lshl_b32 s101, s93, 14
    s_add_u32 s101, s101, s62
    s_cmp_lt_i32 s93, s60
    s_cselect_b32 s101, s101, 1073741824
    buffer_load_dwordx4 v254, s[52:55], s101 offen offset:0 sc1 lds
    buffer_load_dwordx4 v254, s[52:55], s101 offen offset:1024 sc1 lds
    buffer_load_dwordx4 v254, s[52:55], s101 offen offset:2048 sc1 lds
    buffer_load_dwordx4 v254, s[52:55], s101 offen offset:3072 sc1 lds
    s_add_u32 s89, s89, 16384
    s_cmp_eq_u32 s89, 147456
    s_cselect_b32 s89, 65536, s89
    s_add_u32 s93, s61, 2
    s_add_u32 m0, s92, s89
    s_lshl_b32 s101, s93, 14
    s_add_u32 s101, s101, s63
    s_cmp_lt_i32 s93, s60
    s_cselect_b32 s101, s101, 1073741824
    buffer_load_dwordx4 v254, s[52:55], s101 offen offset:0 sc1 lds
    buffer_load_dwordx4 v254, s[52:55], s101 offen offset:1024 sc1 lds
    buffer_load_dwordx4 v254, s[52:55], s101 offen offset:2048 sc1 lds
    buffer_load_dwordx4 v254, s[52:55], s101 offen offset:3072 sc1 lds
    s_add_u32 s89, s89, 16384
    s_cmp_eq_u32 s89, 147456
    s_cselect_b32 s89, 65536, s89
    s_add_u32 s93, s61, 3
    s_add_u32 m0, s92, s89
    s_lshl_b32 s101, s93, 14
    s_add_u32 s101, s101, s63
    s_cmp_lt_i32 s93, s60
    s_cselect_b32 s101, s101, 1073741824
    buffer_load_dwordx4 v254, s[52:55], s101 offen offset:0 sc1 lds
    buffer_load_dwordx4 v254, s[52:55], s101 offen offset:1024 sc1 lds
    buffer_load_dwordx4 v254, s[52:55], s101 offen offset:2048 sc1 lds
    buffer_load_dwordx4 v254, s[52:55], s101 offen offset:3072 sc1 lds
    s_branch L_sb79
    L_sa79:
    s_barrier
    L_sb79:
    s_bitcmp1_b32 s57, 0
    s_cbranch_scc1 L_att_lo0
    s_add_u32 s88, s88, 16384
    s_cmp_eq_u32 s88, 147456
    s_cselect_b32 s88, 65536, s88
    v_add_u32 v245, s88, v254
    ds_read_b128 v[192:195], v245 offset:0
    ds_read_b128 v[196:199], v245 offset:1024
    ds_read_b128 v[200:203], v245 offset:2048
    ds_read_b128 v[204:207], v245 offset:3072
    ds_read_b128 v[208:211], v245 offset:4096
    ds_read_b128 v[212:215], v245 offset:5120
    ds_read_b128 v[216:219], v245 offset:6144
    ds_read_b128 v[220:223], v245 offset:7168
    s_waitcnt lgkmcnt(6)
    v_mfma_f32_16x16x32_bf16 v[0:3], v[192:195], v[160:163], v[0:3]
    v_mfma_f32_16x16x32_bf16 v[4:7], v[192:195], v[164:167], v[4:7]
    v_mfma_f32_16x16x32_bf16 v[8:11], v[196:199], v[160:163], v[8:11]
    v_mfma_f32_16x16x32_bf16 v[12:15], v[196:199], v[164:167], v[12:15]
    s_waitcnt lgkmcnt(4)
    v_mfma_f32_16x16x32_bf16 v[16:19], v[200:203], v[160:163], v[16:19]
    v_mfma_f32_16x16x32_bf16 v[20:23], v[200:203], v[164:167], v[20:23]
    v_mfma_f32_16x16x32_bf16 v[24:27], v[204:207], v[160:163], v[24:27]
    v_mfma_f32_16x16x32_bf16 v[28:31], v[204:207], v[164:167], v[28:31]
    s_waitcnt lgkmcnt(2)
    v_mfma_f32_16x16x32_bf16 v[32:35], v[208:211], v[160:163], v[32:35]
    v_mfma_f32_16x16x32_bf16 v[36:39], v[208:211], v[164:167], v[36:39]
    v_mfma_f32_16x16x32_bf16 v[40:43], v[212:215], v[160:163], v[40:43]
    v_mfma_f32_16x16x32_bf16 v[44:47], v[212:215], v[164:167], v[44:47]
    s_waitcnt lgkmcnt(0)
    v_mfma_f32_16x16x32_bf16 v[48:51], v[216:219], v[160:163], v[48:51]
    v_mfma_f32_16x16x32_bf16 v[52:55], v[216:219], v[164:167], v[52:55]
    v_mfma_f32_16x16x32_bf16 v[56:59], v[220:223], v[160:163], v[56:59]
    v_mfma_f32_16x16x32_bf16 v[60:63], v[220:223], v[164:167], v[60:63]
    s_branch L_att_le0
L_att_lo0:
    s_add_u32 s88, s88, 16384
    s_cmp_eq_u32 s88, 147456
    s_cselect_b32 s88, 65536, s88
    v_add_u32 v245, s88, v254
    ds_read_b128 v[192:195], v245 offset:0
    ds_read_b128 v[196:199], v245 offset:1024
    ds_read_b128 v[200:203], v245 offset:2048
    ds_read_b128 v[204:207], v245 offset:3072
    ds_read_b128 v[208:211], v245 offset:4096
    ds_read_b128 v[212:215], v245 offset:5120
    ds_read_b128 v[216:219], v245 offset:6144
    ds_read_b128 v[220:223], v245 offset:7168
    s_waitcnt lgkmcnt(6)
    v_mfma_f32_16x16x32_bf16 v[0:3], v[192:195], v[160:163], v[0:3]
    v_mfma_f32_16x16x32_bf16 v[4:7], v[192:195], v[164:167], v[4:7]
    ds_read_b128 v[192:195], v245 offset:8192
    v_mfma_f32_16x16x32_bf16 v[8:11], v[196:199], v[160:163], v[8:11]
    v_mfma_f32_16x16x32_bf16 v[12:15], v[196:199], v[164:167], v[12:15]
    ds_read_b128 v[196:199], v245 offset:9216
    s_waitcnt lgkmcnt(6)
    v_mfma_f32_16x16x32_bf16 v[16:19], v[200:203], v[160:163], v[16:19]
    v_mfma_f32_16x16x32_bf16 v[20:23], v[200:203], v[164:167], v[20:23]
    ds_read_b128 v[200:203], v245 offset:10240
    v_mfma_f32_16x16x32_bf16 v[24:27], v[204:207], v[160:163], v[24:27]
    v_mfma_f32_16x16x32_bf16 v[28:31], v[204:207], v[164:167], v[28:31]
    ds_read_b128 v[204:207], v245 offset:11264
    s_waitcnt lgkmcnt(6)
    v_mfma_f32_16x16x32_bf16 v[32:35], v[208:211], v[160:163], v[32:35]
    v_mfma_f32_16x16x32_bf16 v[36:39], v[208:211], v[164:167], v[36:39]
    ds_read_b128 v[208:211], v245 offset:12288
    v_mfma_f32_16x16x32_bf16 v[40:43], v[212:215], v[160:163], v[40:43]
    v_mfma_f32_16x16x32_bf16 v[44:47], v[212:215], v[164:167], v[44:47]
    ds_read_b128 v[212:215], v245 offset:13312
    s_waitcnt lgkmcnt(6)
    v_mfma_f32_16x16x32_bf16 v[48:51], v[216:219], v[160:163], v[48:51]
    v_mfma_f32_16x16x32_bf16 v[52:55], v[216:219], v[164:167], v[52:55]
    ds_read_b128 v[216:219], v245 offset:14336
    v_mfma_f32_16x16x32_bf16 v[56:59], v[220:223], v[160:163], v[56:59]
    v_mfma_f32_16x16x32_bf16 v[60:63], v[220:223], v[164:167], v[60:63]
    ds_read_b128 v[220:223], v245 offset:15360
    s_waitcnt lgkmcnt(6)
    v_mfma_f32_16x16x32_bf16 v[0:3], v[192:195], v[168:171], v[0:3]
    v_mfma_f32_16x16x32_bf16 v[4:7], v[192:195], v[172:175], v[4:7]
    v_mfma_f32_16x16x32_bf16 v[8:11], v[196:199], v[168:171], v[8:11]
    v_mfma_f32_16x16x32_bf16 v[12:15], v[196:199], v[172:175], v[12:15]
    s_waitcnt lgkmcnt(4)
    v_mfma_f32_16x16x32_bf16 v[16:19], v[200:203], v[168:171], v[16:19]
    v_mfma_f32_16x16x32_bf16 v[20:23], v[200:203], v[172:175], v[20:23]
    v_mfma_f32_16x16x32_bf16 v[24:27], v[204:207], v[168:171], v[24:27]
    v_mfma_f32_16x16x32_bf16 v[28:31], v[204:207], v[172:175], v[28:31]
    s_waitcnt lgkmcnt(2)
    v_mfma_f32_16x16x32_bf16 v[32:35], v[208:211], v[168:171], v[32:35]
    v_mfma_f32_16x16x32_bf16 v[36:39], v[208:211], v[172:175], v[36:39]
    v_mfma_f32_16x16x32_bf16 v[40:43], v[212:215], v[168:171], v[40:43]
    v_mfma_f32_16x16x32_bf16 v[44:47], v[212:215], v[172:175], v[44:47]
    s_waitcnt lgkmcnt(0)
    v_mfma_f32_16x16x32_bf16 v[48:51], v[216:219], v[168:171], v[48:51]
    v_mfma_f32_16x16x32_bf16 v[52:55], v[216:219], v[172:175], v[52:55]
    v_mfma_f32_16x16x32_bf16 v[56:59], v[220:223], v[168:171], v[56:59]
    v_mfma_f32_16x16x32_bf16 v[60:63], v[220:223], v[172:175], v[60:63]
L_att_le0:
    v_mov_b32 v240, v238
    v_mov_b32 v241, v239
    s_add_u32 s61, s61, 1
    s_branch L_att_epi
L_exact0:
    s_nop 7
    s_cmp_eq_u32 s98, 0
    s_cbranch_scc1 L_exact_nm0
    v_cmp_ge_i32 s[64:65], v246, 0
    v_cmp_ge_i32 s[66:67], v246, 1
    v_cmp_ge_i32 s[68:69], v246, 2
    v_cmp_ge_i32 s[70:71], v246, 3
    v_cndmask_b32 v64, v247, v64, s[64:65]
    v_cmp_ge_i32 s[64:65], v246, -16
    v_cndmask_b32 v65, v247, v65, s[66:67]
    v_cmp_ge_i32 s[66:67], v246, -15
    v_cndmask_b32 v66, v247, v66, s[68:69]
    v_cmp_ge_i32 s[68:69], v246, -14
    v_cndmask_b32 v67, v247, v67, s[70:71]
    v_cmp_ge_i32 s[70:71], v246, -13
    v_cndmask_b32 v68, v247, v68, s[64:65]
    v_cmp_ge_i32 s[64:65], v246, 16
    v_cndmask_b32 v69, v247, v69, s[66:67]
    v_cmp_ge_i32 s[66:67], v246, 17
    v_cndmask_b32 v70, v247, v70, s[68:69]
    v_cmp_ge_i32 s[68:69], v246, 18
    v_cndmask_b32 v71, v247, v71, s[70:71]
    v_cmp_ge_i32 s[70:71], v246, 19
    v_cndmask_b32 v72, v247, v72, s[64:65]
    v_cmp_ge_i32 s[64:65], v246, 0
    v_cndmask_b32 v73, v247, v73, s[66:67]
    v_cmp_ge_i32 s[66:67], v246, 1
    v_cndmask_b32 v74, v247, v74, s[68:69]
    v_cmp_ge_i32 s[68:69], v246, 2
    v_cndmask_b32 v75, v247, v75, s[70:71]
    v_cmp_ge_i32 s[70:71], v246, 3
    v_cndmask_b32 v76, v247, v76, s[64:65]
    v_cmp_ge_i32 s[64:65], v246, 32
    v_cndmask_b32 v77, v247, v77, s[66:67]
    v_cmp_ge_i32 s[66:67], v246, 33
    v_cndmask_b32 v78, v247, v78, s[68:69]
    v_cmp_ge_i32 s[68:69], v246, 34
    v_cndmask_b32 v79, v247, v79, s[70:71]
    v_cmp_ge_i32 s[70:71], v246, 35
    v_cndmask_b32 v80, v247, v80, s[64:65]
    v_cmp_ge_i32 s[64:65], v246, 16
    v_cndmask_b32 v81, v247, v81, s[66:67]
    v_cmp_ge_i32 s[66:67], v246, 17
    v_cndmask_b32 v82, v247, v82, s[68:69]
    v_cmp_ge_i32 s[68:69], v246, 18
    v_cndmask_b32 v83, v247, v83, s[70:71]
    v_cmp_ge_i32 s[70:71], v246, 19
    v_cndmask_b32 v84, v247, v84, s[64:65]
    v_cmp_ge_i32 s[64:65], v246, 48
    v_cndmask_b32 v85, v247, v85, s[66:67]
    v_cmp_ge_i32 s[66:67], v246, 49
    v_cndmask_b32 v86, v247, v86, s[68:69]
    v_cmp_ge_i32 s[68:69], v246, 50
    v_cndmask_b32 v87, v247, v87, s[70:71]
    v_cmp_ge_i32 s[70:71], v246, 51
    v_cndmask_b32 v88, v247, v88, s[64:65]
    v_cmp_ge_i32 s[64:65], v246, 32
    v_cndmask_b32 v89, v247, v89, s[66:67]
    v_cmp_ge_i32 s[66:67], v246, 33
    v_cndmask_b32 v90, v247, v90, s[68:69]
    v_cmp_ge_i32 s[68:69], v246, 34
    v_cndmask_b32 v91, v247, v91, s[70:71]
    v_cmp_ge_i32 s[70:71], v246, 35
    v_cndmask_b32 v92, v247, v92, s[64:65]
    s_nop 0
    v_cndmask_b32 v93, v247, v93, s[66:67]
    s_nop 0
    v_cndmask_b32 v94, v247, v94, s[68:69]
    s_nop 0
    v_cndmask_b32 v95, v247, v95, s[70:71]
L_exact_nm0:
    v_max3_f32 v232, v64, v65, v66
    v_max3_f32 v232, v232, v67, v72
    v_max3_f32 v232, v232, v73, v74
    v_max3_f32 v232, v232, v75, v80
    v_max3_f32 v232, v232, v81, v82
    v_max3_f32 v232, v232, v83, v88
    v_max3_f32 v232, v232, v89, v90
    v_max_f32 v232, v232, v91
    v_max3_f32 v233, v68, v69, v70
    v_max3_f32 v233, v233, v71, v76
    v_max3_f32 v233, v233, v77, v78
    v_max3_f32 v233, v233, v79, v84
    v_max3_f32 v233, v233, v85, v86
    v_max3_f32 v233, v233, v87, v92
    v_max3_f32 v233, v233, v93, v94
    v_max_f32 v233, v233, v95
    v_mov_b32 v236, v232
    v_mov_b32 v237, v233
    s_nop 1
    v_permlane16_swap_b32 v232, v236
    v_permlane16_swap_b32 v233, v237
    v_max_f32 v232, v232, v236
    v_max_f32 v233, v233, v237
    v_mov_b32 v236, v232
    v_mov_b32 v237, v233
    s_nop 1
    v_permlane32_swap_b32 v232, v236
    v_permlane32_swap_b32 v233, v237
    v_max_f32 v232, v232, v236
    v_max_f32 v233, v233, v237
    v_max_f32 v232, s97, v232
    v_max_f32 v234, 0, v232
    v_exp_f32 v234, -v234
    v_max_f32 v233, s97, v233
    v_max_f32 v235, 0, v233
    v_exp_f32 v235, -v235
    v_sub_f32 v236, v64, v232
    v_sub_f32 v237, v65, v232
    v_exp_f32 v236, v236
    v_exp_f32 v237, v237
    s_nop 0
    v_add_f32 v242, v236, v237
    v_cvt_pk_bf16_f32 v160, v236, v237
    v_sub_f32 v236, v66, v232
    v_sub_f32 v237, v67, v232
    v_exp_f32 v236, v236
    v_exp_f32 v237, v237
    s_nop 0
    v_add_f32 v242, v242, v236
    v_add_f32 v242, v242, v237
    v_cvt_pk_bf16_f32 v161, v236, v237
    v_sub_f32 v236, v72, v232
    v_sub_f32 v237, v73, v232
    v_exp_f32 v236, v236
    v_exp_f32 v237, v237
    s_nop 0
    v_add_f32 v242, v242, v236
    v_add_f32 v242, v242, v237
    v_cvt_pk_bf16_f32 v162, v236, v237
    v_sub_f32 v236, v74, v232
    v_sub_f32 v237, v75, v232
    v_exp_f32 v236, v236
    v_exp_f32 v237, v237
    s_nop 0
    v_add_f32 v242, v242, v236
    v_add_f32 v242, v242, v237
    v_cvt_pk_bf16_f32 v163, v236, v237
    v_sub_f32 v236, v80, v232
    v_sub_f32 v237, v81, v232
    v_exp_f32 v236, v236
    v_exp_f32 v237, v237
    s_nop 0
    v_add_f32 v242, v242, v236
    v_add_f32 v242, v242, v237
    v_cvt_pk_bf16_f32 v168, v236, v237
    v_sub_f32 v236, v82, v232
    v_sub_f32 v237, v83, v232
    v_exp_f32 v236, v236
    v_exp_f32 v237, v237
    s_nop 0
    v_add_f32 v242, v242, v236
    v_add_f32 v242, v242, v237
    v_cvt_pk_bf16_f32 v169, v236, v237
    v_sub_f32 v236, v88, v232
    v_sub_f32 v237, v89, v232
    v_exp_f32 v236, v236
    v_exp_f32 v237, v237
    s_nop 0
    v_add_f32 v242, v242, v236
    v_add_f32 v242, v242, v237
    v_cvt_pk_bf16_f32 v170, v236, v237
    v_sub_f32 v236, v90, v232
    v_sub_f32 v237, v91, v232
    v_exp_f32 v236, v236
    v_exp_f32 v237, v237
    s_nop 0
    v_add_f32 v242, v242, v236
    v_add_f32 v242, v242, v237
    v_cvt_pk_bf16_f32 v171, v236, v237
    v_sub_f32 v236, v68, v233
    v_sub_f32 v237, v69, v233
    v_exp_f32 v236, v236
    v_exp_f32 v237, v237
    s_nop 0
    v_add_f32 v243, v236, v237
    v_cvt_pk_bf16_f32 v164, v236, v237
    v_sub_f32 v236, v70, v233
    v_sub_f32 v237, v71, v233
    v_exp_f32 v236, v236
    v_exp_f32 v237, v237
    s_nop 0
    v_add_f32 v243, v243, v236
    v_add_f32 v243, v243, v237
    v_cvt_pk_bf16_f32 v165, v236, v237
    v_sub_f32 v236, v76, v233
    v_sub_f32 v237, v77, v233
    v_exp_f32 v236, v236
    v_exp_f32 v237, v237
    s_nop 0
    v_add_f32 v243, v243, v236
    v_add_f32 v243, v243, v237
    v_cvt_pk_bf16_f32 v166, v236, v237
    v_sub_f32 v236, v78, v233
    v_sub_f32 v237, v79, v233
    v_exp_f32 v236, v236
    v_exp_f32 v237, v237
    s_nop 0
    v_add_f32 v243, v243, v236
    v_add_f32 v243, v243, v237
    v_cvt_pk_bf16_f32 v167, v236, v237
    v_sub_f32 v236, v84, v233
    v_sub_f32 v237, v85, v233
    v_exp_f32 v236, v236
    v_exp_f32 v237, v237
    s_nop 0
    v_add_f32 v243, v243, v236
    v_add_f32 v243, v243, v237
    v_cvt_pk_bf16_f32 v172, v236, v237
    v_sub_f32 v236, v86, v233
    v_sub_f32 v237, v87, v233
    v_exp_f32 v236, v236
    v_exp_f32 v237, v237
    s_nop 0
    v_add_f32 v243, v243, v236
    v_add_f32 v243, v243, v237
    v_cvt_pk_bf16_f32 v173, v236, v237
    v_sub_f32 v236, v92, v233
    v_sub_f32 v237, v93, v233
    v_exp_f32 v236, v236
    v_exp_f32 v237, v237
    s_nop 0
    v_add_f32 v243, v243, v236
    v_add_f32 v243, v243, v237
    v_cvt_pk_bf16_f32 v174, v236, v237
    v_sub_f32 v236, v94, v233
    v_sub_f32 v237, v95, v233
    v_exp_f32 v236, v236
    v_exp_f32 v237, v237
    s_nop 0
    v_add_f32 v243, v243, v236
    v_add_f32 v243, v243, v237
    v_cvt_pk_bf16_f32 v175, v236, v237
    v_fma_f32 v238, v240, v234, v242
    v_fma_f32 v239, v241, v235, v243
    s_cmp_lg_u32 s97, 0
    s_cbranch_scc1 L_exact_no0
    v_mul_f32 v0, v0, v234
    v_mul_f32 v1, v1, v234
    v_mul_f32 v2, v2, v234
    v_mul_f32 v3, v3, v234
    v_mul_f32 v4, v4, v235
    v_mul_f32 v5, v5, v235
    v_mul_f32 v6, v6, v235
    v_mul_f32 v7, v7, v235
    v_mul_f32 v8, v8, v234
    v_mul_f32 v9, v9, v234
    v_mul_f32 v10, v10, v234
    v_mul_f32 v11, v11, v234
    v_mul_f32 v12, v12, v235
    v_mul_f32 v13, v13, v235
    v_mul_f32 v14, v14, v235
    v_mul_f32 v15, v15, v235
    v_mul_f32 v16, v16, v234
    v_mul_f32 v17, v17, v234
    v_mul_f32 v18, v18, v234
    v_mul_f32 v19, v19, v234
    v_mul_f32 v20, v20, v235
    v_mul_f32 v21, v21, v235
    v_mul_f32 v22, v22, v235
    v_mul_f32 v23, v23, v235
    v_mul_f32 v24, v24, v234
    v_mul_f32 v25, v25, v234
    v_mul_f32 v26, v26, v234
    v_mul_f32 v27, v27, v234
    v_mul_f32 v28, v28, v235
    v_mul_f32 v29, v29, v235
    v_mul_f32 v30, v30, v235
    v_mul_f32 v31, v31, v235
    v_mul_f32 v32, v32, v234
    v_mul_f32 v33, v33, v234
    v_mul_f32 v34, v34, v234
    v_mul_f32 v35, v35, v234
    v_mul_f32 v36, v36, v235
    v_mul_f32 v37, v37, v235
    v_mul_f32 v38, v38, v235
    v_mul_f32 v39, v39, v235
    v_mul_f32 v40, v40, v234
    v_mul_f32 v41, v41, v234
    v_mul_f32 v42, v42, v234
    v_mul_f32 v43, v43, v234
    v_mul_f32 v44, v44, v235
    v_mul_f32 v45, v45, v235
    v_mul_f32 v46, v46, v235
    v_mul_f32 v47, v47, v235
    v_mul_f32 v48, v48, v234
    v_mul_f32 v49, v49, v234
    v_mul_f32 v50, v50, v234
    v_mul_f32 v51, v51, v234
    v_mul_f32 v52, v52, v235
    v_mul_f32 v53, v53, v235
    v_mul_f32 v54, v54, v235
    v_mul_f32 v55, v55, v235
    v_mul_f32 v56, v56, v234
    v_mul_f32 v57, v57, v234
    v_mul_f32 v58, v58, v234
    v_mul_f32 v59, v59, v234
    v_mul_f32 v60, v60, v235
    v_mul_f32 v61, v61, v235
    v_mul_f32 v62, v62, v235
    v_mul_f32 v63, v63, v235
L_exact_no0:
    s_cmp_lg_u32 s98, 0
    s_cbranch_scc1 L_exact_ns0
    v_sub_f32 v96, v96, v232
    v_sub_f32 v97, v97, v232
    v_sub_f32 v98, v98, v232
    v_sub_f32 v99, v99, v232
    v_sub_f32 v100, v100, v233
    v_sub_f32 v101, v101, v233
    v_sub_f32 v102, v102, v233
    v_sub_f32 v103, v103, v233
    v_sub_f32 v104, v104, v232
    v_sub_f32 v105, v105, v232
    v_sub_f32 v106, v106, v232
    v_sub_f32 v107, v107, v232
    v_sub_f32 v108, v108, v233
    v_sub_f32 v109, v109, v233
    v_sub_f32 v110, v110, v233
    v_sub_f32 v111, v111, v233
    v_sub_f32 v112, v112, v232
    v_sub_f32 v113, v113, v232
    v_sub_f32 v114, v114, v232
    v_sub_f32 v115, v115, v232
    v_sub_f32 v116, v116, v233
    v_sub_f32 v117, v117, v233
    v_sub_f32 v118, v118, v233
    v_sub_f32 v119, v119, v233
    v_sub_f32 v120, v120, v232
    v_sub_f32 v121, v121, v232
    v_sub_f32 v122, v122, v232
    v_sub_f32 v123, v123, v232
    v_sub_f32 v124, v124, v233
    v_sub_f32 v125, v125, v233
    v_sub_f32 v126, v126, v233
    v_sub_f32 v127, v127, v233
    v_sub_f32 v224, v224, v232
    v_sub_f32 v225, v225, v232
    v_sub_f32 v226, v226, v232
    v_sub_f32 v227, v227, v232
    v_sub_f32 v228, v228, v233
    v_sub_f32 v229, v229, v233
    v_sub_f32 v230, v230, v233
    v_sub_f32 v231, v231, v233
L_exact_ns0:
    s_mov_b32 s97, 0
    s_nop 1
    s_setpc_b64 s[94:95]
L_exact1:
    s_nop 7
    s_cmp_eq_u32 s98, 0
    s_cbranch_scc1 L_exact_nm1
    v_cmp_ge_i32 s[64:65], v246, 0
    v_cmp_ge_i32 s[66:67], v246, 1
    v_cmp_ge_i32 s[68:69], v246, 2
    v_cmp_ge_i32 s[70:71], v246, 3
    v_cndmask_b32 v96, v247, v96, s[64:65]
    v_cmp_ge_i32 s[64:65], v246, -16
    v_cndmask_b32 v97, v247, v97, s[66:67]
    v_cmp_ge_i32 s[66:67], v246, -15
    v_cndmask_b32 v98, v247, v98, s[68:69]
    v_cmp_ge_i32 s[68:69], v246, -14
    v_cndmask_b32 v99, v247, v99, s[70:71]
    v_cmp_ge_i32 s[70:71], v246, -13
    v_cndmask_b32 v100, v247, v100, s[64:65]
    v_cmp_ge_i32 s[64:65], v246, 16
    v_cndmask_b32 v101, v247, v101, s[66:67]
    v_cmp_ge_i32 s[66:67], v246, 17
    v_cndmask_b32 v102, v247, v102, s[68:69]
    v_cmp_ge_i32 s[68:69], v246, 18
    v_cndmask_b32 v103, v247, v103, s[70:71]
    v_cmp_ge_i32 s[70:71], v246, 19
    v_cndmask_b32 v104, v247, v104, s[64:65]
    v_cmp_ge_i32 s[64:65], v246, 0
    v_cndmask_b32 v105, v247, v105, s[66:67]
    v_cmp_ge_i32 s[66:67], v246, 1
    v_cndmask_b32 v106, v247, v106, s[68:69]
    v_cmp_ge_i32 s[68:69], v246, 2
    v_cndmask_b32 v107, v247, v107, s[70:71]
    v_cmp_ge_i32 s[70:71], v246, 3
    v_cndmask_b32 v108, v247, v108, s[64:65]
    v_cmp_ge_i32 s[64:65], v246, 32
    v_cndmask_b32 v109, v247, v109, s[66:67]
    v_cmp_ge_i32 s[66:67], v246, 33
    v_cndmask_b32 v110, v247, v110, s[68:69]
    v_cmp_ge_i32 s[68:69], v246, 34
    v_cndmask_b32 v111, v247, v111, s[70:71]
    v_cmp_ge_i32 s[70:71], v246, 35
    v_cndmask_b32 v112, v247, v112, s[64:65]
    v_cmp_ge_i32 s[64:65], v246, 16
    v_cndmask_b32 v113, v247, v113, s[66:67]
    v_cmp_ge_i32 s[66:67], v246, 17
    v_cndmask_b32 v114, v247, v114, s[68:69]
    v_cmp_ge_i32 s[68:69], v246, 18
    v_cndmask_b32 v115, v247, v115, s[70:71]
    v_cmp_ge_i32 s[70:71], v246, 19
    v_cndmask_b32 v116, v247, v116, s[64:65]
    v_cmp_ge_i32 s[64:65], v246, 48
    v_cndmask_b32 v117, v247, v117, s[66:67]
    v_cmp_ge_i32 s[66:67], v246, 49
    v_cndmask_b32 v118, v247, v118, s[68:69]
    v_cmp_ge_i32 s[68:69], v246, 50
    v_cndmask_b32 v119, v247, v119, s[70:71]
    v_cmp_ge_i32 s[70:71], v246, 51
    v_cndmask_b32 v120, v247, v120, s[64:65]
    v_cmp_ge_i32 s[64:65], v246, 32
    v_cndmask_b32 v121, v247, v121, s[66:67]
    v_cmp_ge_i32 s[66:67], v246, 33
    v_cndmask_b32 v122, v247, v122, s[68:69]
    v_cmp_ge_i32 s[68:69], v246, 34
    v_cndmask_b32 v123, v247, v123, s[70:71]
    v_cmp_ge_i32 s[70:71], v246, 35
    v_cndmask_b32 v124, v247, v124, s[64:65]
    s_nop 0
    v_cndmask_b32 v125, v247, v125, s[66:67]
    s_nop 0
    v_cndmask_b32 v126, v247, v126, s[68:69]
    s_nop 0
    v_cndmask_b32 v127, v247, v127, s[70:71]
L_exact_nm1:
    v_max3_f32 v232, v96, v97, v98
    v_max3_f32 v232, v232, v99, v104
    v_max3_f32 v232, v232, v105, v106
    v_max3_f32 v232, v232, v107, v112
    v_max3_f32 v232, v232, v113, v114
    v_max3_f32 v232, v232, v115, v120
    v_max3_f32 v232, v232, v121, v122
    v_max_f32 v232, v232, v123
    v_max3_f32 v233, v100, v101, v102
    v_max3_f32 v233, v233, v103, v108
    v_max3_f32 v233, v233, v109, v110
    v_max3_f32 v233, v233, v111, v116
    v_max3_f32 v233, v233, v117, v118
    v_max3_f32 v233, v233, v119, v124
    v_max3_f32 v233, v233, v125, v126
    v_max_f32 v233, v233, v127
    v_mov_b32 v236, v232
    v_mov_b32 v237, v233
    s_nop 1
    v_permlane16_swap_b32 v232, v236
    v_permlane16_swap_b32 v233, v237
    v_max_f32 v232, v232, v236
    v_max_f32 v233, v233, v237
    v_mov_b32 v236, v232
    v_mov_b32 v237, v233
    s_nop 1
    v_permlane32_swap_b32 v232, v236
    v_permlane32_swap_b32 v233, v237
    v_max_f32 v232, v232, v236
    v_max_f32 v233, v233, v237
    v_max_f32 v232, s97, v232
    v_max_f32 v234, 0, v232
    v_exp_f32 v234, -v234
    v_max_f32 v233, s97, v233
    v_max_f32 v235, 0, v233
    v_exp_f32 v235, -v235
    v_sub_f32 v236, v96, v232
    v_sub_f32 v237, v97, v232
    v_exp_f32 v236, v236
    v_exp_f32 v237, v237
    s_nop 0
    v_add_f32 v242, v236, v237
    v_cvt_pk_bf16_f32 v176, v236, v237
    v_sub_f32 v236, v98, v232
    v_sub_f32 v237, v99, v232
    v_exp_f32 v236, v236
    v_exp_f32 v237, v237
    s_nop 0
    v_add_f32 v242, v242, v236
    v_add_f32 v242, v242, v237
    v_cvt_pk_bf16_f32 v177, v236, v237
    v_sub_f32 v236, v104, v232
    v_sub_f32 v237, v105, v232
    v_exp_f32 v236, v236
    v_exp_f32 v237, v237
    s_nop 0
    v_add_f32 v242, v242, v236
    v_add_f32 v242, v242, v237
    v_cvt_pk_bf16_f32 v178, v236, v237
    v_sub_f32 v236, v106, v232
    v_sub_f32 v237, v107, v232
    v_exp_f32 v236, v236
    v_exp_f32 v237, v237
    s_nop 0
    v_add_f32 v242, v242, v236
    v_add_f32 v242, v242, v237
    v_cvt_pk_bf16_f32 v179, v236, v237
    v_sub_f32 v236, v112, v232
    v_sub_f32 v237, v113, v232
    v_exp_f32 v236, v236
    v_exp_f32 v237, v237
    s_nop 0
    v_add_f32 v242, v242, v236
    v_add_f32 v242, v242, v237
    v_cvt_pk_bf16_f32 v184, v236, v237
    v_sub_f32 v236, v114, v232
    v_sub_f32 v237, v115, v232
    v_exp_f32 v236, v236
    v_exp_f32 v237, v237
    s_nop 0
    v_add_f32 v242, v242, v236
    v_add_f32 v242, v242, v237
    v_cvt_pk_bf16_f32 v185, v236, v237
    v_sub_f32 v236, v120, v232
    v_sub_f32 v237, v121, v232
    v_exp_f32 v236, v236
    v_exp_f32 v237, v237
    s_nop 0
    v_add_f32 v242, v242, v236
    v_add_f32 v242, v242, v237
    v_cvt_pk_bf16_f32 v186, v236, v237
    v_sub_f32 v236, v122, v232
    v_sub_f32 v237, v123, v232
    v_exp_f32 v236, v236
    v_exp_f32 v237, v237
    s_nop 0
    v_add_f32 v242, v242, v236
    v_add_f32 v242, v242, v237
    v_cvt_pk_bf16_f32 v187, v236, v237
    v_sub_f32 v236, v100, v233
    v_sub_f32 v237, v101, v233
    v_exp_f32 v236, v236
    v_exp_f32 v237, v237
    s_nop 0
    v_add_f32 v243, v236, v237
    v_cvt_pk_bf16_f32 v180, v236, v237
    v_sub_f32 v236, v102, v233
    v_sub_f32 v237, v103, v233
    v_exp_f32 v236, v236
    v_exp_f32 v237, v237
    s_nop 0
    v_add_f32 v243, v243, v236
    v_add_f32 v243, v243, v237
    v_cvt_pk_bf16_f32 v181, v236, v237
    v_sub_f32 v236, v108, v233
    v_sub_f32 v237, v109, v233
    v_exp_f32 v236, v236
    v_exp_f32 v237, v237
    s_nop 0
    v_add_f32 v243, v243, v236
    v_add_f32 v243, v243, v237
    v_cvt_pk_bf16_f32 v182, v236, v237
    v_sub_f32 v236, v110, v233
    v_sub_f32 v237, v111, v233
    v_exp_f32 v236, v236
    v_exp_f32 v237, v237
    s_nop 0
    v_add_f32 v243, v243, v236
    v_add_f32 v243, v243, v237
    v_cvt_pk_bf16_f32 v183, v236, v237
    v_sub_f32 v236, v116, v233
    v_sub_f32 v237, v117, v233
    v_exp_f32 v236, v236
    v_exp_f32 v237, v237
    s_nop 0
    v_add_f32 v243, v243, v236
    v_add_f32 v243, v243, v237
    v_cvt_pk_bf16_f32 v188, v236, v237
    v_sub_f32 v236, v118, v233
    v_sub_f32 v237, v119, v233
    v_exp_f32 v236, v236
    v_exp_f32 v237, v237
    s_nop 0
    v_add_f32 v243, v243, v236
    v_add_f32 v243, v243, v237
    v_cvt_pk_bf16_f32 v189, v236, v237
    v_sub_f32 v236, v124, v233
    v_sub_f32 v237, v125, v233
    v_exp_f32 v236, v236
    v_exp_f32 v237, v237
    s_nop 0
    v_add_f32 v243, v243, v236
    v_add_f32 v243, v243, v237
    v_cvt_pk_bf16_f32 v190, v236, v237
    v_sub_f32 v236, v126, v233
    v_sub_f32 v237, v127, v233
    v_exp_f32 v236, v236
    v_exp_f32 v237, v237
    s_nop 0
    v_add_f32 v243, v243, v236
    v_add_f32 v243, v243, v237
    v_cvt_pk_bf16_f32 v191, v236, v237
    v_fma_f32 v240, v238, v234, v242
    v_fma_f32 v241, v239, v235, v243
    s_cmp_lg_u32 s97, 0
    s_cbranch_scc1 L_exact_no1
    v_mul_f32 v0, v0, v234
    v_mul_f32 v1, v1, v234
    v_mul_f32 v2, v2, v234
    v_mul_f32 v3, v3, v234
    v_mul_f32 v4, v4, v235
    v_mul_f32 v5, v5, v235
    v_mul_f32 v6, v6, v235
    v_mul_f32 v7, v7, v235
    v_mul_f32 v8, v8, v234
    v_mul_f32 v9, v9, v234
    v_mul_f32 v10, v10, v234
    v_mul_f32 v11, v11, v234
    v_mul_f32 v12, v12, v235
    v_mul_f32 v13, v13, v235
    v_mul_f32 v14, v14, v235
    v_mul_f32 v15, v15, v235
    v_mul_f32 v16, v16, v234
    v_mul_f32 v17, v17, v234
    v_mul_f32 v18, v18, v234
    v_mul_f32 v19, v19, v234
    v_mul_f32 v20, v20, v235
    v_mul_f32 v21, v21, v235
    v_mul_f32 v22, v22, v235
    v_mul_f32 v23, v23, v235
    v_mul_f32 v24, v24, v234
    v_mul_f32 v25, v25, v234
    v_mul_f32 v26, v26, v234
    v_mul_f32 v27, v27, v234
    v_mul_f32 v28, v28, v235
    v_mul_f32 v29, v29, v235
    v_mul_f32 v30, v30, v235
    v_mul_f32 v31, v31, v235
    v_mul_f32 v32, v32, v234
    v_mul_f32 v33, v33, v234
    v_mul_f32 v34, v34, v234
    v_mul_f32 v35, v35, v234
    v_mul_f32 v36, v36, v235
    v_mul_f32 v37, v37, v235
    v_mul_f32 v38, v38, v235
    v_mul_f32 v39, v39, v235
    v_mul_f32 v40, v40, v234
    v_mul_f32 v41, v41, v234
    v_mul_f32 v42, v42, v234
    v_mul_f32 v43, v43, v234
    v_mul_f32 v44, v44, v235
    v_mul_f32 v45, v45, v235
    v_mul_f32 v46, v46, v235
    v_mul_f32 v47, v47, v235
    v_mul_f32 v48, v48, v234
    v_mul_f32 v49, v49, v234
    v_mul_f32 v50, v50, v234
    v_mul_f32 v51, v51, v234
    v_mul_f32 v52, v52, v235
    v_mul_f32 v53, v53, v235
    v_mul_f32 v54, v54, v235
    v_mul_f32 v55, v55, v235
    v_mul_f32 v56, v56, v234
    v_mul_f32 v57, v57, v234
    v_mul_f32 v58, v58, v234
    v_mul_f32 v59, v59, v234
    v_mul_f32 v60, v60, v235
    v_mul_f32 v61, v61, v235
    v_mul_f32 v62, v62, v235
    v_mul_f32 v63, v63, v235
L_exact_no1:
    s_cmp_lg_u32 s98, 0
    s_cbranch_scc1 L_exact_ns1
    v_sub_f32 v64, v64, v232
    v_sub_f32 v65, v65, v232
    v_sub_f32 v66, v66, v232
    v_sub_f32 v67, v67, v232
    v_sub_f32 v68, v68, v233
    v_sub_f32 v69, v69, v233
    v_sub_f32 v70, v70, v233
    v_sub_f32 v71, v71, v233
    v_sub_f32 v72, v72, v232
    v_sub_f32 v73, v73, v232
    v_sub_f32 v74, v74, v232
    v_sub_f32 v75, v75, v232
    v_sub_f32 v76, v76, v233
    v_sub_f32 v77, v77, v233
    v_sub_f32 v78, v78, v233
    v_sub_f32 v79, v79, v233
    v_sub_f32 v80, v80, v232
    v_sub_f32 v81, v81, v232
    v_sub_f32 v82, v82, v232
    v_sub_f32 v83, v83, v232
    v_sub_f32 v84, v84, v233
    v_sub_f32 v85, v85, v233
    v_sub_f32 v86, v86, v233
    v_sub_f32 v87, v87, v233
    v_sub_f32 v88, v88, v232
    v_sub_f32 v89, v89, v232
    v_sub_f32 v90, v90, v232
    v_sub_f32 v91, v91, v232
    v_sub_f32 v92, v92, v233
    v_sub_f32 v93, v93, v233
    v_sub_f32 v94, v94, v233
    v_sub_f32 v95, v95, v233
    v_sub_f32 v224, v224, v232
    v_sub_f32 v225, v225, v232
    v_sub_f32 v226, v226, v232
    v_sub_f32 v227, v227, v232
    v_sub_f32 v228, v228, v233
    v_sub_f32 v229, v229, v233
    v_sub_f32 v230, v230, v233
    v_sub_f32 v231, v231, v233
L_exact_ns1:
    s_mov_b32 s97, 0
    s_nop 1
    s_setpc_b64 s[94:95]
L_att_epi:
    s_setprio 0
    v_mov_b32 v232, v240
    v_mov_b32 v233, v241
    s_nop 1
    v_permlane16_swap_b32 v240, v232
    v_permlane16_swap_b32 v241, v233
    v_add_f32 v240, v240, v232
    v_add_f32 v241, v241, v233
    v_mov_b32 v232, v240
    v_mov_b32 v233, v241
    s_nop 1
    v_permlane32_swap_b32 v240, v232
    v_permlane32_swap_b32 v241, v233
    v_add_f32 v240, v240, v232
    v_add_f32 v241, v241, v233
    v_rcp_f32 v240, v240
    v_rcp_f32 v241, v241
    s_mul_i32 s100, s99, 175104
    s_lshl_b32 s93, s4, 12
    s_add_u32 s100, s100, s93
    s_add_u32 s100, s100, 37748736
    s_add_u32 s101, s100, 175104
    v_pk_mul_f32 v[0:1], v[0:1], v[240:241] op_sel_hi:[1,0]
    v_pk_mul_f32 v[2:3], v[2:3], v[240:241] op_sel_hi:[1,0]
    v_pk_mul_f32 v[8:9], v[8:9], v[240:241] op_sel_hi:[1,0]
    v_pk_mul_f32 v[10:11], v[10:11], v[240:241] op_sel_hi:[1,0]
    v_cvt_pk_bf16_f32 v192, v0, v1
    v_cvt_pk_bf16_f32 v193, v2, v3
    v_cvt_pk_bf16_f32 v194, v8, v9
    v_cvt_pk_bf16_f32 v195, v10, v11
    buffer_store_dwordx4 v[192:195], v254, s[52:55], s100 offen offset:0 sc1
    v_pk_mul_f32 v[16:17], v[16:17], v[240:241] op_sel_hi:[1,0]
    v_pk_mul_f32 v[18:19], v[18:19], v[240:241] op_sel_hi:[1,0]
    v_pk_mul_f32 v[24:25], v[24:25], v[240:241] op_sel_hi:[1,0]
    v_pk_mul_f32 v[26:27], v[26:27], v[240:241] op_sel_hi:[1,0]
    v_cvt_pk_bf16_f32 v196, v16, v17
    v_cvt_pk_bf16_f32 v197, v18, v19
    v_cvt_pk_bf16_f32 v198, v24, v25
    v_cvt_pk_bf16_f32 v199, v26, v27
    buffer_store_dwordx4 v[196:199], v254, s[52:55], s100 offen offset:1024 sc1
    v_pk_mul_f32 v[32:33], v[32:33], v[240:241] op_sel_hi:[1,0]
    v_pk_mul_f32 v[34:35], v[34:35], v[240:241] op_sel_hi:[1,0]
    v_pk_mul_f32 v[40:41], v[40:41], v[240:241] op_sel_hi:[1,0]
    v_pk_mul_f32 v[42:43], v[42:43], v[240:241] op_sel_hi:[1,0]
    v_cvt_pk_bf16_f32 v200, v32, v33
    v_cvt_pk_bf16_f32 v201, v34, v35
    v_cvt_pk_bf16_f32 v202, v40, v41
    v_cvt_pk_bf16_f32 v203, v42, v43
    buffer_store_dwordx4 v[200:203], v254, s[52:55], s100 offen offset:2048 sc1
    v_pk_mul_f32 v[48:49], v[48:49], v[240:241] op_sel_hi:[1,0]
    v_pk_mul_f32 v[50:51], v[50:51], v[240:241] op_sel_hi:[1,0]
    v_pk_mul_f32 v[56:57], v[56:57], v[240:241] op_sel_hi:[1,0]
    v_pk_mul_f32 v[58:59], v[58:59], v[240:241] op_sel_hi:[1,0]
    v_cvt_pk_bf16_f32 v204, v48, v49
    v_cvt_pk_bf16_f32 v205, v50, v51
    v_cvt_pk_bf16_f32 v206, v56, v57
    v_cvt_pk_bf16_f32 v207, v58, v59
    buffer_store_dwordx4 v[204:207], v254, s[52:55], s100 offen offset:3072 sc1
    v_pk_mul_f32 v[4:5], v[4:5], v[240:241] op_sel:[0,1] op_sel_hi:[1,1]
    v_pk_mul_f32 v[6:7], v[6:7], v[240:241] op_sel:[0,1] op_sel_hi:[1,1]
    v_pk_mul_f32 v[12:13], v[12:13], v[240:241] op_sel:[0,1] op_sel_hi:[1,1]
    v_pk_mul_f32 v[14:15], v[14:15], v[240:241] op_sel:[0,1] op_sel_hi:[1,1]
    v_cvt_pk_bf16_f32 v192, v4, v5
    v_cvt_pk_bf16_f32 v193, v6, v7
    v_cvt_pk_bf16_f32 v194, v12, v13
    v_cvt_pk_bf16_f32 v195, v14, v15
    buffer_store_dwordx4 v[192:195], v254, s[52:55], s101 offen offset:0 sc1
    v_pk_mul_f32 v[20:21], v[20:21], v[240:241] op_sel:[0,1] op_sel_hi:[1,1]
    v_pk_mul_f32 v[22:23], v[22:23], v[240:241] op_sel:[0,1] op_sel_hi:[1,1]
    v_pk_mul_f32 v[28:29], v[28:29], v[240:241] op_sel:[0,1] op_sel_hi:[1,1]
    v_pk_mul_f32 v[30:31], v[30:31], v[240:241] op_sel:[0,1] op_sel_hi:[1,1]
    v_cvt_pk_bf16_f32 v196, v20, v21
    v_cvt_pk_bf16_f32 v197, v22, v23
    v_cvt_pk_bf16_f32 v198, v28, v29
    v_cvt_pk_bf16_f32 v199, v30, v31
    buffer_store_dwordx4 v[196:199], v254, s[52:55], s101 offen offset:1024 sc1
    v_pk_mul_f32 v[36:37], v[36:37], v[240:241] op_sel:[0,1] op_sel_hi:[1,1]
    v_pk_mul_f32 v[38:39], v[38:39], v[240:241] op_sel:[0,1] op_sel_hi:[1,1]
    v_pk_mul_f32 v[44:45], v[44:45], v[240:241] op_sel:[0,1] op_sel_hi:[1,1]
    v_pk_mul_f32 v[46:47], v[46:47], v[240:241] op_sel:[0,1] op_sel_hi:[1,1]
    v_cvt_pk_bf16_f32 v200, v36, v37
    v_cvt_pk_bf16_f32 v201, v38, v39
    v_cvt_pk_bf16_f32 v202, v44, v45
    v_cvt_pk_bf16_f32 v203, v46, v47
    buffer_store_dwordx4 v[200:203], v254, s[52:55], s101 offen offset:2048 sc1
    v_pk_mul_f32 v[52:53], v[52:53], v[240:241] op_sel:[0,1] op_sel_hi:[1,1]
    v_pk_mul_f32 v[54:55], v[54:55], v[240:241] op_sel:[0,1] op_sel_hi:[1,1]
    v_pk_mul_f32 v[60:61], v[60:61], v[240:241] op_sel:[0,1] op_sel_hi:[1,1]
    v_pk_mul_f32 v[62:63], v[62:63], v[240:241] op_sel:[0,1] op_sel_hi:[1,1]
    v_cvt_pk_bf16_f32 v204, v52, v53
    v_cvt_pk_bf16_f32 v205, v54, v55
    v_cvt_pk_bf16_f32 v206, v60, v61
    v_cvt_pk_bf16_f32 v207, v62, v63
    buffer_store_dwordx4 v[204:207], v254, s[52:55], s101 offen offset:3072 sc1
    s_add_u32 s61, s61, 1
L_att_idle:
    s_cmp_ge_u32 s61, s60
    s_cbranch_scc1 L_att_done
    s_cmp_eq_u32 s56, 0
    s_cbranch_scc1 L_sa80
    s_waitcnt vmcnt(0)
    s_barrier
    s_add_u32 s93, s61, 2
    s_cmp_ge_i32 s93, s60
    s_cbranch_scc1 L_sb80
    s_add_u32 s93, s61, 4
    s_and_b32 s100, s93, 3
    s_lshl_b32 s100, s100, 14
    s_add_u32 m0, s100, s92
    s_lshl_b32 s101, s93, 14
    s_add_u32 s101, s101, s62
    s_cmp_lt_i32 s93, s60
    s_cselect_b32 s101, s101, 1073741824
    buffer_load_dwordx4 v254, s[52:55], s101 offen offset:0 sc1 lds
    buffer_load_dwordx4 v254, s[52:55], s101 offen offset:1024 sc1 lds
    buffer_load_dwordx4 v254, s[52:55], s101 offen offset:2048 sc1 lds
    buffer_load_dwordx4 v254, s[52:55], s101 offen offset:3072 sc1 lds
    s_add_u32 s93, s61, 5
    s_and_b32 s100, s93, 3
    s_lshl_b32 s100, s100, 14
    s_add_u32 m0, s100, s92
    s_lshl_b32 s101, s93, 14
    s_add_u32 s101, s101, s62
    s_cmp_lt_i32 s93, s60
    s_cselect_b32 s101, s101, 1073741824
    buffer_load_dwordx4 v254, s[52:55], s101 offen offset:0 sc1 lds
    buffer_load_dwordx4 v254, s[52:55], s101 offen offset:1024 sc1 lds
    buffer_load_dwordx4 v254, s[52:55], s101 offen offset:2048 sc1 lds
    buffer_load_dwordx4 v254, s[52:55], s101 offen offset:3072 sc1 lds
    s_add_u32 s89, s89, 16384
    s_cmp_eq_u32 s89, 147456
    s_cselect_b32 s89, 65536, s89
    s_add_u32 s93, s61, 2
    s_add_u32 m0, s92, s89
    s_lshl_b32 s101, s93, 14
    s_add_u32 s101, s101, s63
    s_cmp_lt_i32 s93, s60
    s_cselect_b32 s101, s101, 1073741824
    buffer_load_dwordx4 v254, s[52:55], s101 offen offset:0 sc1 lds
    buffer_load_dwordx4 v254, s[52:55], s101 offen offset:1024 sc1 lds
    buffer_load_dwordx4 v254, s[52:55], s101 offen offset:2048 sc1 lds
    buffer_load_dwordx4 v254, s[52:55], s101 offen offset:3072 sc1 lds
    s_add_u32 s89, s89, 16384
    s_cmp_eq_u32 s89, 147456
    s_cselect_b32 s89, 65536, s89
    s_add_u32 s93, s61, 3
    s_add_u32 m0, s92, s89
    s_lshl_b32 s101, s93, 14
    s_add_u32 s101, s101, s63
    s_cmp_lt_i32 s93, s60
    s_cselect_b32 s101, s101, 1073741824
    buffer_load_dwordx4 v254, s[52:55], s101 offen offset:0 sc1 lds
    buffer_load_dwordx4 v254, s[52:55], s101 offen offset:1024 sc1 lds
    buffer_load_dwordx4 v254, s[52:55], s101 offen offset:2048 sc1 lds
    buffer_load_dwordx4 v254, s[52:55], s101 offen offset:3072 sc1 lds
    s_branch L_sb80
    L_sa80:
    s_barrier
    L_sb80:
    s_cmp_lg_u32 s79, 0
    s_cbranch_scc1 L_ip9
    s_cmp_lt_u32 s61, 9
    s_cbranch_scc1 L_ip9
    s_mov_b32 s79, 1
    s_cmp_lg_u32 s3, 4
    s_cbranch_scc1 L_pub75
    v_mov_b32 v0, 3
    s_lshl_b32 s93, s6, 7
    s_add_u32 s93, s93, 3145728
    v_mov_b32 v1, s93
    s_mov_b64 s[72:73], exec
    s_mov_b64 exec, 1
    buffer_store_dword v0, v1, s[52:55], 0 offen sc1
    s_mov_b64 exec, s[72:73]
    L_pub75:
    L_ip9:
    s_add_u32 s61, s61, 2
    s_branch L_att_idle
L_att_done:
    s_and_b32 s56, s2, 3
    s_bfe_u32 s57, s2, 0x10002
    s_lshl_b32 s57, s57, 3
    s_bfe_u32 s93, s2, 0x30003
    s_add_u32 s57, s57, s93
    s_lshr_b32 s58, s2, 6
    s_sub_u32 s100, 15, s57
    s_min_u32 s100, s100, s57
    v_and_b32 v236, 31, v255
    v_lshl_add_u32 v250, v236, 3, s100
    s_and_b32 s101, s2, 4
    s_lshl_b32 s101, s101, 5
    s_bfe_u32 s93, s2, 0x20003
    s_lshl_b32 s93, s93, 3
    s_add_u32 s101, s101, s93
    s_lshr_b32 s93, s2, 5
    s_add_u32 s101, s101, s93
    v_and_b32 v236, 3, v255
    v_lshl_add_u32 v236, v236, 5, s101
    v_cmp_gt_u32 vcc, 32, v255
    s_nop 1
    v_cndmask_b32 v250, v236, v250, vcc
    v_lshlrev_b32 v250, 7, v250
    v_add_u32 v250, 3145728, v250
    v_lshrrev_b32 v236, 4, v255
    v_bfe_u32 v237, v255, 1, 3
    v_xor_b32 v237, v237, v236
    v_lshlrev_b32 v237, 5, v237
    v_and_b32 v238, 1, v255
    v_lshl_add_u32 v237, v238, 4, v237
    v_mul_u32_u24 v236, 1024, v236
    v_add_u32 v232, v236, v237
    v_xor_b32 v237, 128, v237
    v_add_u32 v233, v236, v237
    s_and_b32 s93, s3, 1
    s_lshl_b32 s93, s93, 13
    v_add_u32 v224, s93, v254
    v_lshrrev_b32 v236, 2, v255
    v_lshlrev_b32 v237, 8, v236
    v_and_b32 v238, 3, v255
    v_lshl_add_u32 v237, v238, 3, v237
    v_add_u32 v237, 16384, v237
    v_and_b32 v236, 7, v236
    s_and_b32 s93, s3, 6
    v_xor_b32 v238, s93, v236
    v_lshl_add_u32 v225, v238, 5, v237
    v_xor_b32 v226, 32, v225
    s_lshl_b32 s97, s57, 3
    s_add_u32 s97, s97, s3
    s_mul_i32 s97, s97, 175104
    s_add_u32 s97, s97, 37748736
    s_lshl_b32 s98, s3, 13
    s_lshl_b32 s93, s58, 8
    s_add_u32 s98, s98, s93
    s_lshl_b32 s62, s3, 11
    s_mul_i32 s99, s56, 11
    s_cmp_lt_u32 s3, 4
    s_cbranch_scc1 L_c_g0
    buffer_load_dword v249, v250, s[52:55], 0 offen sc1
    s_waitcnt vmcnt(0)
    s_mov_b32 s90, 0
    L_pl81:
    v_cmp_gt_u32 vcc, 3, v249
    s_cbranch_vccz L_pd81
    s_add_u32 s90, s90, 1
    s_cmp_gt_u32 s90, 0x40000
    s_cbranch_scc1 L_pd81
    s_sleep 4
    buffer_load_dword v249, v250, s[52:55], 0 offen sc1
    s_waitcnt vmcnt(0)
    s_branch L_pl81
    L_pd81:
    s_add_u32 s63, s99, 0
    s_lshl_b32 s59, s63, 10
    s_add_u32 s59, s59, s97
    s_add_u32 s59, s59, 131072
    s_lshl_b32 s60, s63, 15
    s_add_u32 s60, s60, s98
    s_add_u32 m0, s62, 16384
    s_add_u32 s93, s60, 3072
    buffer_load_dwordx4 v232, s[32:35], s60 offen lds
    buffer_load_dwordx4 v233, s[32:35], s93 offen offset:1024 lds
    s_add_u32 m0, s62, 0
    s_nop 0
    buffer_load_dwordx4 v254, s[52:55], s59 offen sc1 lds
    buffer_load_dwordx4 v254, s[52:55], s59 offen offset:1024 sc1 lds
    s_add_u32 s63, s99, 2
    s_lshl_b32 s59, s63, 10
    s_add_u32 s59, s59, s97
    s_add_u32 s59, s59, 131072
    s_lshl_b32 s60, s63, 15
    s_add_u32 s60, s60, s98
    s_add_u32 m0, s62, 49152
    s_add_u32 s93, s60, 3072
    buffer_load_dwordx4 v232, s[32:35], s60 offen lds
    buffer_load_dwordx4 v233, s[32:35], s93 offen offset:1024 lds
    s_add_u32 m0, s62, 32768
    s_nop 0
    buffer_load_dwordx4 v254, s[52:55], s59 offen sc1 lds
    buffer_load_dwordx4 v254, s[52:55], s59 offen offset:1024 sc1 lds
    s_sub_u32 s97, s97, 700416
    s_sub_u32 s98, s98, 32768
    s_sub_u32 s62, s62, 8192
    s_add_u32 s63, s99, 0
    s_lshl_b32 s59, s63, 10
    s_add_u32 s59, s59, s97
    s_add_u32 s59, s59, 131072
    s_lshl_b32 s60, s63, 15
    s_add_u32 s60, s60, s98
    s_add_u32 m0, s62, 16384
    s_add_u32 s93, s60, 3072
    buffer_load_dwordx4 v232, s[32:35], s60 offen lds
    buffer_load_dwordx4 v233, s[32:35], s93 offen offset:1024 lds
    s_add_u32 m0, s62, 0
    s_nop 0
    buffer_load_dwordx4 v254, s[52:55], s59 offen sc1 lds
    buffer_load_dwordx4 v254, s[52:55], s59 offen offset:1024 sc1 lds
    s_add_u32 s63, s99, 2
    s_lshl_b32 s59, s63, 10
    s_add_u32 s59, s59, s97
    s_add_u32 s59, s59, 131072
    s_lshl_b32 s60, s63, 15
    s_add_u32 s60, s60, s98
    s_add_u32 m0, s62, 49152
    s_add_u32 s93, s60, 3072
    buffer_load_dwordx4 v232, s[32:35], s60 offen lds
    buffer_load_dwordx4 v233, s[32:35], s93 offen offset:1024 lds
    s_add_u32 m0, s62, 32768
    s_nop 0
    buffer_load_dwordx4 v254, s[52:55], s59 offen sc1 lds
    buffer_load_dwordx4 v254, s[52:55], s59 offen offset:1024 sc1 lds
    s_add_u32 s97, s97, 700416
    s_add_u32 s98, s98, 32768
    s_add_u32 s62, s62, 8192
L_c_g0:
    s_waitcnt vmcnt(0)
    s_barrier
    s_cmp_lg_u32 s3, 0
    s_cbranch_scc1 L_pub82
    v_mov_b32 v248, 4
    s_lshl_b32 s93, s6, 7
    s_add_u32 s93, s93, 3145728
    v_mov_b32 v251, s93
    s_mov_b64 s[72:73], exec
    s_mov_b64 exec, 1
    buffer_store_dword v248, v251, s[52:55], 0 offen sc1
    s_mov_b64 exec, s[72:73]
    L_pub82:
    s_add_u32 s63, s99, 4
    s_lshl_b32 s59, s63, 10
    s_add_u32 s59, s59, s97
    s_add_u32 s59, s59, 131072
    s_lshl_b32 s60, s63, 15
    s_add_u32 s60, s60, s98
    s_add_u32 m0, s62, 81920
    s_add_u32 s93, s60, 3072
    buffer_load_dwordx4 v232, s[32:35], s60 offen lds
    buffer_load_dwordx4 v233, s[32:35], s93 offen offset:1024 lds
    s_add_u32 m0, s62, 65536
    s_nop 0
    buffer_load_dwordx4 v254, s[52:55], s59 offen sc1 lds
    buffer_load_dwordx4 v254, s[52:55], s59 offen offset:1024 sc1 lds
    s_add_u32 s63, s99, 6
    s_lshl_b32 s59, s63, 10
    s_add_u32 s59, s59, s97
    s_add_u32 s59, s59, 131072
    s_lshl_b32 s60, s63, 15
    s_add_u32 s60, s60, s98
    s_add_u32 m0, s62, 114688
    s_add_u32 s93, s60, 3072
    buffer_load_dwordx4 v232, s[32:35], s60 offen lds
    buffer_load_dwordx4 v233, s[32:35], s93 offen offset:1024 lds
    s_add_u32 m0, s62, 98304
    s_nop 0
    buffer_load_dwordx4 v254, s[52:55], s59 offen sc1 lds
    buffer_load_dwordx4 v254, s[52:55], s59 offen offset:1024 sc1 lds
    s_lshl_b32 s93, s56, 6
    s_add_u32 s93, s93, s100
    v_and_b32 v250, 7, v255
    v_lshl_add_u32 v250, v250, 3, s93
    v_lshlrev_b32 v250, 7, v250
    v_add_u32 v250, 3145728, v250
    v_add_u32 v228, 0, v224
    v_add_u32 v229, 0, v225
    v_add_u32 v230, 0, v226
    ds_read_b64_tr_b16 v[64:65], v229 offset:0
    ds_read_b64_tr_b16 v[66:67], v229 offset:4096
    ds_read_b128 v[32:35], v228 offset:0
    ds_read_b64_tr_b16 v[68:69], v230 offset:0
    ds_read_b64_tr_b16 v[70:71], v230 offset:4096
    ds_read_b128 v[36:39], v228 offset:2048
    ds_read_b128 v[40:43], v228 offset:4096
    ds_read_b128 v[44:47], v228 offset:6144
    ds_read_b64_tr_b16 v[72:73], v229 offset:8192
    ds_read_b64_tr_b16 v[74:75], v229 offset:12288
    ds_read_b128 v[48:51], v228 offset:1024
    ds_read_b64_tr_b16 v[76:77], v230 offset:8192
    ds_read_b64_tr_b16 v[78:79], v230 offset:12288
    ds_read_b128 v[52:55], v228 offset:3072
    s_waitcnt lgkmcnt(8)
    v_mfma_f32_16x16x32_bf16 v[0:3], v[64:67], v[32:35], 0
    v_mfma_f32_16x16x32_bf16 v[4:7], v[68:71], v[32:35], 0
    ds_read_b128 v[56:59], v228 offset:5120
    s_waitcnt vmcnt(8)
    s_barrier
    v_mfma_f32_16x16x32_bf16 v[8:11], v[64:67], v[36:39], 0
    s_add_u32 s63, s99, 8
    s_lshl_b32 s59, s63, 10
    s_add_u32 s59, s59, s97
    s_add_u32 s59, s59, 131072
    s_lshl_b32 s60, s63, 15
    s_add_u32 s60, s60, s98
    s_add_u32 m0, s62, 147456
    s_add_u32 s93, s60, 3072
    buffer_load_dwordx4 v232, s[32:35], s60 offen lds
    v_mfma_f32_16x16x32_bf16 v[12:15], v[68:71], v[36:39], 0
    ds_read_b128 v[60:63], v228 offset:7168
    s_waitcnt lgkmcnt(8)
    v_mfma_f32_16x16x32_bf16 v[16:19], v[64:67], v[40:43], 0
    v_mfma_f32_16x16x32_bf16 v[20:23], v[68:71], v[40:43], 0
    v_add_u32 v228, 32768, v224
    v_add_u32 v229, 32768, v225
    v_add_u32 v230, 32768, v226
    v_mfma_f32_16x16x32_bf16 v[24:27], v[64:67], v[44:47], 0
    ds_read_b64_tr_b16 v[64:65], v229 offset:0
    ds_read_b64_tr_b16 v[66:67], v229 offset:4096
    buffer_load_dwordx4 v233, s[32:35], s93 offen offset:1024 lds
    v_mfma_f32_16x16x32_bf16 v[28:31], v[68:71], v[44:47], 0
    ds_read_b128 v[32:35], v228 offset:0
    ds_read_b64_tr_b16 v[68:69], v230 offset:0
    s_waitcnt lgkmcnt(6)
    v_mfma_f32_16x16x32_bf16 v[0:3], v[72:75], v[48:51], v[0:3]
    ds_read_b64_tr_b16 v[70:71], v230 offset:4096
    ds_read_b128 v[36:39], v228 offset:2048
    v_mfma_f32_16x16x32_bf16 v[4:7], v[76:79], v[48:51], v[4:7]
    ds_read_b128 v[40:43], v228 offset:4096
    v_mfma_f32_16x16x32_bf16 v[8:11], v[72:75], v[52:55], v[8:11]
    s_add_u32 m0, s62, 131072
    s_nop 0
    buffer_load_dwordx4 v254, s[52:55], s59 offen sc1 lds
    v_mfma_f32_16x16x32_bf16 v[12:15], v[76:79], v[52:55], v[12:15]
    ds_read_b128 v[44:47], v228 offset:6144
    s_waitcnt lgkmcnt(8)
    v_mfma_f32_16x16x32_bf16 v[16:19], v[72:75], v[56:59], v[16:19]
    v_mfma_f32_16x16x32_bf16 v[20:23], v[76:79], v[56:59], v[20:23]
    v_mfma_f32_16x16x32_bf16 v[24:27], v[72:75], v[60:63], v[24:27]
    ds_read_b64_tr_b16 v[72:73], v229 offset:8192
    ds_read_b64_tr_b16 v[74:75], v229 offset:12288
    buffer_load_dwordx4 v254, s[52:55], s59 offen offset:1024 sc1 lds
    v_mfma_f32_16x16x32_bf16 v[28:31], v[76:79], v[60:63], v[28:31]
    ds_read_b128 v[48:51], v228 offset:1024
    ds_read_b64_tr_b16 v[76:77], v230 offset:8192
    s_waitcnt lgkmcnt(6)
    v_mfma_f32_16x16x32_bf16 v[0:3], v[64:67], v[32:35], v[0:3]
    ds_read_b64_tr_b16 v[78:79], v230 offset:12288
    ds_read_b128 v[52:55], v228 offset:3072
    v_mfma_f32_16x16x32_bf16 v[4:7], v[68:71], v[32:35], v[4:7]
    ds_read_b128 v[56:59], v228 offset:5120
    s_waitcnt vmcnt(8)
    s_barrier
    v_mfma_f32_16x16x32_bf16 v[8:11], v[64:67], v[36:39], v[8:11]
    s_add_u32 s63, s99, 10
    s_lshl_b32 s59, s63, 10
    s_add_u32 s59, s59, s97
    s_add_u32 s59, s59, 131072
    s_lshl_b32 s60, s63, 15
    s_add_u32 s60, s60, s98
    s_add_u32 m0, s62, 16384
    s_add_u32 s93, s60, 3072
    buffer_load_dwordx4 v232, s[32:35], s60 offen lds
    v_mfma_f32_16x16x32_bf16 v[12:15], v[68:71], v[36:39], v[12:15]
    ds_read_b128 v[60:63], v228 offset:7168
    s_waitcnt lgkmcnt(8)
    v_mfma_f32_16x16x32_bf16 v[16:19], v[64:67], v[40:43], v[16:19]
    v_mfma_f32_16x16x32_bf16 v[20:23], v[68:71], v[40:43], v[20:23]
    v_add_u32 v228, 65536, v224
    v_add_u32 v229, 65536, v225
    v_add_u32 v230, 65536, v226
    v_mfma_f32_16x16x32_bf16 v[24:27], v[64:67], v[44:47], v[24:27]
    ds_read_b64_tr_b16 v[64:65], v229 offset:0
    ds_read_b64_tr_b16 v[66:67], v229 offset:4096
    buffer_load_dwordx4 v233, s[32:35], s93 offen offset:1024 lds
    v_mfma_f32_16x16x32_bf16 v[28:31], v[68:71], v[44:47], v[28:31]
    ds_read_b128 v[32:35], v228 offset:0
    ds_read_b64_tr_b16 v[68:69], v230 offset:0
    s_waitcnt lgkmcnt(6)
    v_mfma_f32_16x16x32_bf16 v[0:3], v[72:75], v[48:51], v[0:3]
    ds_read_b64_tr_b16 v[70:71], v230 offset:4096
    ds_read_b128 v[36:39], v228 offset:2048
    v_mfma_f32_16x16x32_bf16 v[4:7], v[76:79], v[48:51], v[4:7]
    ds_read_b128 v[40:43], v228 offset:4096
    v_mfma_f32_16x16x32_bf16 v[8:11], v[72:75], v[52:55], v[8:11]
    s_cmp_lt_u32 s56, 3
    s_cselect_b32 s59, s59, 1073741824
    s_add_u32 m0, s62, 0
    s_mov_b32 s93, 1073741824
    buffer_load_dwordx4 v254, s[52:55], s59 offen sc1 lds
    v_mfma_f32_16x16x32_bf16 v[12:15], v[76:79], v[52:55], v[12:15]
    ds_read_b128 v[44:47], v228 offset:6144
    s_waitcnt lgkmcnt(8)
    v_mfma_f32_16x16x32_bf16 v[16:19], v[72:75], v[56:59], v[16:19]
    v_mfma_f32_16x16x32_bf16 v[20:23], v[76:79], v[56:59], v[20:23]
    v_mfma_f32_16x16x32_bf16 v[24:27], v[72:75], v[60:63], v[24:27]
    ds_read_b64_tr_b16 v[72:73], v229 offset:8192
    ds_read_b64_tr_b16 v[74:75], v229 offset:12288
    buffer_load_dwordx4 v254, s[52:55], s93 offen offset:1024 sc1 lds
    v_mfma_f32_16x16x32_bf16 v[28:31], v[76:79], v[60:63], v[28:31]
    ds_read_b128 v[48:51], v228 offset:1024
    ds_read_b64_tr_b16 v[76:77], v230 offset:8192
    s_waitcnt lgkmcnt(6)
    v_mfma_f32_16x16x32_bf16 v[0:3], v[64:67], v[32:35], v[0:3]
    ds_read_b64_tr_b16 v[78:79], v230 offset:12288
    ds_read_b128 v[52:55], v228 offset:3072
    v_mfma_f32_16x16x32_bf16 v[4:7], v[68:71], v[32:35], v[4:7]
    ds_read_b128 v[56:59], v228 offset:5120
    s_cmp_lg_u32 s3, 0
    s_cbranch_scc1 L_po83
    buffer_load_dword v249, v250, s[52:55], 0 offen sc1
    s_waitcnt vmcnt(0)
    s_mov_b32 s90, 0
    L_pl84:
    v_cmp_gt_u32 vcc, 4, v249
    s_cbranch_vccz L_pd84
    s_add_u32 s90, s90, 1
    s_cmp_gt_u32 s90, 0x40000
    s_cbranch_scc1 L_pd84
    s_sleep 4
    buffer_load_dword v249, v250, s[52:55], 0 offen sc1
    s_waitcnt vmcnt(0)
    s_branch L_pl84
    L_pd84:
    L_po83:
    s_waitcnt vmcnt(8)
    s_barrier
    v_mfma_f32_16x16x32_bf16 v[8:11], v[64:67], v[36:39], v[8:11]
    s_lshl_b32 s63, s58, 3
    s_add_u32 s63, s63, 0
    s_and_b32 s63, s63, 31
    s_lshl_b32 s59, s56, 5
    s_add_u32 s63, s63, s59
    s_lshl_b32 s59, s63, 10
    s_add_u32 s59, s59, s97
    s_lshl_b32 s60, s63, 15
    s_add_u32 s60, s60, s98
    s_add_u32 m0, s62, 49152
    s_add_u32 s93, s60, 3072
    buffer_load_dwordx4 v232, s[24:27], s60 offen lds
    v_mfma_f32_16x16x32_bf16 v[12:15], v[68:71], v[36:39], v[12:15]
    ds_read_b128 v[60:63], v228 offset:7168
    s_waitcnt lgkmcnt(8)
    v_mfma_f32_16x16x32_bf16 v[16:19], v[64:67], v[40:43], v[16:19]
    v_mfma_f32_16x16x32_bf16 v[20:23], v[68:71], v[40:43], v[20:23]
    v_add_u32 v228, 98304, v224
    v_add_u32 v229, 98304, v225
    v_add_u32 v230, 98304, v226
    v_mfma_f32_16x16x32_bf16 v[24:27], v[64:67], v[44:47], v[24:27]
    ds_read_b64_tr_b16 v[64:65], v229 offset:0
    ds_read_b64_tr_b16 v[66:67], v229 offset:4096
    buffer_load_dwordx4 v233, s[24:27], s93 offen offset:1024 lds
    v_mfma_f32_16x16x32_bf16 v[28:31], v[68:71], v[44:47], v[28:31]
    ds_read_b128 v[32:35], v228 offset:0
    ds_read_b64_tr_b16 v[68:69], v230 offset:0
    s_waitcnt lgkmcnt(6)
    v_mfma_f32_16x16x32_bf16 v[0:3], v[72:75], v[48:51], v[0:3]
    ds_read_b64_tr_b16 v[70:71], v230 offset:4096
    ds_read_b128 v[36:39], v228 offset:2048
    v_mfma_f32_16x16x32_bf16 v[4:7], v[76:79], v[48:51], v[4:7]
    ds_read_b128 v[40:43], v228 offset:4096
    v_mfma_f32_16x16x32_bf16 v[8:11], v[72:75], v[52:55], v[8:11]
    s_add_u32 m0, s62, 32768
    s_nop 0
    buffer_load_dwordx4 v254, s[52:55], s59 offen sc1 lds
    v_mfma_f32_16x16x32_bf16 v[12:15], v[76:79], v[52:55], v[12:15]
    ds_read_b128 v[44:47], v228 offset:6144
    s_waitcnt lgkmcnt(8)
    v_mfma_f32_16x16x32_bf16 v[16:19], v[72:75], v[56:59], v[16:19]
    v_mfma_f32_16x16x32_bf16 v[20:23], v[76:79], v[56:59], v[20:23]
    v_mfma_f32_16x16x32_bf16 v[24:27], v[72:75], v[60:63], v[24:27]
    ds_read_b64_tr_b16 v[72:73], v229 offset:8192
    ds_read_b64_tr_b16 v[74:75], v229 offset:12288
    buffer_load_dwordx4 v254, s[52:55], s59 offen offset:1024 sc1 lds
    v_mfma_f32_16x16x32_bf16 v[28:31], v[76:79], v[60:63], v[28:31]
    ds_read_b128 v[48:51], v228 offset:1024
    ds_read_b64_tr_b16 v[76:77], v230 offset:8192
    s_waitcnt lgkmcnt(6)
    v_mfma_f32_16x16x32_bf16 v[0:3], v[64:67], v[32:35], v[0:3]
    ds_read_b64_tr_b16 v[78:79], v230 offset:12288
    ds_read_b128 v[52:55], v228 offset:3072
    v_mfma_f32_16x16x32_bf16 v[4:7], v[68:71], v[32:35], v[4:7]
    ds_read_b128 v[56:59], v228 offset:5120
    s_waitcnt vmcnt(8)
    s_barrier
    v_mfma_f32_16x16x32_bf16 v[8:11], v[64:67], v[36:39], v[8:11]
    s_lshl_b32 s63, s58, 3
    s_add_u32 s63, s63, 2
    s_and_b32 s63, s63, 31
    s_lshl_b32 s59, s56, 5
    s_add_u32 s63, s63, s59
    s_lshl_b32 s59, s63, 10
    s_add_u32 s59, s59, s97
    s_lshl_b32 s60, s63, 15
    s_add_u32 s60, s60, s98
    s_add_u32 m0, s62, 81920
    s_add_u32 s93, s60, 3072
    buffer_load_dwordx4 v232, s[24:27], s60 offen lds
    v_mfma_f32_16x16x32_bf16 v[12:15], v[68:71], v[36:39], v[12:15]
    ds_read_b128 v[60:63], v228 offset:7168
    s_waitcnt lgkmcnt(8)
    v_mfma_f32_16x16x32_bf16 v[16:19], v[64:67], v[40:43], v[16:19]
    v_mfma_f32_16x16x32_bf16 v[20:23], v[68:71], v[40:43], v[20:23]
    v_add_u32 v228, 131072, v224
    v_add_u32 v229, 131072, v225
    v_add_u32 v230, 131072, v226
    v_mfma_f32_16x16x32_bf16 v[24:27], v[64:67], v[44:47], v[24:27]
    ds_read_b64_tr_b16 v[64:65], v229 offset:0
    ds_read_b64_tr_b16 v[66:67], v229 offset:4096
    buffer_load_dwordx4 v233, s[24:27], s93 offen offset:1024 lds
    v_mfma_f32_16x16x32_bf16 v[28:31], v[68:71], v[44:47], v[28:31]
    ds_read_b128 v[32:35], v228 offset:0
    ds_read_b64_tr_b16 v[68:69], v230 offset:0
    s_waitcnt lgkmcnt(6)
    v_mfma_f32_16x16x32_bf16 v[0:3], v[72:75], v[48:51], v[0:3]
    ds_read_b64_tr_b16 v[70:71], v230 offset:4096
    ds_read_b128 v[36:39], v228 offset:2048
    v_mfma_f32_16x16x32_bf16 v[4:7], v[76:79], v[48:51], v[4:7]
    ds_read_b128 v[40:43], v228 offset:4096
    v_mfma_f32_16x16x32_bf16 v[8:11], v[72:75], v[52:55], v[8:11]
    s_add_u32 m0, s62, 65536
    s_nop 0
    buffer_load_dwordx4 v254, s[52:55], s59 offen sc1 lds
    v_mfma_f32_16x16x32_bf16 v[12:15], v[76:79], v[52:55], v[12:15]
    ds_read_b128 v[44:47], v228 offset:6144
    s_waitcnt lgkmcnt(8)
    v_mfma_f32_16x16x32_bf16 v[16:19], v[72:75], v[56:59], v[16:19]
    v_mfma_f32_16x16x32_bf16 v[20:23], v[76:79], v[56:59], v[20:23]
    v_mfma_f32_16x16x32_bf16 v[24:27], v[72:75], v[60:63], v[24:27]
    ds_read_b64_tr_b16 v[72:73], v229 offset:8192
    ds_read_b64_tr_b16 v[74:75], v229 offset:12288
    buffer_load_dwordx4 v254, s[52:55], s59 offen offset:1024 sc1 lds
    v_mfma_f32_16x16x32_bf16 v[28:31], v[76:79], v[60:63], v[28:31]
    ds_read_b128 v[48:51], v228 offset:1024
    ds_read_b64_tr_b16 v[76:77], v230 offset:8192
    s_waitcnt lgkmcnt(6)
    v_mfma_f32_16x16x32_bf16 v[0:3], v[64:67], v[32:35], v[0:3]
    ds_read_b64_tr_b16 v[78:79], v230 offset:12288
    ds_read_b128 v[52:55], v228 offset:3072
    v_mfma_f32_16x16x32_bf16 v[4:7], v[68:71], v[32:35], v[4:7]
    ds_read_b128 v[56:59], v228 offset:5120
    s_waitcnt vmcnt(8)
    s_barrier
    v_mfma_f32_16x16x32_bf16 v[8:11], v[64:67], v[36:39], v[8:11]
    s_lshl_b32 s63, s58, 3
    s_add_u32 s63, s63, 4
    s_and_b32 s63, s63, 31
    s_lshl_b32 s59, s56, 5
    s_add_u32 s63, s63, s59
    s_lshl_b32 s59, s63, 10
    s_add_u32 s59, s59, s97
    s_lshl_b32 s60, s63, 15
    s_add_u32 s60, s60, s98
    s_add_u32 m0, s62, 114688
    s_add_u32 s93, s60, 3072
    buffer_load_dwordx4 v232, s[24:27], s60 offen lds
    v_mfma_f32_16x16x32_bf16 v[12:15], v[68:71], v[36:39], v[12:15]
    ds_read_b128 v[60:63], v228 offset:7168
    s_waitcnt lgkmcnt(8)
    v_mfma_f32_16x16x32_bf16 v[16:19], v[64:67], v[40:43], v[16:19]
    v_mfma_f32_16x16x32_bf16 v[20:23], v[68:71], v[40:43], v[20:23]
    v_add_u32 v228, 0, v224
    v_add_u32 v229, 0, v225
    v_add_u32 v230, 0, v226
    v_mfma_f32_16x16x32_bf16 v[24:27], v[64:67], v[44:47], v[24:27]
    ds_read_b64_tr_b16 v[64:65], v229 offset:0
    ds_read_b64_tr_b16 v[66:67], v229 offset:4096
    buffer_load_dwordx4 v233, s[24:27], s93 offen offset:1024 lds
    v_mfma_f32_16x16x32_bf16 v[28:31], v[68:71], v[44:47], v[28:31]
    ds_read_b128 v[32:35], v228 offset:0
    ds_read_b64_tr_b16 v[68:69], v230 offset:0
    s_waitcnt lgkmcnt(6)
    v_mfma_f32_16x16x32_bf16 v[0:3], v[72:75], v[48:51], v[0:3]
    ds_read_b64_tr_b16 v[70:71], v230 offset:4096
    ds_read_b128 v[36:39], v228 offset:2048
    v_mfma_f32_16x16x32_bf16 v[4:7], v[76:79], v[48:51], v[4:7]
    ds_read_b128 v[40:43], v228 offset:4096
    v_mfma_f32_16x16x32_bf16 v[8:11], v[72:75], v[52:55], v[8:11]
    s_add_u32 m0, s62, 98304
    s_nop 0
    buffer_load_dwordx4 v254, s[52:55], s59 offen sc1 lds
    v_mfma_f32_16x16x32_bf16 v[12:15], v[76:79], v[52:55], v[12:15]
    ds_read_b128 v[44:47], v228 offset:6144
    s_waitcnt lgkmcnt(8)
    v_mfma_f32_16x16x32_bf16 v[16:19], v[72:75], v[56:59], v[16:19]
    v_mfma_f32_16x16x32_bf16 v[20:23], v[76:79], v[56:59], v[20:23]
    v_mfma_f32_16x16x32_bf16 v[24:27], v[72:75], v[60:63], v[24:27]
    ds_read_b64_tr_b16 v[72:73], v229 offset:8192
    ds_read_b64_tr_b16 v[74:75], v229 offset:12288
    buffer_load_dwordx4 v254, s[52:55], s59 offen offset:1024 sc1 lds
    v_mfma_f32_16x16x32_bf16 v[28:31], v[76:79], v[60:63], v[28:31]
    ds_read_b128 v[48:51], v228 offset:1024
    ds_read_b64_tr_b16 v[76:77], v230 offset:8192
    s_waitcnt lgkmcnt(6)
    v_mfma_f32_16x16x32_bf16 v[0:3], v[64:67], v[32:35], v[0:3]
    ds_read_b64_tr_b16 v[78:79], v230 offset:12288
    ds_read_b128 v[52:55], v228 offset:3072
    v_mfma_f32_16x16x32_bf16 v[4:7], v[68:71], v[32:35], v[4:7]
    ds_read_b128 v[56:59], v228 offset:5120
    s_waitcnt vmcnt(8)
    s_barrier
    v_mfma_f32_16x16x32_bf16 v[8:11], v[64:67], v[36:39], v[8:11]
    s_lshl_b32 s63, s58, 3
    s_add_u32 s63, s63, 6
    s_and_b32 s63, s63, 31
    s_lshl_b32 s59, s56, 5
    s_add_u32 s63, s63, s59
    s_lshl_b32 s59, s63, 10
    s_add_u32 s59, s59, s97
    s_lshl_b32 s60, s63, 15
    s_add_u32 s60, s60, s98
    s_add_u32 m0, s62, 147456
    s_add_u32 s93, s60, 3072
    buffer_load_dwordx4 v232, s[24:27], s60 offen lds
    v_mfma_f32_16x16x32_bf16 v[12:15], v[68:71], v[36:39], v[12:15]
    ds_read_b128 v[60:63], v228 offset:7168
    s_waitcnt lgkmcnt(8)
    v_mfma_f32_16x16x32_bf16 v[16:19], v[64:67], v[40:43], v[16:19]
    v_mfma_f32_16x16x32_bf16 v[20:23], v[68:71], v[40:43], v[20:23]
    v_add_u32 v228, 32768, v224
    v_add_u32 v229, 32768, v225
    v_add_u32 v230, 32768, v226
    v_mfma_f32_16x16x32_bf16 v[24:27], v[64:67], v[44:47], v[24:27]
    ds_read_b64_tr_b16 v[64:65], v229 offset:0
    ds_read_b64_tr_b16 v[66:67], v229 offset:4096
    buffer_load_dwordx4 v233, s[24:27], s93 offen offset:1024 lds
    v_mfma_f32_16x16x32_bf16 v[28:31], v[68:71], v[44:47], v[28:31]
    ds_read_b128 v[32:35], v228 offset:0
    ds_read_b64_tr_b16 v[68:69], v230 offset:0
    s_waitcnt lgkmcnt(6)
    v_mfma_f32_16x16x32_bf16 v[0:3], v[72:75], v[48:51], v[0:3]
    ds_read_b64_tr_b16 v[70:71], v230 offset:4096
    ds_read_b128 v[36:39], v228 offset:2048
    v_mfma_f32_16x16x32_bf16 v[4:7], v[76:79], v[48:51], v[4:7]
    ds_read_b128 v[40:43], v228 offset:4096
    v_mfma_f32_16x16x32_bf16 v[8:11], v[72:75], v[52:55], v[8:11]
    s_add_u32 m0, s62, 131072
    s_nop 0
    buffer_load_dwordx4 v254, s[52:55], s59 offen sc1 lds
    v_mfma_f32_16x16x32_bf16 v[12:15], v[76:79], v[52:55], v[12:15]
    ds_read_b128 v[44:47], v228 offset:6144
    s_waitcnt lgkmcnt(8)
    v_mfma_f32_16x16x32_bf16 v[16:19], v[72:75], v[56:59], v[16:19]
    v_mfma_f32_16x16x32_bf16 v[20:23], v[76:79], v[56:59], v[20:23]
    v_mfma_f32_16x16x32_bf16 v[24:27], v[72:75], v[60:63], v[24:27]
    ds_read_b64_tr_b16 v[72:73], v229 offset:8192
    ds_read_b64_tr_b16 v[74:75], v229 offset:12288
    buffer_load_dwordx4 v254, s[52:55], s59 offen offset:1024 sc1 lds
    v_mfma_f32_16x16x32_bf16 v[28:31], v[76:79], v[60:63], v[28:31]
    ds_read_b128 v[48:51], v228 offset:1024
    ds_read_b64_tr_b16 v[76:77], v230 offset:8192
    s_waitcnt lgkmcnt(6)
    v_mfma_f32_16x16x32_bf16 v[0:3], v[64:67], v[32:35], v[0:3]
    ds_read_b64_tr_b16 v[78:79], v230 offset:12288
    ds_read_b128 v[52:55], v228 offset:3072
    v_mfma_f32_16x16x32_bf16 v[4:7], v[68:71], v[32:35], v[4:7]
    ds_read_b128 v[56:59], v228 offset:5120
    s_waitcnt vmcnt(8)
    s_barrier
    v_mfma_f32_16x16x32_bf16 v[8:11], v[64:67], v[36:39], v[8:11]
    s_lshl_b32 s63, s58, 3
    s_add_u32 s63, s63, 8
    s_and_b32 s63, s63, 31
    s_lshl_b32 s59, s56, 5
    s_add_u32 s63, s63, s59
    s_lshl_b32 s59, s63, 10
    s_add_u32 s59, s59, s97
    s_lshl_b32 s60, s63, 15
    s_add_u32 s60, s60, s98
    s_add_u32 m0, s62, 16384
    s_add_u32 s93, s60, 3072
    buffer_load_dwordx4 v232, s[24:27], s60 offen lds
    v_mfma_f32_16x16x32_bf16 v[12:15], v[68:71], v[36:39], v[12:15]
    ds_read_b128 v[60:63], v228 offset:7168
    s_waitcnt lgkmcnt(8)
    v_mfma_f32_16x16x32_bf16 v[16:19], v[64:67], v[40:43], v[16:19]
    v_mfma_f32_16x16x32_bf16 v[20:23], v[68:71], v[40:43], v[20:23]
    v_add_u32 v228, 65536, v224
    v_add_u32 v229, 65536, v225
    v_add_u32 v230, 65536, v226
    v_mfma_f32_16x16x32_bf16 v[24:27], v[64:67], v[44:47], v[24:27]
    ds_read_b64_tr_b16 v[64:65], v229 offset:0
    ds_read_b64_tr_b16 v[66:67], v229 offset:4096
    buffer_load_dwordx4 v233, s[24:27], s93 offen offset:1024 lds
    v_mfma_f32_16x16x32_bf16 v[28:31], v[68:71], v[44:47], v[28:31]
    ds_read_b128 v[32:35], v228 offset:0
    ds_read_b64_tr_b16 v[68:69], v230 offset:0
    s_waitcnt lgkmcnt(6)
    v_mfma_f32_16x16x32_bf16 v[0:3], v[72:75], v[48:51], v[0:3]
    ds_read_b64_tr_b16 v[70:71], v230 offset:4096
    ds_read_b128 v[36:39], v228 offset:2048
    v_mfma_f32_16x16x32_bf16 v[4:7], v[76:79], v[48:51], v[4:7]
    ds_read_b128 v[40:43], v228 offset:4096
    v_mfma_f32_16x16x32_bf16 v[8:11], v[72:75], v[52:55], v[8:11]
    s_add_u32 m0, s62, 0
    s_nop 0
    buffer_load_dwordx4 v254, s[52:55], s59 offen sc1 lds
    v_mfma_f32_16x16x32_bf16 v[12:15], v[76:79], v[52:55], v[12:15]
    ds_read_b128 v[44:47], v228 offset:6144
    s_waitcnt lgkmcnt(8)
    v_mfma_f32_16x16x32_bf16 v[16:19], v[72:75], v[56:59], v[16:19]
    v_mfma_f32_16x16x32_bf16 v[20:23], v[76:79], v[56:59], v[20:23]
    v_mfma_f32_16x16x32_bf16 v[24:27], v[72:75], v[60:63], v[24:27]
    ds_read_b64_tr_b16 v[72:73], v229 offset:8192
    ds_read_b64_tr_b16 v[74:75], v229 offset:12288
    buffer_load_dwordx4 v254, s[52:55], s59 offen offset:1024 sc1 lds
    v_mfma_f32_16x16x32_bf16 v[28:31], v[76:79], v[60:63], v[28:31]
    ds_read_b128 v[48:51], v228 offset:1024
    ds_read_b64_tr_b16 v[76:77], v230 offset:8192
    s_waitcnt lgkmcnt(6)
    v_mfma_f32_16x16x32_bf16 v[0:3], v[64:67], v[32:35], v[0:3]
    ds_read_b64_tr_b16 v[78:79], v230 offset:12288
    ds_read_b128 v[52:55], v228 offset:3072
    v_mfma_f32_16x16x32_bf16 v[4:7], v[68:71], v[32:35], v[4:7]
    ds_read_b128 v[56:59], v228 offset:5120
    s_waitcnt vmcnt(8)
    s_barrier
    v_mfma_f32_16x16x32_bf16 v[8:11], v[64:67], v[36:39], v[8:11]
    s_lshl_b32 s63, s58, 3
    s_add_u32 s63, s63, 10
    s_and_b32 s63, s63, 31
    s_lshl_b32 s59, s56, 5
    s_add_u32 s63, s63, s59
    s_lshl_b32 s59, s63, 10
    s_add_u32 s59, s59, s97
    s_lshl_b32 s60, s63, 15
    s_add_u32 s60, s60, s98
    s_add_u32 m0, s62, 49152
    s_add_u32 s93, s60, 3072
    buffer_load_dwordx4 v232, s[24:27], s60 offen lds
    v_mfma_f32_16x16x32_bf16 v[12:15], v[68:71], v[36:39], v[12:15]
    ds_read_b128 v[60:63], v228 offset:7168
    s_waitcnt lgkmcnt(8)
    v_mfma_f32_16x16x32_bf16 v[16:19], v[64:67], v[40:43], v[16:19]
    v_mfma_f32_16x16x32_bf16 v[20:23], v[68:71], v[40:43], v[20:23]
    v_add_u32 v228, 98304, v224
    v_add_u32 v229, 98304, v225
    v_add_u32 v230, 98304, v226
    v_mfma_f32_16x16x32_bf16 v[24:27], v[64:67], v[44:47], v[24:27]
    ds_read_b64_tr_b16 v[64:65], v229 offset:0
    ds_read_b64_tr_b16 v[66:67], v229 offset:4096
    buffer_load_dwordx4 v233, s[24:27], s93 offen offset:1024 lds
    v_mfma_f32_16x16x32_bf16 v[28:31], v[68:71], v[44:47], v[28:31]
    ds_read_b128 v[32:35], v228 offset:0
    ds_read_b64_tr_b16 v[68:69], v230 offset:0
    s_waitcnt lgkmcnt(6)
    v_mfma_f32_16x16x32_bf16 v[0:3], v[72:75], v[48:51], v[0:3]
    ds_read_b64_tr_b16 v[70:71], v230 offset:4096
    ds_read_b128 v[36:39], v228 offset:2048
    v_mfma_f32_16x16x32_bf16 v[4:7], v[76:79], v[48:51], v[4:7]
    ds_read_b128 v[40:43], v228 offset:4096
    v_mfma_f32_16x16x32_bf16 v[8:11], v[72:75], v[52:55], v[8:11]
    s_add_u32 m0, s62, 32768
    s_nop 0
    buffer_load_dwordx4 v254, s[52:55], s59 offen sc1 lds
    v_mfma_f32_16x16x32_bf16 v[12:15], v[76:79], v[52:55], v[12:15]
    ds_read_b128 v[44:47], v228 offset:6144
    s_waitcnt lgkmcnt(8)
    v_mfma_f32_16x16x32_bf16 v[16:19], v[72:75], v[56:59], v[16:19]
    v_mfma_f32_16x16x32_bf16 v[20:23], v[76:79], v[56:59], v[20:23]
    v_mfma_f32_16x16x32_bf16 v[24:27], v[72:75], v[60:63], v[24:27]
    ds_read_b64_tr_b16 v[72:73], v229 offset:8192
    ds_read_b64_tr_b16 v[74:75], v229 offset:12288
    buffer_load_dwordx4 v254, s[52:55], s59 offen offset:1024 sc1 lds
    v_mfma_f32_16x16x32_bf16 v[28:31], v[76:79], v[60:63], v[28:31]
    ds_read_b128 v[48:51], v228 offset:1024
    ds_read_b64_tr_b16 v[76:77], v230 offset:8192
    s_waitcnt lgkmcnt(6)
    v_mfma_f32_16x16x32_bf16 v[0:3], v[64:67], v[32:35], v[0:3]
    ds_read_b64_tr_b16 v[78:79], v230 offset:12288
    ds_read_b128 v[52:55], v228 offset:3072
    v_mfma_f32_16x16x32_bf16 v[4:7], v[68:71], v[32:35], v[4:7]
    ds_read_b128 v[56:59], v228 offset:5120
    s_waitcnt vmcnt(8)
    s_barrier
    v_mfma_f32_16x16x32_bf16 v[8:11], v[64:67], v[36:39], v[8:11]
    s_lshl_b32 s63, s58, 3
    s_add_u32 s63, s63, 12
    s_and_b32 s63, s63, 31
    s_lshl_b32 s59, s56, 5
    s_add_u32 s63, s63, s59
    s_lshl_b32 s59, s63, 10
    s_add_u32 s59, s59, s97
    s_lshl_b32 s60, s63, 15
    s_add_u32 s60, s60, s98
    s_add_u32 m0, s62, 81920
    s_add_u32 s93, s60, 3072
    buffer_load_dwordx4 v232, s[24:27], s60 offen lds
    v_mfma_f32_16x16x32_bf16 v[12:15], v[68:71], v[36:39], v[12:15]
    ds_read_b128 v[60:63], v228 offset:7168
    s_waitcnt lgkmcnt(8)
    v_mfma_f32_16x16x32_bf16 v[16:19], v[64:67], v[40:43], v[16:19]
    v_mfma_f32_16x16x32_bf16 v[20:23], v[68:71], v[40:43], v[20:23]
    v_add_u32 v228, 131072, v224
    v_add_u32 v229, 131072, v225
    v_add_u32 v230, 131072, v226
    v_mfma_f32_16x16x32_bf16 v[24:27], v[64:67], v[44:47], v[24:27]
    ds_read_b64_tr_b16 v[64:65], v229 offset:0
    ds_read_b64_tr_b16 v[66:67], v229 offset:4096
    buffer_load_dwordx4 v233, s[24:27], s93 offen offset:1024 lds
    v_mfma_f32_16x16x32_bf16 v[28:31], v[68:71], v[44:47], v[28:31]
    ds_read_b128 v[32:35], v228 offset:0
    ds_read_b64_tr_b16 v[68:69], v230 offset:0
    s_waitcnt lgkmcnt(6)
    v_mfma_f32_16x16x32_bf16 v[0:3], v[72:75], v[48:51], v[0:3]
    ds_read_b64_tr_b16 v[70:71], v230 offset:4096
    ds_read_b128 v[36:39], v228 offset:2048
    v_mfma_f32_16x16x32_bf16 v[4:7], v[76:79], v[48:51], v[4:7]
    ds_read_b128 v[40:43], v228 offset:4096
    v_mfma_f32_16x16x32_bf16 v[8:11], v[72:75], v[52:55], v[8:11]
    s_add_u32 m0, s62, 65536
    s_nop 0
    buffer_load_dwordx4 v254, s[52:55], s59 offen sc1 lds
    v_mfma_f32_16x16x32_bf16 v[12:15], v[76:79], v[52:55], v[12:15]
    ds_read_b128 v[44:47], v228 offset:6144
    s_waitcnt lgkmcnt(8)
    v_mfma_f32_16x16x32_bf16 v[16:19], v[72:75], v[56:59], v[16:19]
    v_mfma_f32_16x16x32_bf16 v[20:23], v[76:79], v[56:59], v[20:23]
    v_mfma_f32_16x16x32_bf16 v[24:27], v[72:75], v[60:63], v[24:27]
    ds_read_b64_tr_b16 v[72:73], v229 offset:8192
    ds_read_b64_tr_b16 v[74:75], v229 offset:12288
    buffer_load_dwordx4 v254, s[52:55], s59 offen offset:1024 sc1 lds
    v_mfma_f32_16x16x32_bf16 v[28:31], v[76:79], v[60:63], v[28:31]
    ds_read_b128 v[48:51], v228 offset:1024
    ds_read_b64_tr_b16 v[76:77], v230 offset:8192
    s_waitcnt lgkmcnt(6)
    v_mfma_f32_16x16x32_bf16 v[0:3], v[64:67], v[32:35], v[0:3]
    ds_read_b64_tr_b16 v[78:79], v230 offset:12288
    ds_read_b128 v[52:55], v228 offset:3072
    v_mfma_f32_16x16x32_bf16 v[4:7], v[68:71], v[32:35], v[4:7]
    ds_read_b128 v[56:59], v228 offset:5120
    s_waitcnt vmcnt(8)
    s_barrier
    v_mfma_f32_16x16x32_bf16 v[8:11], v[64:67], v[36:39], v[8:11]
    s_lshl_b32 s63, s58, 3
    s_add_u32 s63, s63, 14
    s_and_b32 s63, s63, 31
    s_lshl_b32 s59, s56, 5
    s_add_u32 s63, s63, s59
    s_lshl_b32 s59, s63, 10
    s_add_u32 s59, s59, s97
    s_lshl_b32 s60, s63, 15
    s_add_u32 s60, s60, s98
    s_add_u32 m0, s62, 114688
    s_add_u32 s93, s60, 3072
    buffer_load_dwordx4 v232, s[24:27], s60 offen lds
    v_mfma_f32_16x16x32_bf16 v[12:15], v[68:71], v[36:39], v[12:15]
    ds_read_b128 v[60:63], v228 offset:7168
    s_waitcnt lgkmcnt(8)
    v_mfma_f32_16x16x32_bf16 v[16:19], v[64:67], v[40:43], v[16:19]
    v_mfma_f32_16x16x32_bf16 v[20:23], v[68:71], v[40:43], v[20:23]
    v_add_u32 v228, 0, v224
    v_add_u32 v229, 0, v225
    v_add_u32 v230, 0, v226
    v_mfma_f32_16x16x32_bf16 v[24:27], v[64:67], v[44:47], v[24:27]
    ds_read_b64_tr_b16 v[64:65], v229 offset:0
    ds_read_b64_tr_b16 v[66:67], v229 offset:4096
    buffer_load_dwordx4 v233, s[24:27], s93 offen offset:1024 lds
    v_mfma_f32_16x16x32_bf16 v[28:31], v[68:71], v[44:47], v[28:31]
    ds_read_b128 v[32:35], v228 offset:0
    ds_read_b64_tr_b16 v[68:69], v230 offset:0
    s_waitcnt lgkmcnt(6)
    v_mfma_f32_16x16x32_bf16 v[0:3], v[72:75], v[48:51], v[0:3]
    ds_read_b64_tr_b16 v[70:71], v230 offset:4096
    ds_read_b128 v[36:39], v228 offset:2048
    v_mfma_f32_16x16x32_bf16 v[4:7], v[76:79], v[48:51], v[4:7]
    ds_read_b128 v[40:43], v228 offset:4096
    v_mfma_f32_16x16x32_bf16 v[8:11], v[72:75], v[52:55], v[8:11]
    s_add_u32 m0, s62, 98304
    s_nop 0
    buffer_load_dwordx4 v254, s[52:55], s59 offen sc1 lds
    v_mfma_f32_16x16x32_bf16 v[12:15], v[76:79], v[52:55], v[12:15]
    ds_read_b128 v[44:47], v228 offset:6144
    s_waitcnt lgkmcnt(8)
    v_mfma_f32_16x16x32_bf16 v[16:19], v[72:75], v[56:59], v[16:19]
    v_mfma_f32_16x16x32_bf16 v[20:23], v[76:79], v[56:59], v[20:23]
    v_mfma_f32_16x16x32_bf16 v[24:27], v[72:75], v[60:63], v[24:27]
    ds_read_b64_tr_b16 v[72:73], v229 offset:8192
    ds_read_b64_tr_b16 v[74:75], v229 offset:12288
    buffer_load_dwordx4 v254, s[52:55], s59 offen offset:1024 sc1 lds
    v_mfma_f32_16x16x32_bf16 v[28:31], v[76:79], v[60:63], v[28:31]
    ds_read_b128 v[48:51], v228 offset:1024
    ds_read_b64_tr_b16 v[76:77], v230 offset:8192
    s_waitcnt lgkmcnt(6)
    v_mfma_f32_16x16x32_bf16 v[0:3], v[64:67], v[32:35], v[0:3]
    ds_read_b64_tr_b16 v[78:79], v230 offset:12288
    ds_read_b128 v[52:55], v228 offset:3072
    v_mfma_f32_16x16x32_bf16 v[4:7], v[68:71], v[32:35], v[4:7]
    ds_read_b128 v[56:59], v228 offset:5120
    s_waitcnt vmcnt(8)
    s_barrier
    v_mfma_f32_16x16x32_bf16 v[8:11], v[64:67], v[36:39], v[8:11]
    s_lshl_b32 s63, s58, 3
    s_add_u32 s63, s63, 16
    s_and_b32 s63, s63, 31
    s_lshl_b32 s59, s56, 5
    s_add_u32 s63, s63, s59
    s_lshl_b32 s59, s63, 10
    s_add_u32 s59, s59, s97
    s_lshl_b32 s60, s63, 15
    s_add_u32 s60, s60, s98
    s_add_u32 m0, s62, 147456
    s_add_u32 s93, s60, 3072
    buffer_load_dwordx4 v232, s[24:27], s60 offen lds
    v_mfma_f32_16x16x32_bf16 v[12:15], v[68:71], v[36:39], v[12:15]
    ds_read_b128 v[60:63], v228 offset:7168
    s_waitcnt lgkmcnt(8)
    v_mfma_f32_16x16x32_bf16 v[16:19], v[64:67], v[40:43], v[16:19]
    v_mfma_f32_16x16x32_bf16 v[20:23], v[68:71], v[40:43], v[20:23]
    v_add_u32 v228, 32768, v224
    v_add_u32 v229, 32768, v225
    v_add_u32 v230, 32768, v226
    v_mfma_f32_16x16x32_bf16 v[24:27], v[64:67], v[44:47], v[24:27]
    ds_read_b64_tr_b16 v[64:65], v229 offset:0
    ds_read_b64_tr_b16 v[66:67], v229 offset:4096
    buffer_load_dwordx4 v233, s[24:27], s93 offen offset:1024 lds
    v_mfma_f32_16x16x32_bf16 v[28:31], v[68:71], v[44:47], v[28:31]
    ds_read_b128 v[32:35], v228 offset:0
    ds_read_b64_tr_b16 v[68:69], v230 offset:0
    s_waitcnt lgkmcnt(6)
    v_mfma_f32_16x16x32_bf16 v[0:3], v[72:75], v[48:51], v[0:3]
    ds_read_b64_tr_b16 v[70:71], v230 offset:4096
    ds_read_b128 v[36:39], v228 offset:2048
    v_mfma_f32_16x16x32_bf16 v[4:7], v[76:79], v[48:51], v[4:7]
    ds_read_b128 v[40:43], v228 offset:4096
    v_mfma_f32_16x16x32_bf16 v[8:11], v[72:75], v[52:55], v[8:11]
    s_add_u32 m0, s62, 131072
    s_nop 0
    buffer_load_dwordx4 v254, s[52:55], s59 offen sc1 lds
    v_mfma_f32_16x16x32_bf16 v[12:15], v[76:79], v[52:55], v[12:15]
    ds_read_b128 v[44:47], v228 offset:6144
    s_waitcnt lgkmcnt(8)
    v_mfma_f32_16x16x32_bf16 v[16:19], v[72:75], v[56:59], v[16:19]
    v_mfma_f32_16x16x32_bf16 v[20:23], v[76:79], v[56:59], v[20:23]
    v_mfma_f32_16x16x32_bf16 v[24:27], v[72:75], v[60:63], v[24:27]
    ds_read_b64_tr_b16 v[72:73], v229 offset:8192
    ds_read_b64_tr_b16 v[74:75], v229 offset:12288
    buffer_load_dwordx4 v254, s[52:55], s59 offen offset:1024 sc1 lds
    v_mfma_f32_16x16x32_bf16 v[28:31], v[76:79], v[60:63], v[28:31]
    ds_read_b128 v[48:51], v228 offset:1024
    ds_read_b64_tr_b16 v[76:77], v230 offset:8192
    s_waitcnt lgkmcnt(6)
    v_mfma_f32_16x16x32_bf16 v[0:3], v[64:67], v[32:35], v[0:3]
    ds_read_b64_tr_b16 v[78:79], v230 offset:12288
    ds_read_b128 v[52:55], v228 offset:3072
    v_mfma_f32_16x16x32_bf16 v[4:7], v[68:71], v[32:35], v[4:7]
    ds_read_b128 v[56:59], v228 offset:5120
    s_waitcnt vmcnt(8)
    s_barrier
    v_mfma_f32_16x16x32_bf16 v[8:11], v[64:67], v[36:39], v[8:11]
    s_lshl_b32 s63, s58, 3
    s_add_u32 s63, s63, 18
    s_and_b32 s63, s63, 31
    s_lshl_b32 s59, s56, 5
    s_add_u32 s63, s63, s59
    s_lshl_b32 s59, s63, 10
    s_add_u32 s59, s59, s97
    s_lshl_b32 s60, s63, 15
    s_add_u32 s60, s60, s98
    s_add_u32 m0, s62, 16384
    s_add_u32 s93, s60, 3072
    buffer_load_dwordx4 v232, s[24:27], s60 offen lds
    v_mfma_f32_16x16x32_bf16 v[12:15], v[68:71], v[36:39], v[12:15]
    ds_read_b128 v[60:63], v228 offset:7168
    s_waitcnt lgkmcnt(8)
    v_mfma_f32_16x16x32_bf16 v[16:19], v[64:67], v[40:43], v[16:19]
    v_mfma_f32_16x16x32_bf16 v[20:23], v[68:71], v[40:43], v[20:23]
    v_add_u32 v228, 65536, v224
    v_add_u32 v229, 65536, v225
    v_add_u32 v230, 65536, v226
    v_mfma_f32_16x16x32_bf16 v[24:27], v[64:67], v[44:47], v[24:27]
    ds_read_b64_tr_b16 v[64:65], v229 offset:0
    ds_read_b64_tr_b16 v[66:67], v229 offset:4096
    buffer_load_dwordx4 v233, s[24:27], s93 offen offset:1024 lds
    v_mfma_f32_16x16x32_bf16 v[28:31], v[68:71], v[44:47], v[28:31]
    ds_read_b128 v[32:35], v228 offset:0
    ds_read_b64_tr_b16 v[68:69], v230 offset:0
    s_waitcnt lgkmcnt(6)
    v_mfma_f32_16x16x32_bf16 v[0:3], v[72:75], v[48:51], v[0:3]
    ds_read_b64_tr_b16 v[70:71], v230 offset:4096
    ds_read_b128 v[36:39], v228 offset:2048
    v_mfma_f32_16x16x32_bf16 v[4:7], v[76:79], v[48:51], v[4:7]
    ds_read_b128 v[40:43], v228 offset:4096
    v_mfma_f32_16x16x32_bf16 v[8:11], v[72:75], v[52:55], v[8:11]
    s_add_u32 m0, s62, 0
    s_nop 0
    buffer_load_dwordx4 v254, s[52:55], s59 offen sc1 lds
    v_mfma_f32_16x16x32_bf16 v[12:15], v[76:79], v[52:55], v[12:15]
    ds_read_b128 v[44:47], v228 offset:6144
    s_waitcnt lgkmcnt(8)
    v_mfma_f32_16x16x32_bf16 v[16:19], v[72:75], v[56:59], v[16:19]
    v_mfma_f32_16x16x32_bf16 v[20:23], v[76:79], v[56:59], v[20:23]
    v_mfma_f32_16x16x32_bf16 v[24:27], v[72:75], v[60:63], v[24:27]
    ds_read_b64_tr_b16 v[72:73], v229 offset:8192
    ds_read_b64_tr_b16 v[74:75], v229 offset:12288
    buffer_load_dwordx4 v254, s[52:55], s59 offen offset:1024 sc1 lds
    v_mfma_f32_16x16x32_bf16 v[28:31], v[76:79], v[60:63], v[28:31]
    ds_read_b128 v[48:51], v228 offset:1024
    ds_read_b64_tr_b16 v[76:77], v230 offset:8192
    s_waitcnt lgkmcnt(6)
    v_mfma_f32_16x16x32_bf16 v[0:3], v[64:67], v[32:35], v[0:3]
    ds_read_b64_tr_b16 v[78:79], v230 offset:12288
    ds_read_b128 v[52:55], v228 offset:3072
    v_mfma_f32_16x16x32_bf16 v[4:7], v[68:71], v[32:35], v[4:7]
    ds_read_b128 v[56:59], v228 offset:5120
    s_waitcnt vmcnt(8)
    s_barrier
    v_mfma_f32_16x16x32_bf16 v[8:11], v[64:67], v[36:39], v[8:11]
    s_lshl_b32 s63, s58, 3
    s_add_u32 s63, s63, 20
    s_and_b32 s63, s63, 31
    s_lshl_b32 s59, s56, 5
    s_add_u32 s63, s63, s59
    s_lshl_b32 s59, s63, 10
    s_add_u32 s59, s59, s97
    s_lshl_b32 s60, s63, 15
    s_add_u32 s60, s60, s98
    s_add_u32 m0, s62, 49152
    s_add_u32 s93, s60, 3072
    buffer_load_dwordx4 v232, s[24:27], s60 offen lds
    v_mfma_f32_16x16x32_bf16 v[12:15], v[68:71], v[36:39], v[12:15]
    ds_read_b128 v[60:63], v228 offset:7168
    s_waitcnt lgkmcnt(8)
    v_mfma_f32_16x16x32_bf16 v[16:19], v[64:67], v[40:43], v[16:19]
    v_mfma_f32_16x16x32_bf16 v[20:23], v[68:71], v[40:43], v[20:23]
    v_add_u32 v228, 98304, v224
    v_add_u32 v229, 98304, v225
    v_add_u32 v230, 98304, v226
    v_mfma_f32_16x16x32_bf16 v[24:27], v[64:67], v[44:47], v[24:27]
    ds_read_b64_tr_b16 v[64:65], v229 offset:0
    ds_read_b64_tr_b16 v[66:67], v229 offset:4096
    buffer_load_dwordx4 v233, s[24:27], s93 offen offset:1024 lds
    v_mfma_f32_16x16x32_bf16 v[28:31], v[68:71], v[44:47], v[28:31]
    ds_read_b128 v[32:35], v228 offset:0
    ds_read_b64_tr_b16 v[68:69], v230 offset:0
    s_waitcnt lgkmcnt(6)
    v_mfma_f32_16x16x32_bf16 v[0:3], v[72:75], v[48:51], v[0:3]
    ds_read_b64_tr_b16 v[70:71], v230 offset:4096
    ds_read_b128 v[36:39], v228 offset:2048
    v_mfma_f32_16x16x32_bf16 v[4:7], v[76:79], v[48:51], v[4:7]
    ds_read_b128 v[40:43], v228 offset:4096
    v_mfma_f32_16x16x32_bf16 v[8:11], v[72:75], v[52:55], v[8:11]
    s_add_u32 m0, s62, 32768
    s_nop 0
    buffer_load_dwordx4 v254, s[52:55], s59 offen sc1 lds
    v_mfma_f32_16x16x32_bf16 v[12:15], v[76:79], v[52:55], v[12:15]
    ds_read_b128 v[44:47], v228 offset:6144
    s_waitcnt lgkmcnt(8)
    v_mfma_f32_16x16x32_bf16 v[16:19], v[72:75], v[56:59], v[16:19]
    v_mfma_f32_16x16x32_bf16 v[20:23], v[76:79], v[56:59], v[20:23]
    v_mfma_f32_16x16x32_bf16 v[24:27], v[72:75], v[60:63], v[24:27]
    ds_read_b64_tr_b16 v[72:73], v229 offset:8192
    ds_read_b64_tr_b16 v[74:75], v229 offset:12288
    buffer_load_dwordx4 v254, s[52:55], s59 offen offset:1024 sc1 lds
    v_mfma_f32_16x16x32_bf16 v[28:31], v[76:79], v[60:63], v[28:31]
    ds_read_b128 v[48:51], v228 offset:1024
    ds_read_b64_tr_b16 v[76:77], v230 offset:8192
    s_waitcnt lgkmcnt(6)
    v_mfma_f32_16x16x32_bf16 v[0:3], v[64:67], v[32:35], v[0:3]
    ds_read_b64_tr_b16 v[78:79], v230 offset:12288
    ds_read_b128 v[52:55], v228 offset:3072
    v_mfma_f32_16x16x32_bf16 v[4:7], v[68:71], v[32:35], v[4:7]
    ds_read_b128 v[56:59], v228 offset:5120
    s_waitcnt vmcnt(8)
    s_barrier
    v_mfma_f32_16x16x32_bf16 v[8:11], v[64:67], v[36:39], v[8:11]
    s_lshl_b32 s63, s58, 3
    s_add_u32 s63, s63, 22
    s_and_b32 s63, s63, 31
    s_lshl_b32 s59, s56, 5
    s_add_u32 s63, s63, s59
    s_lshl_b32 s59, s63, 10
    s_add_u32 s59, s59, s97
    s_lshl_b32 s60, s63, 15
    s_add_u32 s60, s60, s98
    s_add_u32 m0, s62, 81920
    s_add_u32 s93, s60, 3072
    buffer_load_dwordx4 v232, s[24:27], s60 offen lds
    v_mfma_f32_16x16x32_bf16 v[12:15], v[68:71], v[36:39], v[12:15]
    ds_read_b128 v[60:63], v228 offset:7168
    s_waitcnt lgkmcnt(8)
    v_mfma_f32_16x16x32_bf16 v[16:19], v[64:67], v[40:43], v[16:19]
    v_mfma_f32_16x16x32_bf16 v[20:23], v[68:71], v[40:43], v[20:23]
    v_add_u32 v228, 131072, v224
    v_add_u32 v229, 131072, v225
    v_add_u32 v230, 131072, v226
    v_mfma_f32_16x16x32_bf16 v[24:27], v[64:67], v[44:47], v[24:27]
    ds_read_b64_tr_b16 v[64:65], v229 offset:0
    ds_read_b64_tr_b16 v[66:67], v229 offset:4096
    buffer_load_dwordx4 v233, s[24:27], s93 offen offset:1024 lds
    v_mfma_f32_16x16x32_bf16 v[28:31], v[68:71], v[44:47], v[28:31]
    ds_read_b128 v[32:35], v228 offset:0
    ds_read_b64_tr_b16 v[68:69], v230 offset:0
    s_waitcnt lgkmcnt(6)
    v_mfma_f32_16x16x32_bf16 v[0:3], v[72:75], v[48:51], v[0:3]
    ds_read_b64_tr_b16 v[70:71], v230 offset:4096
    ds_read_b128 v[36:39], v228 offset:2048
    v_mfma_f32_16x16x32_bf16 v[4:7], v[76:79], v[48:51], v[4:7]
    ds_read_b128 v[40:43], v228 offset:4096
    v_mfma_f32_16x16x32_bf16 v[8:11], v[72:75], v[52:55], v[8:11]
    s_add_u32 m0, s62, 65536
    s_nop 0
    buffer_load_dwordx4 v254, s[52:55], s59 offen sc1 lds
    v_mfma_f32_16x16x32_bf16 v[12:15], v[76:79], v[52:55], v[12:15]
    ds_read_b128 v[44:47], v228 offset:6144
    s_waitcnt lgkmcnt(8)
    v_mfma_f32_16x16x32_bf16 v[16:19], v[72:75], v[56:59], v[16:19]
    v_mfma_f32_16x16x32_bf16 v[20:23], v[76:79], v[56:59], v[20:23]
    v_mfma_f32_16x16x32_bf16 v[24:27], v[72:75], v[60:63], v[24:27]
    ds_read_b64_tr_b16 v[72:73], v229 offset:8192
    ds_read_b64_tr_b16 v[74:75], v229 offset:12288
    buffer_load_dwordx4 v254, s[52:55], s59 offen offset:1024 sc1 lds
    v_mfma_f32_16x16x32_bf16 v[28:31], v[76:79], v[60:63], v[28:31]
    ds_read_b128 v[48:51], v228 offset:1024
    ds_read_b64_tr_b16 v[76:77], v230 offset:8192
    s_waitcnt lgkmcnt(6)
    v_mfma_f32_16x16x32_bf16 v[0:3], v[64:67], v[32:35], v[0:3]
    ds_read_b64_tr_b16 v[78:79], v230 offset:12288
    ds_read_b128 v[52:55], v228 offset:3072
    v_mfma_f32_16x16x32_bf16 v[4:7], v[68:71], v[32:35], v[4:7]
    ds_read_b128 v[56:59], v228 offset:5120
    s_waitcnt vmcnt(8)
    s_barrier
    v_mfma_f32_16x16x32_bf16 v[8:11], v[64:67], v[36:39], v[8:11]
    s_lshl_b32 s63, s58, 3
    s_add_u32 s63, s63, 24
    s_and_b32 s63, s63, 31
    s_lshl_b32 s59, s56, 5
    s_add_u32 s63, s63, s59
    s_lshl_b32 s59, s63, 10
    s_add_u32 s59, s59, s97
    s_lshl_b32 s60, s63, 15
    s_add_u32 s60, s60, s98
    s_add_u32 m0, s62, 114688
    s_add_u32 s93, s60, 3072
    buffer_load_dwordx4 v232, s[24:27], s60 offen lds
    v_mfma_f32_16x16x32_bf16 v[12:15], v[68:71], v[36:39], v[12:15]
    ds_read_b128 v[60:63], v228 offset:7168
    s_waitcnt lgkmcnt(8)
    v_mfma_f32_16x16x32_bf16 v[16:19], v[64:67], v[40:43], v[16:19]
    v_mfma_f32_16x16x32_bf16 v[20:23], v[68:71], v[40:43], v[20:23]
    v_add_u32 v228, 0, v224
    v_add_u32 v229, 0, v225
    v_add_u32 v230, 0, v226
    v_mfma_f32_16x16x32_bf16 v[24:27], v[64:67], v[44:47], v[24:27]
    ds_read_b64_tr_b16 v[64:65], v229 offset:0
    ds_read_b64_tr_b16 v[66:67], v229 offset:4096
    buffer_load_dwordx4 v233, s[24:27], s93 offen offset:1024 lds
    v_mfma_f32_16x16x32_bf16 v[28:31], v[68:71], v[44:47], v[28:31]
    ds_read_b128 v[32:35], v228 offset:0
    ds_read_b64_tr_b16 v[68:69], v230 offset:0
    s_waitcnt lgkmcnt(6)
    v_mfma_f32_16x16x32_bf16 v[0:3], v[72:75], v[48:51], v[0:3]
    ds_read_b64_tr_b16 v[70:71], v230 offset:4096
    ds_read_b128 v[36:39], v228 offset:2048
    v_mfma_f32_16x16x32_bf16 v[4:7], v[76:79], v[48:51], v[4:7]
    ds_read_b128 v[40:43], v228 offset:4096
    v_mfma_f32_16x16x32_bf16 v[8:11], v[72:75], v[52:55], v[8:11]
    s_add_u32 m0, s62, 98304
    s_nop 0
    buffer_load_dwordx4 v254, s[52:55], s59 offen sc1 lds
    v_mfma_f32_16x16x32_bf16 v[12:15], v[76:79], v[52:55], v[12:15]
    ds_read_b128 v[44:47], v228 offset:6144
    s_waitcnt lgkmcnt(8)
    v_mfma_f32_16x16x32_bf16 v[16:19], v[72:75], v[56:59], v[16:19]
    v_mfma_f32_16x16x32_bf16 v[20:23], v[76:79], v[56:59], v[20:23]
    v_mfma_f32_16x16x32_bf16 v[24:27], v[72:75], v[60:63], v[24:27]
    ds_read_b64_tr_b16 v[72:73], v229 offset:8192
    ds_read_b64_tr_b16 v[74:75], v229 offset:12288
    buffer_load_dwordx4 v254, s[52:55], s59 offen offset:1024 sc1 lds
    v_mfma_f32_16x16x32_bf16 v[28:31], v[76:79], v[60:63], v[28:31]
    ds_read_b128 v[48:51], v228 offset:1024
    ds_read_b64_tr_b16 v[76:77], v230 offset:8192
    s_waitcnt lgkmcnt(6)
    v_mfma_f32_16x16x32_bf16 v[0:3], v[64:67], v[32:35], v[0:3]
    ds_read_b64_tr_b16 v[78:79], v230 offset:12288
    ds_read_b128 v[52:55], v228 offset:3072
    v_mfma_f32_16x16x32_bf16 v[4:7], v[68:71], v[32:35], v[4:7]
    ds_read_b128 v[56:59], v228 offset:5120
    s_waitcnt vmcnt(8)
    s_barrier
    v_mfma_f32_16x16x32_bf16 v[8:11], v[64:67], v[36:39], v[8:11]
    s_lshl_b32 s63, s58, 3
    s_add_u32 s63, s63, 26
    s_and_b32 s63, s63, 31
    s_lshl_b32 s59, s56, 5
    s_add_u32 s63, s63, s59
    s_lshl_b32 s59, s63, 10
    s_add_u32 s59, s59, s97
    s_lshl_b32 s60, s63, 15
    s_add_u32 s60, s60, s98
    s_add_u32 m0, s62, 147456
    s_add_u32 s93, s60, 3072
    buffer_load_dwordx4 v232, s[24:27], s60 offen lds
    v_mfma_f32_16x16x32_bf16 v[12:15], v[68:71], v[36:39], v[12:15]
    ds_read_b128 v[60:63], v228 offset:7168
    s_waitcnt lgkmcnt(8)
    v_mfma_f32_16x16x32_bf16 v[16:19], v[64:67], v[40:43], v[16:19]
    v_mfma_f32_16x16x32_bf16 v[20:23], v[68:71], v[40:43], v[20:23]
    v_add_u32 v228, 32768, v224
    v_add_u32 v229, 32768, v225
    v_add_u32 v230, 32768, v226
    v_mfma_f32_16x16x32_bf16 v[24:27], v[64:67], v[44:47], v[24:27]
    ds_read_b64_tr_b16 v[64:65], v229 offset:0
    ds_read_b64_tr_b16 v[66:67], v229 offset:4096
    buffer_load_dwordx4 v233, s[24:27], s93 offen offset:1024 lds
    v_mfma_f32_16x16x32_bf16 v[28:31], v[68:71], v[44:47], v[28:31]
    ds_read_b128 v[32:35], v228 offset:0
    ds_read_b64_tr_b16 v[68:69], v230 offset:0
    s_waitcnt lgkmcnt(6)
    v_mfma_f32_16x16x32_bf16 v[0:3], v[72:75], v[48:51], v[0:3]
    ds_read_b64_tr_b16 v[70:71], v230 offset:4096
    ds_read_b128 v[36:39], v228 offset:2048
    v_mfma_f32_16x16x32_bf16 v[4:7], v[76:79], v[48:51], v[4:7]
    ds_read_b128 v[40:43], v228 offset:4096
    v_mfma_f32_16x16x32_bf16 v[8:11], v[72:75], v[52:55], v[8:11]
    s_add_u32 m0, s62, 131072
    s_nop 0
    buffer_load_dwordx4 v254, s[52:55], s59 offen sc1 lds
    v_mfma_f32_16x16x32_bf16 v[12:15], v[76:79], v[52:55], v[12:15]
    ds_read_b128 v[44:47], v228 offset:6144
    s_waitcnt lgkmcnt(8)
    v_mfma_f32_16x16x32_bf16 v[16:19], v[72:75], v[56:59], v[16:19]
    v_mfma_f32_16x16x32_bf16 v[20:23], v[76:79], v[56:59], v[20:23]
    v_mfma_f32_16x16x32_bf16 v[24:27], v[72:75], v[60:63], v[24:27]
    ds_read_b64_tr_b16 v[72:73], v229 offset:8192
    ds_read_b64_tr_b16 v[74:75], v229 offset:12288
    buffer_load_dwordx4 v254, s[52:55], s59 offen offset:1024 sc1 lds
    v_mfma_f32_16x16x32_bf16 v[28:31], v[76:79], v[60:63], v[28:31]
    ds_read_b128 v[48:51], v228 offset:1024
    ds_read_b64_tr_b16 v[76:77], v230 offset:8192
    s_waitcnt lgkmcnt(6)
    v_mfma_f32_16x16x32_bf16 v[0:3], v[64:67], v[32:35], v[0:3]
    ds_read_b64_tr_b16 v[78:79], v230 offset:12288
    ds_read_b128 v[52:55], v228 offset:3072
    v_mfma_f32_16x16x32_bf16 v[4:7], v[68:71], v[32:35], v[4:7]
    ds_read_b128 v[56:59], v228 offset:5120
    s_waitcnt vmcnt(8)
    s_barrier
    v_mfma_f32_16x16x32_bf16 v[8:11], v[64:67], v[36:39], v[8:11]
    s_lshl_b32 s63, s58, 3
    s_add_u32 s63, s63, 28
    s_and_b32 s63, s63, 31
    s_lshl_b32 s59, s56, 5
    s_add_u32 s63, s63, s59
    s_lshl_b32 s59, s63, 10
    s_add_u32 s59, s59, s97
    s_lshl_b32 s60, s63, 15
    s_add_u32 s60, s60, s98
    s_add_u32 m0, s62, 16384
    s_add_u32 s93, s60, 3072
    buffer_load_dwordx4 v232, s[24:27], s60 offen lds
    v_mfma_f32_16x16x32_bf16 v[12:15], v[68:71], v[36:39], v[12:15]
    ds_read_b128 v[60:63], v228 offset:7168
    s_waitcnt lgkmcnt(8)
    v_mfma_f32_16x16x32_bf16 v[16:19], v[64:67], v[40:43], v[16:19]
    v_mfma_f32_16x16x32_bf16 v[20:23], v[68:71], v[40:43], v[20:23]
    v_add_u32 v228, 65536, v224
    v_add_u32 v229, 65536, v225
    v_add_u32 v230, 65536, v226
    v_mfma_f32_16x16x32_bf16 v[24:27], v[64:67], v[44:47], v[24:27]
    ds_read_b64_tr_b16 v[64:65], v229 offset:0
    ds_read_b64_tr_b16 v[66:67], v229 offset:4096
    buffer_load_dwordx4 v233, s[24:27], s93 offen offset:1024 lds
    v_mfma_f32_16x16x32_bf16 v[28:31], v[68:71], v[44:47], v[28:31]
    ds_read_b128 v[32:35], v228 offset:0
    ds_read_b64_tr_b16 v[68:69], v230 offset:0
    s_waitcnt lgkmcnt(6)
    v_mfma_f32_16x16x32_bf16 v[0:3], v[72:75], v[48:51], v[0:3]
    ds_read_b64_tr_b16 v[70:71], v230 offset:4096
    ds_read_b128 v[36:39], v228 offset:2048
    v_mfma_f32_16x16x32_bf16 v[4:7], v[76:79], v[48:51], v[4:7]
    ds_read_b128 v[40:43], v228 offset:4096
    v_mfma_f32_16x16x32_bf16 v[8:11], v[72:75], v[52:55], v[8:11]
    s_add_u32 m0, s62, 0
    s_nop 0
    buffer_load_dwordx4 v254, s[52:55], s59 offen sc1 lds
    v_mfma_f32_16x16x32_bf16 v[12:15], v[76:79], v[52:55], v[12:15]
    ds_read_b128 v[44:47], v228 offset:6144
    s_waitcnt lgkmcnt(8)
    v_mfma_f32_16x16x32_bf16 v[16:19], v[72:75], v[56:59], v[16:19]
    v_mfma_f32_16x16x32_bf16 v[20:23], v[76:79], v[56:59], v[20:23]
    v_mfma_f32_16x16x32_bf16 v[24:27], v[72:75], v[60:63], v[24:27]
    ds_read_b64_tr_b16 v[72:73], v229 offset:8192
    ds_read_b64_tr_b16 v[74:75], v229 offset:12288
    buffer_load_dwordx4 v254, s[52:55], s59 offen offset:1024 sc1 lds
    v_mfma_f32_16x16x32_bf16 v[28:31], v[76:79], v[60:63], v[28:31]
    ds_read_b128 v[48:51], v228 offset:1024
    ds_read_b64_tr_b16 v[76:77], v230 offset:8192
    s_waitcnt lgkmcnt(6)
    v_mfma_f32_16x16x32_bf16 v[0:3], v[64:67], v[32:35], v[0:3]
    ds_read_b64_tr_b16 v[78:79], v230 offset:12288
    ds_read_b128 v[52:55], v228 offset:3072
    v_mfma_f32_16x16x32_bf16 v[4:7], v[68:71], v[32:35], v[4:7]
    ds_read_b128 v[56:59], v228 offset:5120
    s_waitcnt vmcnt(8)
    s_barrier
    v_mfma_f32_16x16x32_bf16 v[8:11], v[64:67], v[36:39], v[8:11]
    s_lshl_b32 s63, s58, 3
    s_add_u32 s63, s63, 30
    s_and_b32 s63, s63, 31
    s_lshl_b32 s59, s56, 5
    s_add_u32 s63, s63, s59
    s_lshl_b32 s59, s63, 10
    s_add_u32 s59, s59, s97
    s_lshl_b32 s60, s63, 15
    s_add_u32 s60, s60, s98
    s_add_u32 m0, s62, 49152
    s_add_u32 s93, s60, 3072
    buffer_load_dwordx4 v232, s[24:27], s60 offen lds
    v_mfma_f32_16x16x32_bf16 v[12:15], v[68:71], v[36:39], v[12:15]
    ds_read_b128 v[60:63], v228 offset:7168
    s_waitcnt lgkmcnt(8)
    v_mfma_f32_16x16x32_bf16 v[16:19], v[64:67], v[40:43], v[16:19]
    v_mfma_f32_16x16x32_bf16 v[20:23], v[68:71], v[40:43], v[20:23]
    v_add_u32 v228, 98304, v224
    v_add_u32 v229, 98304, v225
    v_add_u32 v230, 98304, v226
    v_mfma_f32_16x16x32_bf16 v[24:27], v[64:67], v[44:47], v[24:27]
    ds_read_b64_tr_b16 v[64:65], v229 offset:0
    ds_read_b64_tr_b16 v[66:67], v229 offset:4096
    buffer_load_dwordx4 v233, s[24:27], s93 offen offset:1024 lds
    v_mfma_f32_16x16x32_bf16 v[28:31], v[68:71], v[44:47], v[28:31]
    ds_read_b128 v[32:35], v228 offset:0
    ds_read_b64_tr_b16 v[68:69], v230 offset:0
    s_waitcnt lgkmcnt(6)
    v_mfma_f32_16x16x32_bf16 v[0:3], v[72:75], v[48:51], v[0:3]
    ds_read_b64_tr_b16 v[70:71], v230 offset:4096
    ds_read_b128 v[36:39], v228 offset:2048
    v_mfma_f32_16x16x32_bf16 v[4:7], v[76:79], v[48:51], v[4:7]
    ds_read_b128 v[40:43], v228 offset:4096
    v_mfma_f32_16x16x32_bf16 v[8:11], v[72:75], v[52:55], v[8:11]
    s_add_u32 m0, s62, 32768
    s_nop 0
    buffer_load_dwordx4 v254, s[52:55], s59 offen sc1 lds
    v_mfma_f32_16x16x32_bf16 v[12:15], v[76:79], v[52:55], v[12:15]
    ds_read_b128 v[44:47], v228 offset:6144
    s_waitcnt lgkmcnt(8)
    v_mfma_f32_16x16x32_bf16 v[16:19], v[72:75], v[56:59], v[16:19]
    v_mfma_f32_16x16x32_bf16 v[20:23], v[76:79], v[56:59], v[20:23]
    v_mfma_f32_16x16x32_bf16 v[24:27], v[72:75], v[60:63], v[24:27]
    ds_read_b64_tr_b16 v[72:73], v229 offset:8192
    ds_read_b64_tr_b16 v[74:75], v229 offset:12288
    buffer_load_dwordx4 v254, s[52:55], s59 offen offset:1024 sc1 lds
    v_mfma_f32_16x16x32_bf16 v[28:31], v[76:79], v[60:63], v[28:31]
    ds_read_b128 v[48:51], v228 offset:1024
    ds_read_b64_tr_b16 v[76:77], v230 offset:8192
    s_waitcnt lgkmcnt(6)
    v_mfma_f32_16x16x32_bf16 v[0:3], v[64:67], v[32:35], v[0:3]
    ds_read_b64_tr_b16 v[78:79], v230 offset:12288
    ds_read_b128 v[52:55], v228 offset:3072
    v_mfma_f32_16x16x32_bf16 v[4:7], v[68:71], v[32:35], v[4:7]
    ds_read_b128 v[56:59], v228 offset:5120
    s_waitcnt vmcnt(8)
    s_barrier
    v_mfma_f32_16x16x32_bf16 v[8:11], v[64:67], v[36:39], v[8:11]
    v_mfma_f32_16x16x32_bf16 v[12:15], v[68:71], v[36:39], v[12:15]
    ds_read_b128 v[60:63], v228 offset:7168
    s_waitcnt lgkmcnt(8)
    v_mfma_f32_16x16x32_bf16 v[16:19], v[64:67], v[40:43], v[16:19]
    v_mfma_f32_16x16x32_bf16 v[20:23], v[68:71], v[40:43], v[20:23]
    v_add_u32 v228, 131072, v224
    v_add_u32 v229, 131072, v225
    v_add_u32 v230, 131072, v226
    v_mfma_f32_16x16x32_bf16 v[24:27], v[64:67], v[44:47], v[24:27]
    ds_read_b64_tr_b16 v[64:65], v229 offset:0
    ds_read_b64_tr_b16 v[66:67], v229 offset:4096
    v_mfma_f32_16x16x32_bf16 v[28:31], v[68:71], v[44:47], v[28:31]
    ds_read_b128 v[32:35], v228 offset:0
    ds_read_b64_tr_b16 v[68:69], v230 offset:0
    s_waitcnt lgkmcnt(6)
    v_mfma_f32_16x16x32_bf16 v[0:3], v[72:75], v[48:51], v[0:3]
    ds_read_b64_tr_b16 v[70:71], v230 offset:4096
    ds_read_b128 v[36:39], v228 offset:2048
    v_mfma_f32_16x16x32_bf16 v[4:7], v[76:79], v[48:51], v[4:7]
    ds_read_b128 v[40:43], v228 offset:4096
    v_mfma_f32_16x16x32_bf16 v[8:11], v[72:75], v[52:55], v[8:11]
    v_mfma_f32_16x16x32_bf16 v[12:15], v[76:79], v[52:55], v[12:15]
    ds_read_b128 v[44:47], v228 offset:6144
    s_waitcnt lgkmcnt(8)
    v_mfma_f32_16x16x32_bf16 v[16:19], v[72:75], v[56:59], v[16:19]
    v_mfma_f32_16x16x32_bf16 v[20:23], v[76:79], v[56:59], v[20:23]
    v_mfma_f32_16x16x32_bf16 v[24:27], v[72:75], v[60:63], v[24:27]
    ds_read_b64_tr_b16 v[72:73], v229 offset:8192
    ds_read_b64_tr_b16 v[74:75], v229 offset:12288
    v_mfma_f32_16x16x32_bf16 v[28:31], v[76:79], v[60:63], v[28:31]
    ds_read_b128 v[48:51], v228 offset:1024
    ds_read_b64_tr_b16 v[76:77], v230 offset:8192
    s_waitcnt lgkmcnt(6)
    v_mfma_f32_16x16x32_bf16 v[0:3], v[64:67], v[32:35], v[0:3]
    ds_read_b64_tr_b16 v[78:79], v230 offset:12288
    ds_read_b128 v[52:55], v228 offset:3072
    v_mfma_f32_16x16x32_bf16 v[4:7], v[68:71], v[32:35], v[4:7]
    ds_read_b128 v[56:59], v228 offset:5120
    s_waitcnt vmcnt(4)
    s_barrier
    v_mfma_f32_16x16x32_bf16 v[8:11], v[64:67], v[36:39], v[8:11]
    v_mfma_f32_16x16x32_bf16 v[12:15], v[68:71], v[36:39], v[12:15]
    ds_read_b128 v[60:63], v228 offset:7168
    s_waitcnt lgkmcnt(8)
    v_mfma_f32_16x16x32_bf16 v[16:19], v[64:67], v[40:43], v[16:19]
    v_mfma_f32_16x16x32_bf16 v[20:23], v[68:71], v[40:43], v[20:23]
    v_add_u32 v228, 0, v224
    v_add_u32 v229, 0, v225
    v_add_u32 v230, 0, v226
    v_mfma_f32_16x16x32_bf16 v[24:27], v[64:67], v[44:47], v[24:27]
    ds_read_b64_tr_b16 v[64:65], v229 offset:0
    ds_read_b64_tr_b16 v[66:67], v229 offset:4096
    v_mfma_f32_16x16x32_bf16 v[28:31], v[68:71], v[44:47], v[28:31]
    ds_read_b128 v[32:35], v228 offset:0
    ds_read_b64_tr_b16 v[68:69], v230 offset:0
    s_waitcnt lgkmcnt(6)
    v_mfma_f32_16x16x32_bf16 v[0:3], v[72:75], v[48:51], v[0:3]
    ds_read_b64_tr_b16 v[70:71], v230 offset:4096
    ds_read_b128 v[36:39], v228 offset:2048
    v_mfma_f32_16x16x32_bf16 v[4:7], v[76:79], v[48:51], v[4:7]
    ds_read_b128 v[40:43], v228 offset:4096
    v_mfma_f32_16x16x32_bf16 v[8:11], v[72:75], v[52:55], v[8:11]
    v_mfma_f32_16x16x32_bf16 v[12:15], v[76:79], v[52:55], v[12:15]
    ds_read_b128 v[44:47], v228 offset:6144
    s_waitcnt lgkmcnt(8)
    v_mfma_f32_16x16x32_bf16 v[16:19], v[72:75], v[56:59], v[16:19]
    v_mfma_f32_16x16x32_bf16 v[20:23], v[76:79], v[56:59], v[20:23]
    v_mfma_f32_16x16x32_bf16 v[24:27], v[72:75], v[60:63], v[24:27]
    ds_read_b64_tr_b16 v[72:73], v229 offset:8192
    ds_read_b64_tr_b16 v[74:75], v229 offset:12288
    v_mfma_f32_16x16x32_bf16 v[28:31], v[76:79], v[60:63], v[28:31]
    ds_read_b128 v[48:51], v228 offset:1024
    ds_read_b64_tr_b16 v[76:77], v230 offset:8192
    s_waitcnt lgkmcnt(6)
    v_mfma_f32_16x16x32_bf16 v[0:3], v[64:67], v[32:35], v[0:3]
    ds_read_b64_tr_b16 v[78:79], v230 offset:12288
    ds_read_b128 v[52:55], v228 offset:3072
    v_mfma_f32_16x16x32_bf16 v[4:7], v[68:71], v[32:35], v[4:7]
    ds_read_b128 v[56:59], v228 offset:5120
    s_waitcnt vmcnt(0)
    s_barrier
    v_mfma_f32_16x16x32_bf16 v[8:11], v[64:67], v[36:39], v[8:11]
    v_mfma_f32_16x16x32_bf16 v[12:15], v[68:71], v[36:39], v[12:15]
    ds_read_b128 v[60:63], v228 offset:7168
    s_waitcnt lgkmcnt(8)
    v_mfma_f32_16x16x32_bf16 v[16:19], v[64:67], v[40:43], v[16:19]
    v_and_b32 v236, 15, v255
    v_lshrrev_b32 v237, 4, v255
    v_mfma_f32_16x16x32_bf16 v[20:23], v[68:71], v[40:43], v[20:23]
    v_add_u32 v228, 32768, v224
    v_add_u32 v229, 32768, v225
    v_add_u32 v230, 32768, v226
    v_lshlrev_b32 v238, 9, v237
    v_lshl_add_u32 v238, v236, 4, v238
    v_mfma_f32_16x16x32_bf16 v[24:27], v[64:67], v[44:47], v[24:27]
    ds_read_b64_tr_b16 v[64:65], v229 offset:0
    ds_read_b64_tr_b16 v[66:67], v229 offset:4096
    v_lshlrev_b32 v239, 10, v236
    v_mfma_f32_16x16x32_bf16 v[28:31], v[68:71], v[44:47], v[28:31]
    ds_read_b128 v[32:35], v228 offset:0
    ds_read_b64_tr_b16 v[68:69], v230 offset:0
    v_lshl_add_u32 v239, v237, 4, v239
    v_and_b32 v240, 1, v237
    s_waitcnt lgkmcnt(6)
    v_mfma_f32_16x16x32_bf16 v[0:3], v[72:75], v[48:51], v[0:3]
    ds_read_b64_tr_b16 v[70:71], v230 offset:4096
    ds_read_b128 v[36:39], v228 offset:2048
    v_lshlrev_b32 v240, 9, v240
    v_mfma_f32_16x16x32_bf16 v[4:7], v[76:79], v[48:51], v[4:7]
    ds_read_b128 v[40:43], v228 offset:4096
    v_lshl_add_u32 v240, v236, 4, v240
    v_lshrrev_b32 v236, 1, v237
    v_mfma_f32_16x16x32_bf16 v[8:11], v[72:75], v[52:55], v[8:11]
    v_lshl_add_u32 v240, v236, 3, v240
    v_mfma_f32_16x16x32_bf16 v[12:15], v[76:79], v[52:55], v[12:15]
    ds_read_b128 v[44:47], v228 offset:6144
    v_lshlrev_b32 v237, 4, v237
    s_lshl_b32 s98, s57, 7
    s_waitcnt lgkmcnt(8)
    v_mfma_f32_16x16x32_bf16 v[16:19], v[72:75], v[56:59], v[16:19]
    s_lshl_b32 s93, s3, 4
    v_mfma_f32_16x16x32_bf16 v[20:23], v[76:79], v[56:59], v[20:23]
    s_add_u32 s98, s98, s93
    s_lshl_b32 s98, s98, 10
    v_mfma_f32_16x16x32_bf16 v[24:27], v[72:75], v[60:63], v[24:27]
    ds_read_b64_tr_b16 v[72:73], v229 offset:8192
    ds_read_b64_tr_b16 v[74:75], v229 offset:12288
    s_lshl_b32 s99, s58, 8
    v_mfma_f32_16x16x32_bf16 v[28:31], v[76:79], v[60:63], v[28:31]
    ds_read_b128 v[48:51], v228 offset:1024
    ds_read_b64_tr_b16 v[76:77], v230 offset:8192
    s_lshl_b32 s93, s56, 6
    s_add_u32 s99, s99, s93
    s_waitcnt lgkmcnt(6)
    v_mfma_f32_16x16x32_bf16 v[0:3], v[64:67], v[32:35], v[0:3]
    ds_read_b64_tr_b16 v[78:79], v230 offset:12288
    ds_read_b128 v[52:55], v228 offset:3072
    s_add_u32 s98, s98, s99
    buffer_load_dwordx4 v[100:103], v239, s[8:11], s98 offen
    v_mfma_f32_16x16x32_bf16 v[4:7], v[68:71], v[32:35], v[4:7]
    ds_read_b128 v[56:59], v228 offset:5120
    buffer_load_dwordx4 v[104:107], v237, s[40:43], s99 offen
    v_mfma_f32_16x16x32_bf16 v[8:11], v[64:67], v[36:39], v[8:11]
    v_and_b32 v250, 3, v255
    v_max_u32 v250, 1, v250
    v_mfma_f32_16x16x32_bf16 v[12:15], v[68:71], v[36:39], v[12:15]
    ds_read_b128 v[60:63], v228 offset:7168
    v_add_u32 v250, s56, v250
    s_waitcnt lgkmcnt(8)
    v_mfma_f32_16x16x32_bf16 v[16:19], v[64:67], v[40:43], v[16:19]
    v_and_b32 v250, 3, v250
    v_lshl_add_u32 v250, v250, 5, s101
    v_mfma_f32_16x16x32_bf16 v[20:23], v[68:71], v[40:43], v[20:23]
    v_lshlrev_b32 v250, 7, v250
    v_mfma_f32_16x16x32_bf16 v[24:27], v[64:67], v[44:47], v[24:27]
    v_add_u32 v250, 3145728, v250
    s_lshl_b32 s97, s57, 2
    v_mfma_f32_16x16x32_bf16 v[28:31], v[68:71], v[44:47], v[28:31]
    s_add_u32 s97, s97, s58
    s_waitcnt lgkmcnt(2)
    v_mfma_f32_16x16x32_bf16 v[0:3], v[72:75], v[48:51], v[0:3]
    s_lshl_b32 s97, s97, 17
    s_add_u32 s97, s97, 67108864
    v_mfma_f32_16x16x32_bf16 v[4:7], v[76:79], v[48:51], v[4:7]
    s_lshl_b32 s93, s56, 15
    v_mfma_f32_16x16x32_bf16 v[8:11], v[72:75], v[52:55], v[8:11]
    s_add_u32 s99, s97, s93
    s_lshl_b32 s93, s3, 12
    v_mfma_f32_16x16x32_bf16 v[12:15], v[76:79], v[52:55], v[12:15]
    s_add_u32 s99, s99, s93
    s_waitcnt lgkmcnt(0)
    v_mfma_f32_16x16x32_bf16 v[16:19], v[72:75], v[56:59], v[16:19]
    v_mfma_f32_16x16x32_bf16 v[20:23], v[76:79], v[56:59], v[20:23]
    v_mfma_f32_16x16x32_bf16 v[24:27], v[72:75], v[60:63], v[24:27]
    v_mfma_f32_16x16x32_bf16 v[28:31], v[76:79], v[60:63], v[28:31]
    s_cmp_lg_u32 s3, 0
    s_cbranch_scc1 L_pub85
    v_mov_b32 v248, 5
    s_lshl_b32 s93, s6, 7
    s_add_u32 s93, s93, 3145728
    v_mov_b32 v251, s93
    s_mov_b64 s[72:73], exec
    s_mov_b64 exec, 1
    buffer_store_dword v248, v251, s[52:55], 0 offen sc1
    s_mov_b64 exec, s[72:73]
    L_pub85:
    s_lshr_b32 s93, s3, 1
    s_cmp_eq_u32 s93, s56
    s_cbranch_scc1 L_c_own
    s_nop 3
    v_cvt_pk_bf16_f32 v128, v0, v1
    v_cvt_pk_bf16_f32 v129, v2, v3
    v_cvt_pk_bf16_f32 v130, v4, v5
    v_cvt_pk_bf16_f32 v131, v6, v7
    buffer_store_dwordx4 v[128:131], v254, s[52:55], s99 offen offset:0 sc1
    v_cvt_pk_bf16_f32 v132, v8, v9
    v_cvt_pk_bf16_f32 v133, v10, v11
    v_cvt_pk_bf16_f32 v134, v12, v13
    v_cvt_pk_bf16_f32 v135, v14, v15
    buffer_store_dwordx4 v[132:135], v254, s[52:55], s99 offen offset:1024 sc1
    v_cvt_pk_bf16_f32 v136, v16, v17
    v_cvt_pk_bf16_f32 v137, v18, v19
    v_cvt_pk_bf16_f32 v138, v20, v21
    v_cvt_pk_bf16_f32 v139, v22, v23
    buffer_store_dwordx4 v[136:139], v254, s[52:55], s99 offen offset:2048 sc1
    v_cvt_pk_bf16_f32 v140, v24, v25
    v_cvt_pk_bf16_f32 v141, v26, v27
    v_cvt_pk_bf16_f32 v142, v28, v29
    v_cvt_pk_bf16_f32 v143, v30, v31
    buffer_store_dwordx4 v[140:143], v254, s[52:55], s99 offen offset:3072 sc1
    s_branch L_c_st
L_c_own:
    v_add_u32 v236, 131072, v224
    s_nop 3
    ds_write_b128 v236, v[0:3] offset:0
    ds_write_b128 v236, v[4:7] offset:1024
    ds_write_b128 v236, v[8:11] offset:2048
    ds_write_b128 v236, v[12:15] offset:3072
    ds_write_b128 v236, v[16:19] offset:4096
    ds_write_b128 v236, v[20:23] offset:5120
    ds_write_b128 v236, v[24:27] offset:6144
    ds_write_b128 v236, v[28:31] offset:7168
L_c_st:
    s_lshl_b32 s99, s56, 13
    s_lshl_b32 s93, s3, 10
    s_add_u32 s99, s99, s93
    s_add_u32 s97, s97, s99
    s_lshl_b32 s93, s3, 11
    s_add_u32 s93, s93, 131072
    v_add_u32 v236, s93, v238
    s_lshl_b32 s99, s56, 1
    s_add_u32 s99, s99, 1
    s_cmp_lg_u32 s3, s99
    s_cbranch_scc1 L_po86
    buffer_load_dword v249, v250, s[52:55], 0 offen sc1
    s_waitcnt vmcnt(0)
    s_mov_b32 s90, 0
    L_pl87:
    v_cmp_gt_u32 vcc, 5, v249
    s_cbranch_vccz L_pd87
    s_add_u32 s90, s90, 1
    s_cmp_gt_u32 s90, 0x40000
    s_cbranch_scc1 L_pd87
    s_sleep 4
    buffer_load_dword v249, v250, s[52:55], 0 offen sc1
    s_waitcnt vmcnt(0)
    s_branch L_pl87
    L_pd87:
    L_po86:
    s_waitcnt lgkmcnt(0)
    s_barrier
    ds_read_b128 v[32:35], v236
    ds_read_b128 v[36:39], v236 offset:256
    s_mov_b32 s101, 0
L_c_rd:
    s_add_u32 s93, s56, 1
    s_and_b32 s93, s93, 3
    s_lshl_b32 s93, s93, 15
    s_add_u32 s93, s93, s97
    buffer_load_dwordx2 v[44:45], v240, s[52:55], s93 offen sc1
    buffer_load_dwordx2 v[46:47], v240, s[52:55], s93 offen offset:256 sc1
    s_add_u32 s93, s56, 2
    s_and_b32 s93, s93, 3
    s_lshl_b32 s93, s93, 15
    s_add_u32 s93, s93, s97
    buffer_load_dwordx2 v[48:49], v240, s[52:55], s93 offen sc1
    buffer_load_dwordx2 v[50:51], v240, s[52:55], s93 offen offset:256 sc1
    s_add_u32 s93, s56, 3
    s_and_b32 s93, s93, 3
    s_lshl_b32 s93, s93, 15
    s_add_u32 s93, s93, s97
    buffer_load_dwordx2 v[52:53], v240, s[52:55], s93 offen sc1
    buffer_load_dwordx2 v[54:55], v240, s[52:55], s93 offen offset:256 sc1
    s_waitcnt vmcnt(0)
    v_max_u32 v64, v44, v45
    v_max3_u32 v64, v64, v46, v47
    v_max3_u32 v64, v64, v48, v49
    v_max3_u32 v64, v64, v50, v51
    v_max3_u32 v64, v64, v52, v53
    v_max3_u32 v64, v64, v54, v55
    v_cmp_eq_u32 vcc, -1, v64
    s_cbranch_vccz L_c_ok
    s_add_u32 s101, s101, 1
    s_cmp_gt_u32 s101, 0x20000
    s_cbranch_scc1 L_c_ok
    s_sleep 4
    s_branch L_c_rd
L_c_ok:
    v_lshlrev_b32 v108, 16, v100
    v_and_b32 v109, 0xffff0000, v100
    v_lshlrev_b32 v110, 16, v101
    v_and_b32 v111, 0xffff0000, v101
    v_lshlrev_b32 v112, 16, v102
    v_and_b32 v113, 0xffff0000, v102
    v_lshlrev_b32 v114, 16, v103
    v_and_b32 v115, 0xffff0000, v103
    v_lshlrev_b32 v116, 16, v104
    v_and_b32 v117, 0xffff0000, v104
    v_lshlrev_b32 v118, 16, v105
    v_and_b32 v119, 0xffff0000, v105
    v_lshlrev_b32 v120, 16, v106
    v_and_b32 v121, 0xffff0000, v106
    v_lshlrev_b32 v122, 16, v107
    v_and_b32 v123, 0xffff0000, v107
    v_pk_add_f32 v[108:109], v[108:109], v[116:117]
    v_pk_add_f32 v[110:111], v[110:111], v[118:119]
    v_pk_add_f32 v[112:113], v[112:113], v[120:121]
    v_pk_add_f32 v[114:115], v[114:115], v[122:123]
    s_waitcnt lgkmcnt(0)
    v_pk_add_f32 v[108:109], v[108:109], v[32:33]
    v_pk_add_f32 v[110:111], v[110:111], v[34:35]
    v_pk_add_f32 v[112:113], v[112:113], v[36:37]
    v_pk_add_f32 v[114:115], v[114:115], v[38:39]
    v_lshlrev_b32 v116, 16, v44
    v_and_b32 v117, 0xffff0000, v44
    v_lshlrev_b32 v118, 16, v45
    v_and_b32 v119, 0xffff0000, v45
    v_lshlrev_b32 v120, 16, v46
    v_and_b32 v121, 0xffff0000, v46
    v_lshlrev_b32 v122, 16, v47
    v_and_b32 v123, 0xffff0000, v47
    v_pk_add_f32 v[108:109], v[108:109], v[116:117]
    v_pk_add_f32 v[110:111], v[110:111], v[118:119]
    v_pk_add_f32 v[112:113], v[112:113], v[120:121]
    v_pk_add_f32 v[114:115], v[114:115], v[122:123]
    v_lshlrev_b32 v116, 16, v48
    v_and_b32 v117, 0xffff0000, v48
    v_lshlrev_b32 v118, 16, v49
    v_and_b32 v119, 0xffff0000, v49
    v_lshlrev_b32 v120, 16, v50
    v_and_b32 v121, 0xffff0000, v50
    v_lshlrev_b32 v122, 16, v51
    v_and_b32 v123, 0xffff0000, v51
    v_pk_add_f32 v[108:109], v[108:109], v[116:117]
    v_pk_add_f32 v[110:111], v[110:111], v[118:119]
    v_pk_add_f32 v[112:113], v[112:113], v[120:121]
    v_pk_add_f32 v[114:115], v[114:115], v[122:123]
    v_lshlrev_b32 v116, 16, v52
    v_and_b32 v117, 0xffff0000, v52
    v_lshlrev_b32 v118, 16, v53
    v_and_b32 v119, 0xffff0000, v53
    v_lshlrev_b32 v120, 16, v54
    v_and_b32 v121, 0xffff0000, v54
    v_lshlrev_b32 v122, 16, v55
    v_and_b32 v123, 0xffff0000, v55
    v_pk_add_f32 v[108:109], v[108:109], v[116:117]
    v_pk_add_f32 v[110:111], v[110:111], v[118:119]
    v_pk_add_f32 v[112:113], v[112:113], v[120:121]
    v_pk_add_f32 v[114:115], v[114:115], v[122:123]
    v_cvt_pk_bf16_f32 v100, v108, v109
    v_cvt_pk_bf16_f32 v101, v110, v111
    v_cvt_pk_bf16_f32 v102, v112, v113
    v_cvt_pk_bf16_f32 v103, v114, v115
    buffer_store_dwordx4 v[100:103], v239, s[44:47], s98 offen
L_end:
    s_endpgm
.section .rodata,"a"
.p2align 6
.amdhsa_kernel parallel_sum__compressed_kv_cla__mixer_channel_mlp__prompt_kernel
  .amdhsa_next_free_vgpr 256
  .amdhsa_next_free_sgpr 102
  .amdhsa_accum_offset 256
  .amdhsa_group_segment_fixed_size 0
  .amdhsa_kernarg_size 112
  .amdhsa_user_sgpr_count 2
  .amdhsa_user_sgpr_kernarg_segment_ptr 1
  .amdhsa_system_sgpr_workgroup_id_x 1
.end_amdhsa_kernel
```
